```python
import torch

def _softmax(x, axis=-1):
    return torch.softmax(x, dim=axis)
def _gelu(x):
    return torch.nn.functional.gelu(x, approximate="tanh")
def _silu(x):
    return torch.nn.functional.silu(x)
def _sigmoid(x):
    return torch.sigmoid(x)
def _layernorm(x, axis=-1, eps=1e-5):
    m = x.mean(dim=axis, keepdim=True)
    v = x.var(dim=axis, keepdim=True, unbiased=False)
    return (x - m) / torch.sqrt(v + eps)
def _scatter_add(tgt, idx, src, axis=0):
    return tgt.clone().index_add_(axis, idx, src)
def _segment_sum(src, seg, n):
    out = torch.zeros((n,) + src.shape[1:], dtype=src.dtype)
    return out.index_add_(0, seg, src)
def _pad(x, pw):
    flat = tuple(v for pair in reversed(pw) for v in pair)
    return torch.nn.functional.pad(x, flat)

kernel_name = 'concat_heads__gqa_block_cached__mha_block_cached__near_ridge'

def setup_inputs():

    _w = (lambda a: (lambda t: t.to(torch.bfloat16) if t.is_floating_point() else t)(torch.as_tensor(a)))
    def _A_setup():
        B, Sq, D = 8, 160, 512
        Hq, Hkv, Sk, Dh = 32, 32, 512, 128
        assert Hq % Hkv == 0, (Hq, Hkv)
        return {
            "x": _w((lambda *s: torch.randn(*s, dtype=torch.bfloat16) * 0.8)(B, Sq, D)),
            "k_cache": _w((lambda *s: torch.randn(*s, dtype=torch.bfloat16) * 0.8)(B, Hkv, Sk, Dh)),
            "v_cache": _w((lambda *s: torch.randn(*s, dtype=torch.bfloat16) * 0.05)(B, Hkv, Sk, Dh)),
            "wq": _w((lambda *s: torch.randn(*s, dtype=torch.bfloat16) * 0.8)(D, Hq * Dh) * (D ** -0.5)),
            "wo": _w((lambda *s: torch.randn(*s, dtype=torch.bfloat16) * 0.05)(Hq * Dh, D) * ((Hq * Dh) ** -0.5)),
        }
    _A_in = _A_setup()

    def _B_setup():
        B, Sq, D = 8, 160, 512
        H, Sk, Dh = 32, 512, 128
        return {
            "x": _w((lambda *s: torch.randn(*s, dtype=torch.bfloat16) * 0.8)(B, Sq, D)),
            "k_cache": _w((lambda *s: torch.randn(*s, dtype=torch.bfloat16) * 0.8)(B, H, Sk, Dh)),
            "v_cache": _w((lambda *s: torch.randn(*s, dtype=torch.bfloat16) * 0.05)(B, H, Sk, Dh)),
            "wq": _w((lambda *s: torch.randn(*s, dtype=torch.bfloat16) * 0.8)(D, H * Dh) * (D ** -0.5)),
            "wo": _w((lambda *s: torch.randn(*s, dtype=torch.bfloat16) * 0.05)(H * Dh, D) * ((H * Dh) ** -0.5)),
        }
    _B_in = _B_setup()

    return {
        "A_x": _A_in["x"],
        "A_k_cache": _A_in["k_cache"],
        "A_v_cache": _A_in["v_cache"],
        "A_wq": _A_in["wq"],
        "A_wo": _A_in["wo"],
        "B_x": _B_in["x"],
        "B_k_cache": _B_in["k_cache"],
        "B_v_cache": _B_in["v_cache"],
        "B_wq": _B_in["wq"],
        "B_wo": _B_in["wo"],
    }

def reference(A_x, A_k_cache, A_v_cache, A_wq, A_wo, B_x, B_k_cache, B_v_cache, B_wq, B_wo):
    def _A_ref(x, k_cache, v_cache, wq, wo):
        B, Sq, D = x.shape
        Hq, Dh = 32, 128
        Hkv = k_cache.shape[1]
        rep = Hq // Hkv
        q = (lambda x, *d: x.permute(*d))((x @ wq).reshape(B, Sq, Hq, Dh), 0, 2, 1, 3)
        k = (lambda x, n, axis: torch.repeat_interleave(x, n, dim=axis))(k_cache, rep, axis=1)
        v = (lambda x, n, axis: torch.repeat_interleave(x, n, dim=axis))(v_cache, rep, axis=1)
        scores = torch.einsum("bhqd,bhkd->bhqk", q, k) * (Dh ** -0.5)
        p = _softmax(scores, axis=-1)
        o = torch.einsum("bhqk,bhkd->bhqd", p, v)
        return (lambda x, *d: x.permute(*d))(o, 0, 2, 1, 3).reshape(B, Sq, Hq * Dh) @ wo

    def _B_ref(x, k_cache, v_cache, wq, wo):
        B, Sq, D = x.shape
        H, Dh = 32, 128
        q = (lambda x, *d: x.permute(*d))((x @ wq).reshape(B, Sq, H, Dh), 0, 2, 1, 3)
        scores = torch.einsum("bhqd,bhkd->bhqk", q, k_cache) * (Dh ** -0.5)
        p = _softmax(scores, axis=-1)
        o = torch.einsum("bhqk,bhkd->bhqd", p, v_cache)
        return (lambda x, *d: x.permute(*d))(o, 0, 2, 1, 3).reshape(B, Sq, H * Dh) @ wo

    a = _A_ref(A_x, A_k_cache, A_v_cache, A_wq, A_wo)
    b = _B_ref(B_x, B_k_cache, B_v_cache, B_wq, B_wo)
    return torch.concatenate([a, b], axis=-1)
```

```asm
; @launch grid=(256,1,1) block=(512,1,1) lds=163840
.amdgcn_target "amdgcn-amd-amdhsa--gfx950"
.text
.globl concat_heads__gqa_block_cached__mha_block_cached__near_ridge_kernel
.p2align 8
.type concat_heads__gqa_block_cached__mha_block_cached__near_ridge_kernel,@function
concat_heads__gqa_block_cached__mha_block_cached__near_ridge_kernel:
    s_cmp_ge_u32 s2, 256
    s_cbranch_scc1 L_end
    s_load_dwordx16 s[16:31], s[0:1], 0
    s_load_dwordx8 s[32:39], s[0:1], 64
    s_load_dwordx2 s[40:41], s[0:1], 96
    v_lshrrev_b32 v1, 6, v0
    v_and_b32 v0, 63, v0
    v_readfirstlane_b32 s3, v1
    s_bfe_u32 s42, s2, 0x10002
    s_and_b32 s43, s2, 3
    s_lshr_b32 s44, s2, 5
    s_bfe_u32 s45, s2, 0x20003
    s_lshl_b32 s46, s43, 3
    s_lshl_b32 s59, s45, 1
    s_add_u32 s46, s46, s59
    s_bfe_u32 s49, s3, 0x10001
    s_and_b32 s48, s3, 1
    s_cmp_lt_u32 s3, 4
    s_cbranch_scc1 L_F
    s_setprio 1
    v_lshrrev_b32 v1, 3, v0
    s_and_b32 s78, s3, 3
    s_lshl_b32 s59, s78, 3
    v_add_u32 v1, s59, v1
    v_lshrrev_b32 v2, 1, v1
    v_xor_b32 v2, v2, v0
    v_and_b32 v2, 7, v2
    v_lshlrev_b32 v2, 4, v2
    v_lshl_add_u32 v212, v1, 10, v2
    s_lshl_b32 s72, s78, 10
    s_mul_i32 s79, s78, 4352
    v_lshrrev_b32 v1, 4, v0
    v_and_b32 v2, 2, v1
    v_xor_b32 v2, v2, v0
    v_and_b32 v2, 15, v2
    v_lshlrev_b32 v2, 4, v2
    v_lshl_add_u32 v2, v1, 15, v2
    s_lshl_b32 s59, s48, 17
    s_lshl_b32 s78, s49, 8
    s_add_u32 s59, s59, s78
    v_add_u32 v213, s59, v2
    s_lshl_b32 s59, s46, 8
    s_sub_u32 s10, 4194304, s59
    s_mov_b32 s11, 0x20000
    s_mul_i32 s78, s44, 163840
    s_waitcnt lgkmcnt(0)
    s_cmp_eq_u32 s42, 0
    s_cselect_b64 s[16:17], s[16:17], s[26:27]
    s_cselect_b64 s[22:23], s[22:23], s[32:33]
    s_cselect_b64 s[34:35], s[24:25], s[34:35]
    s_add_u32 s8, s22, s59
    s_addc_u32 s9, s23, 0
    s_add_u32 s24, s16, s78
    s_addc_u32 s25, s17, 0
    s_mov_b32 s26, 163840
    s_mov_b32 s27, 0x20000
    s_add_u32 m0, s79, 72704
    s_mov_b32 s16, 0
    buffer_load_dwordx4 v213, s[8:11], s16 offen lds
    s_add_u32 m0, s79, 73792
    s_mov_b32 s16, 8192
    buffer_load_dwordx4 v213, s[8:11], s16 offen lds
    s_add_u32 m0, s79, 74880
    s_mov_b32 s16, 16384
    buffer_load_dwordx4 v213, s[8:11], s16 offen lds
    s_add_u32 m0, s79, 75968
    s_mov_b32 s16, 24576
    buffer_load_dwordx4 v213, s[8:11], s16 offen lds
    s_add_u32 m0, s72, 52224
    s_mov_b32 s16, 0
    buffer_load_dwordx4 v212, s[24:27], s16 offen lds
    s_add_u32 m0, s72, 56320
    s_mov_b32 s16, 32768
    buffer_load_dwordx4 v212, s[24:27], s16 offen lds
    s_add_u32 m0, s72, 60416
    s_mov_b32 s16, 65536
    buffer_load_dwordx4 v212, s[24:27], s16 offen lds
    s_add_u32 m0, s72, 64512
    s_mov_b32 s16, 98304
    buffer_load_dwordx4 v212, s[24:27], s16 offen lds
    s_add_u32 m0, s72, 68608
    s_mov_b32 s16, 131072
    buffer_load_dwordx4 v212, s[24:27], s16 offen lds
    s_add_u32 m0, s79, 90112
    s_mov_b32 s16, 262144
    buffer_load_dwordx4 v213, s[8:11], s16 offen lds
    s_add_u32 m0, s79, 91200
    s_mov_b32 s16, 270336
    buffer_load_dwordx4 v213, s[8:11], s16 offen lds
    s_add_u32 m0, s79, 92288
    s_mov_b32 s16, 278528
    buffer_load_dwordx4 v213, s[8:11], s16 offen lds
    s_add_u32 m0, s79, 93376
    s_mov_b32 s16, 286720
    buffer_load_dwordx4 v213, s[8:11], s16 offen lds
    s_cmp_eq_u32 s42, 0
    s_cselect_b64 s[18:19], s[18:19], s[28:29]
    s_cselect_b64 s[20:21], s[20:21], s[30:31]
    s_mov_b32 s50, 17408
    s_mov_b32 s51, 69632
    s_mov_b32 s52, 104448
    s_mov_b32 s53, 121856
    s_mov_b32 s54, 0
    s_mov_b32 s55, 34816
    s_mov_b32 s56, 52224
    s_mov_b32 s57, 87040
    s_mov_b32 s58, 139264
    s_mov_b32 s61, 0xff800000
    s_mov_b32 s47, 0xff800000
    s_mov_b32 s62, 0x3e0293ee
    s_mov_b32 s63, s62
    s_mul_i32 s77, s48, 2
    s_add_u32 s77, s77, 6
    s_mul_i32 s100, s49, 10
    s_add_u32 s100, s100, s77
    s_lshl_b32 s100, s100, 12
    s_lshl_b32 s59, s44, 5
    s_add_u32 s59, s59, s46
    s_add_u32 s59, s59, s48
    s_lshl_b32 s59, s59, 17
    s_cmp_eq_u32 s49, 0
    s_cselect_b64 s[18:19], s[18:19], s[20:21]
    s_mov_b32 s68, 1088
    s_cselect_b32 s68, 1056, s68
    s_mov_b32 s67, 3328
    s_cselect_b32 s67, 256, s67
    s_mov_b32 s69, 8704
    s_cselect_b32 s69, 8448, s69
    s_mov_b32 s66, 256
    s_mul_i32 s69, s69, s48
    s_add_u32 s4, s18, s59
    s_addc_u32 s5, s19, 0
    s_mov_b32 s6, 131072
    s_mov_b32 s7, 0x20000
    v_lshrrev_b32 v1, 4, v0
    v_lshrrev_b32 v2, 5, v0
    v_xor_b32 v2, v2, v0
    v_and_b32 v2, 15, v2
    v_lshlrev_b32 v2, 4, v2
    v_lshl_add_u32 v202, v1, 11, v2
    s_cmp_eq_u32 s49, 0
    s_cbranch_scc1 L_kpatH
    v_and_b32 v2, 1, v1
    v_lshlrev_b32 v2, 1, v2
    v_xor_b32 v2, v2, v0
    v_and_b32 v2, 15, v2
    v_lshlrev_b32 v2, 4, v2
    v_lshl_add_u32 v202, v1, 10, v2
L_kpatH:
    v_mov_b32 v216, v202
    s_lshl_b32 s59, s42, 3
    s_add_u32 s59, s59, s44
    s_lshl_b32 s78, s59, 4
    s_add_u32 s38, s38, s78
    s_addc_u32 s39, s39, 0
    s_lshl_b32 s59, s59, 11
    s_add_u32 s59, s59, 50331648
    s_add_u32 s20, s40, s59
    s_addc_u32 s21, s41, 0
    s_mov_b32 s22, 2048
    s_mov_b32 s23, 0x20000
    s_lshl_b32 s74, s43, 2
    s_add_u32 s74, s74, s45
    s_lshl_b32 s75, s74, 7
    s_cmp_eq_u32 s49, 0
    s_mov_b32 s64, 0
    s_mov_b32 s73, 16
    s_mov_b32 s71, 8192
    s_mov_b32 s76, -1
    s_lshl_b32 s59, s43, 20
    s_lshl_b32 s78, s45, 8
    s_add_u32 s59, s59, s78
    s_add_u32 s34, s34, s59
    s_addc_u32 s35, s35, 0
    s_lshl_b32 s0, s45, 1
    s_add_u32 s0, s0, s48
    s_lshl_b32 s0, s0, 17
    s_lshl_b32 s1, s44, 1
    s_add_u32 s1, s1, s48
    s_lshl_b32 s1, s1, 16
    s_cmp_eq_u32 s49, 0
    s_mov_b32 s2, 1047808
    s_cselect_b32 s2, 0, s2
    s_mov_b32 s28, s34
    s_mov_b32 s29, s35
    s_mov_b32 s30, 1047808
    s_mov_b32 s31, 0x20000
    v_lshrrev_b32 v1, 4, v0
    v_and_b32 v2, 1, v1
    v_lshlrev_b32 v2, 1, v2
    v_xor_b32 v2, v2, v0
    v_and_b32 v2, 15, v2
    v_lshlrev_b32 v2, 4, v2
    v_lshl_add_u32 v217, v1, 12, v2
    v_lshrrev_b32 v1, 1, v0
    v_and_b32 v2, 1, v0
    v_lshlrev_b32 v2, 7, v2
    v_lshl_add_u32 v214, v1, 10, v2
    v_add_u32 v215, 0x8000, v214
    v_lshrrev_b32 v1, 4, v0
    v_and_b32 v2, 15, v0
    s_lshl_b32 s59, s77, 11
    s_add_u32 s59, s59, 52224
    v_lshrrev_b32 v200, 1, v2
    v_xor_b32 v200, v200, v1
    v_lshlrev_b32 v3, 7, v2
    v_add_u32 v3, s59, v3
    v_xor_b32 v201, 0, v200
    v_lshl_add_u32 v188, v201, 4, v3
    v_add_u32 v190, 72704, v188
    v_xor_b32 v201, 4, v200
    v_lshl_add_u32 v189, v201, 4, v3
    v_add_u32 v191, 72704, v189
    v_and_b32 v3, 7, v2
    v_mul_u32_u24 v3, 1056, v3
    v_lshrrev_b32 v200, 3, v2
    v_lshl_add_u32 v3, v200, 8, v3
    s_mul_i32 s59, s49, 8448
    v_add_u32 v3, s59, v3
    v_lshl_add_u32 v180, v1, 4, v3
    v_xor_b32 v200, 1, v1
    v_lshl_add_u32 v181, v200, 4, v3
    v_add_u32 v181, 512, v181
    v_bfe_u32 v3, v0, 2, 2
    v_mul_u32_u24 v3, 1088, v3
    v_and_b32 v200, 3, v0
    v_lshl_add_u32 v3, v200, 3, v3
    s_mul_i32 s59, s49, 8704
    v_add_u32 v3, s59, v3
    v_and_b32 v200, 1, v1
    v_xor_b32 v201, 1, v200
    v_lshl_add_u32 v2, v1, 8, v3
    v_lshl_add_u32 v182, v200, 5, v2
    v_lshl_add_u32 v183, v201, 5, v2
    v_lshrrev_b32 v2, 1, v1
    v_mul_u32_u24 v2, 4352, v2
    v_add_u32 v2, v2, v3
    v_lshl_add_u32 v2, v200, 9, v2
    v_add_u32 v2, 72704, v2
    v_lshl_add_u32 v192, v200, 5, v2
    v_lshl_add_u32 v193, v201, 5, v2
    v_add_u32 v194, 72704, v192
    v_add_u32 v195, 72704, v193
    s_waitcnt vmcnt(4)
    s_barrier
    ds_read_b128 v[100:103], v188 offset:0
    ds_read_b128 v[104:107], v188 offset:2048
    s_add_u32 m0, s72, 124928
    s_mov_b32 s16, 128
    buffer_load_dwordx4 v212, s[24:27], s16 offen lds
    ds_read_b64_tr_b16 v[68:69], v192 offset:0
    ds_read_b64_tr_b16 v[70:71], v192 offset:256
    s_add_u32 m0, s72, 129024
    s_mov_b32 s16, 32896
    buffer_load_dwordx4 v212, s[24:27], s16 offen lds
    ds_read_b64_tr_b16 v[72:73], v193 offset:0
    ds_read_b64_tr_b16 v[74:75], v193 offset:256
    s_add_u32 m0, s72, 133120
    s_mov_b32 s16, 65664
    buffer_load_dwordx4 v212, s[24:27], s16 offen lds
    ds_read_b64_tr_b16 v[76:77], v192 offset:64
    ds_read_b64_tr_b16 v[78:79], v192 offset:320
    ds_read_b64_tr_b16 v[80:81], v193 offset:64
    ds_read_b64_tr_b16 v[82:83], v193 offset:320
    s_add_u32 m0, s72, 137216
    s_mov_b32 s16, 98432
    buffer_load_dwordx4 v212, s[24:27], s16 offen lds
    ds_read_b64_tr_b16 v[84:85], v192 offset:128
    ds_read_b64_tr_b16 v[86:87], v192 offset:384
    ds_read_b64_tr_b16 v[88:89], v193 offset:128
    ds_read_b64_tr_b16 v[90:91], v193 offset:384
    s_add_u32 m0, s72, 141312
    s_mov_b32 s16, 131200
    buffer_load_dwordx4 v212, s[24:27], s16 offen lds
    ds_read_b64_tr_b16 v[92:93], v192 offset:192
    ds_read_b64_tr_b16 v[94:95], v192 offset:448
    ds_read_b64_tr_b16 v[96:97], v193 offset:192
    ds_read_b64_tr_b16 v[98:99], v193 offset:448
    s_add_u32 m0, s79, 107520
    s_mov_b32 s16, 524288
    buffer_load_dwordx4 v213, s[8:11], s16 offen lds
    s_add_u32 m0, s79, 108608
    s_mov_b32 s16, 532480
    buffer_load_dwordx4 v213, s[8:11], s16 offen lds
    s_add_u32 m0, s79, 109696
    s_mov_b32 s16, 540672
    buffer_load_dwordx4 v213, s[8:11], s16 offen lds
    s_add_u32 m0, s79, 110784
    s_mov_b32 s16, 548864
    buffer_load_dwordx4 v213, s[8:11], s16 offen lds
    s_waitcnt vmcnt(9)
    s_waitcnt lgkmcnt(0)
    s_barrier
    v_mfma_f32_16x16x32_bf16 v[4:7], v[68:71], v[100:103], 0
    ds_read_b128 v[140:143], v189 offset:0
    ds_read_b128 v[144:147], v189 offset:2048
    s_add_u32 m0, s79, 145408
    s_mov_b32 s16, 786432
    buffer_load_dwordx4 v213, s[8:11], s16 offen lds
    v_mfma_f32_16x16x32_bf16 v[36:39], v[68:71], v[104:107], 0
    ds_read_b64_tr_b16 v[108:109], v192 offset:17408
    ds_read_b64_tr_b16 v[110:111], v192 offset:17664
    v_mfma_f32_16x16x32_bf16 v[8:11], v[72:75], v[100:103], 0
    ds_read_b64_tr_b16 v[112:113], v193 offset:17408
    ds_read_b64_tr_b16 v[114:115], v193 offset:17664
    s_add_u32 m0, s79, 146496
    s_mov_b32 s16, 794624
    buffer_load_dwordx4 v213, s[8:11], s16 offen lds
    v_mfma_f32_16x16x32_bf16 v[40:43], v[72:75], v[104:107], 0
    ds_read_b64_tr_b16 v[116:117], v192 offset:17472
    ds_read_b64_tr_b16 v[118:119], v192 offset:17728
    v_mfma_f32_16x16x32_bf16 v[12:15], v[76:79], v[100:103], 0
    ds_read_b64_tr_b16 v[120:121], v193 offset:17472
    ds_read_b64_tr_b16 v[122:123], v193 offset:17728
    s_add_u32 m0, s79, 147584
    s_mov_b32 s16, 802816
    buffer_load_dwordx4 v213, s[8:11], s16 offen lds
    v_mfma_f32_16x16x32_bf16 v[44:47], v[76:79], v[104:107], 0
    ds_read_b64_tr_b16 v[124:125], v192 offset:17536
    ds_read_b64_tr_b16 v[126:127], v192 offset:17792
    v_mfma_f32_16x16x32_bf16 v[16:19], v[80:83], v[100:103], 0
    ds_read_b64_tr_b16 v[128:129], v193 offset:17536
    ds_read_b64_tr_b16 v[130:131], v193 offset:17792
    s_add_u32 m0, s79, 148672
    s_mov_b32 s16, 811008
    buffer_load_dwordx4 v213, s[8:11], s16 offen lds
    v_mfma_f32_16x16x32_bf16 v[48:51], v[80:83], v[104:107], 0
    ds_read_b64_tr_b16 v[132:133], v192 offset:17600
    ds_read_b64_tr_b16 v[134:135], v192 offset:17856
    v_mfma_f32_16x16x32_bf16 v[20:23], v[84:87], v[100:103], 0
    ds_read_b64_tr_b16 v[136:137], v193 offset:17600
    ds_read_b64_tr_b16 v[138:139], v193 offset:17856
    v_mfma_f32_16x16x32_bf16 v[52:55], v[84:87], v[104:107], 0
    v_mfma_f32_16x16x32_bf16 v[24:27], v[88:91], v[100:103], 0
    v_mfma_f32_16x16x32_bf16 v[56:59], v[88:91], v[104:107], 0
    v_mfma_f32_16x16x32_bf16 v[28:31], v[92:95], v[100:103], 0
    v_mfma_f32_16x16x32_bf16 v[60:63], v[92:95], v[104:107], 0
    v_mfma_f32_16x16x32_bf16 v[32:35], v[96:99], v[100:103], 0
    v_mfma_f32_16x16x32_bf16 v[64:67], v[96:99], v[104:107], 0
    s_waitcnt vmcnt(4)
    s_waitcnt lgkmcnt(0)
    s_barrier
    v_mfma_f32_16x16x32_bf16 v[4:7], v[108:111], v[140:143], v[4:7]
    ds_read_b128 v[100:103], v190 offset:0
    ds_read_b128 v[104:107], v190 offset:2048
    s_add_u32 m0, s72, 52224
    s_mov_b32 s16, 256
    buffer_load_dwordx4 v212, s[24:27], s16 offen lds
    v_mfma_f32_16x16x32_bf16 v[36:39], v[108:111], v[144:147], v[36:39]
    ds_read_b64_tr_b16 v[68:69], v192 offset:34816
    ds_read_b64_tr_b16 v[70:71], v192 offset:35072
    s_add_u32 m0, s72, 56320
    s_mov_b32 s16, 33024
    buffer_load_dwordx4 v212, s[24:27], s16 offen lds
    v_mfma_f32_16x16x32_bf16 v[8:11], v[112:115], v[140:143], v[8:11]
    ds_read_b64_tr_b16 v[72:73], v193 offset:34816
    ds_read_b64_tr_b16 v[74:75], v193 offset:35072
    s_add_u32 m0, s72, 60416
    s_mov_b32 s16, 65792
    buffer_load_dwordx4 v212, s[24:27], s16 offen lds
    v_mfma_f32_16x16x32_bf16 v[40:43], v[112:115], v[144:147], v[40:43]
    ds_read_b64_tr_b16 v[76:77], v192 offset:34880
    ds_read_b64_tr_b16 v[78:79], v192 offset:35136
    v_mfma_f32_16x16x32_bf16 v[12:15], v[116:119], v[140:143], v[12:15]
    ds_read_b64_tr_b16 v[80:81], v193 offset:34880
    ds_read_b64_tr_b16 v[82:83], v193 offset:35136
    s_add_u32 m0, s72, 64512
    s_mov_b32 s16, 98560
    buffer_load_dwordx4 v212, s[24:27], s16 offen lds
    v_mfma_f32_16x16x32_bf16 v[44:47], v[116:119], v[144:147], v[44:47]
    ds_read_b64_tr_b16 v[84:85], v192 offset:34944
    ds_read_b64_tr_b16 v[86:87], v192 offset:35200
    v_mfma_f32_16x16x32_bf16 v[16:19], v[120:123], v[140:143], v[16:19]
    ds_read_b64_tr_b16 v[88:89], v193 offset:34944
    ds_read_b64_tr_b16 v[90:91], v193 offset:35200
    s_add_u32 m0, s72, 68608
    s_mov_b32 s16, 131328
    buffer_load_dwordx4 v212, s[24:27], s16 offen lds
    v_mfma_f32_16x16x32_bf16 v[48:51], v[120:123], v[144:147], v[48:51]
    ds_read_b64_tr_b16 v[92:93], v192 offset:35008
    ds_read_b64_tr_b16 v[94:95], v192 offset:35264
    v_mfma_f32_16x16x32_bf16 v[20:23], v[124:127], v[140:143], v[20:23]
    ds_read_b64_tr_b16 v[96:97], v193 offset:35008
    ds_read_b64_tr_b16 v[98:99], v193 offset:35264
    s_add_u32 m0, s79, 72704
    s_mov_b32 s16, 1048576
    buffer_load_dwordx4 v213, s[8:11], s16 offen lds
    v_mfma_f32_16x16x32_bf16 v[52:55], v[124:127], v[144:147], v[52:55]
    v_mfma_f32_16x16x32_bf16 v[24:27], v[128:131], v[140:143], v[24:27]
    s_add_u32 m0, s79, 73792
    s_mov_b32 s16, 1056768
    buffer_load_dwordx4 v213, s[8:11], s16 offen lds
    v_mfma_f32_16x16x32_bf16 v[56:59], v[128:131], v[144:147], v[56:59]
    v_mfma_f32_16x16x32_bf16 v[28:31], v[132:135], v[140:143], v[28:31]
    s_add_u32 m0, s79, 74880
    s_mov_b32 s16, 1064960
    buffer_load_dwordx4 v213, s[8:11], s16 offen lds
    v_mfma_f32_16x16x32_bf16 v[60:63], v[132:135], v[144:147], v[60:63]
    v_mfma_f32_16x16x32_bf16 v[32:35], v[136:139], v[140:143], v[32:35]
    s_add_u32 m0, s79, 75968
    s_mov_b32 s16, 1073152
    buffer_load_dwordx4 v213, s[8:11], s16 offen lds
    v_mfma_f32_16x16x32_bf16 v[64:67], v[136:139], v[144:147], v[64:67]
    s_waitcnt vmcnt(9)
    s_waitcnt lgkmcnt(0)
    s_barrier
    v_mfma_f32_16x16x32_bf16 v[4:7], v[68:71], v[100:103], v[4:7]
    ds_read_b128 v[140:143], v191 offset:0
    ds_read_b128 v[144:147], v191 offset:2048
    s_add_u32 m0, s79, 90112
    s_mov_b32 s16, 1310720
    buffer_load_dwordx4 v213, s[8:11], s16 offen lds
    v_mfma_f32_16x16x32_bf16 v[36:39], v[68:71], v[104:107], v[36:39]
    ds_read_b64_tr_b16 v[108:109], v194 offset:0
    ds_read_b64_tr_b16 v[110:111], v194 offset:256
    v_mfma_f32_16x16x32_bf16 v[8:11], v[72:75], v[100:103], v[8:11]
    ds_read_b64_tr_b16 v[112:113], v195 offset:0
    ds_read_b64_tr_b16 v[114:115], v195 offset:256
    s_add_u32 m0, s79, 91200
    s_mov_b32 s16, 1318912
    buffer_load_dwordx4 v213, s[8:11], s16 offen lds
    v_mfma_f32_16x16x32_bf16 v[40:43], v[72:75], v[104:107], v[40:43]
    ds_read_b64_tr_b16 v[116:117], v194 offset:64
    ds_read_b64_tr_b16 v[118:119], v194 offset:320
    v_mfma_f32_16x16x32_bf16 v[12:15], v[76:79], v[100:103], v[12:15]
    ds_read_b64_tr_b16 v[120:121], v195 offset:64
    ds_read_b64_tr_b16 v[122:123], v195 offset:320
    s_add_u32 m0, s79, 92288
    s_mov_b32 s16, 1327104
    buffer_load_dwordx4 v213, s[8:11], s16 offen lds
    v_mfma_f32_16x16x32_bf16 v[44:47], v[76:79], v[104:107], v[44:47]
    ds_read_b64_tr_b16 v[124:125], v194 offset:128
    ds_read_b64_tr_b16 v[126:127], v194 offset:384
    v_mfma_f32_16x16x32_bf16 v[16:19], v[80:83], v[100:103], v[16:19]
    ds_read_b64_tr_b16 v[128:129], v195 offset:128
    ds_read_b64_tr_b16 v[130:131], v195 offset:384
    s_add_u32 m0, s79, 93376
    s_mov_b32 s16, 1335296
    buffer_load_dwordx4 v213, s[8:11], s16 offen lds
    v_mfma_f32_16x16x32_bf16 v[48:51], v[80:83], v[104:107], v[48:51]
    ds_read_b64_tr_b16 v[132:133], v194 offset:192
    ds_read_b64_tr_b16 v[134:135], v194 offset:448
    v_mfma_f32_16x16x32_bf16 v[20:23], v[84:87], v[100:103], v[20:23]
    ds_read_b64_tr_b16 v[136:137], v195 offset:192
    ds_read_b64_tr_b16 v[138:139], v195 offset:448
    s_add_u32 m0, s79, 107520
    s_mov_b32 s16, 1572864
    buffer_load_dwordx4 v213, s[8:11], s16 offen lds
    v_mfma_f32_16x16x32_bf16 v[52:55], v[84:87], v[104:107], v[52:55]
    v_mfma_f32_16x16x32_bf16 v[24:27], v[88:91], v[100:103], v[24:27]
    s_add_u32 m0, s79, 108608
    s_mov_b32 s16, 1581056
    buffer_load_dwordx4 v213, s[8:11], s16 offen lds
    v_mfma_f32_16x16x32_bf16 v[56:59], v[88:91], v[104:107], v[56:59]
    v_mfma_f32_16x16x32_bf16 v[28:31], v[92:95], v[100:103], v[28:31]
    s_add_u32 m0, s79, 109696
    s_mov_b32 s16, 1589248
    buffer_load_dwordx4 v213, s[8:11], s16 offen lds
    v_mfma_f32_16x16x32_bf16 v[60:63], v[92:95], v[104:107], v[60:63]
    v_mfma_f32_16x16x32_bf16 v[32:35], v[96:99], v[100:103], v[32:35]
    s_add_u32 m0, s79, 110784
    s_mov_b32 s16, 1597440
    buffer_load_dwordx4 v213, s[8:11], s16 offen lds
    v_mfma_f32_16x16x32_bf16 v[64:67], v[96:99], v[104:107], v[64:67]
    s_waitcnt vmcnt(8)
    s_waitcnt lgkmcnt(0)
    s_barrier
    v_mfma_f32_16x16x32_bf16 v[4:7], v[108:111], v[140:143], v[4:7]
    ds_read_b128 v[100:103], v188 offset:0
    ds_read_b128 v[104:107], v188 offset:2048
    s_add_u32 m0, s72, 124928
    s_mov_b32 s16, 384
    buffer_load_dwordx4 v212, s[24:27], s16 offen lds
    v_mfma_f32_16x16x32_bf16 v[36:39], v[108:111], v[144:147], v[36:39]
    ds_read_b64_tr_b16 v[68:69], v192 offset:0
    ds_read_b64_tr_b16 v[70:71], v192 offset:256
    s_add_u32 m0, s72, 129024
    s_mov_b32 s16, 33152
    buffer_load_dwordx4 v212, s[24:27], s16 offen lds
    v_mfma_f32_16x16x32_bf16 v[8:11], v[112:115], v[140:143], v[8:11]
    ds_read_b64_tr_b16 v[72:73], v193 offset:0
    ds_read_b64_tr_b16 v[74:75], v193 offset:256
    s_add_u32 m0, s72, 133120
    s_mov_b32 s16, 65920
    buffer_load_dwordx4 v212, s[24:27], s16 offen lds
    v_mfma_f32_16x16x32_bf16 v[40:43], v[112:115], v[144:147], v[40:43]
    ds_read_b64_tr_b16 v[76:77], v192 offset:64
    ds_read_b64_tr_b16 v[78:79], v192 offset:320
    v_mfma_f32_16x16x32_bf16 v[12:15], v[116:119], v[140:143], v[12:15]
    ds_read_b64_tr_b16 v[80:81], v193 offset:64
    ds_read_b64_tr_b16 v[82:83], v193 offset:320
    s_add_u32 m0, s72, 137216
    s_mov_b32 s16, 98688
    buffer_load_dwordx4 v212, s[24:27], s16 offen lds
    v_mfma_f32_16x16x32_bf16 v[44:47], v[116:119], v[144:147], v[44:47]
    ds_read_b64_tr_b16 v[84:85], v192 offset:128
    ds_read_b64_tr_b16 v[86:87], v192 offset:384
    v_mfma_f32_16x16x32_bf16 v[16:19], v[120:123], v[140:143], v[16:19]
    ds_read_b64_tr_b16 v[88:89], v193 offset:128
    ds_read_b64_tr_b16 v[90:91], v193 offset:384
    s_add_u32 m0, s72, 141312
    s_mov_b32 s16, 131456
    buffer_load_dwordx4 v212, s[24:27], s16 offen lds
    v_mfma_f32_16x16x32_bf16 v[48:51], v[120:123], v[144:147], v[48:51]
    ds_read_b64_tr_b16 v[92:93], v192 offset:192
    ds_read_b64_tr_b16 v[94:95], v192 offset:448
    v_mfma_f32_16x16x32_bf16 v[20:23], v[124:127], v[140:143], v[20:23]
    ds_read_b64_tr_b16 v[96:97], v193 offset:192
    ds_read_b64_tr_b16 v[98:99], v193 offset:448
    s_add_u32 m0, s79, 145408
    s_mov_b32 s16, 1835008
    buffer_load_dwordx4 v213, s[8:11], s16 offen lds
    v_mfma_f32_16x16x32_bf16 v[52:55], v[124:127], v[144:147], v[52:55]
    v_mfma_f32_16x16x32_bf16 v[24:27], v[128:131], v[140:143], v[24:27]
    s_add_u32 m0, s79, 146496
    s_mov_b32 s16, 1843200
    buffer_load_dwordx4 v213, s[8:11], s16 offen lds
    v_mfma_f32_16x16x32_bf16 v[56:59], v[128:131], v[144:147], v[56:59]
    v_mfma_f32_16x16x32_bf16 v[28:31], v[132:135], v[140:143], v[28:31]
    s_add_u32 m0, s79, 147584
    s_mov_b32 s16, 1851392
    buffer_load_dwordx4 v213, s[8:11], s16 offen lds
    v_mfma_f32_16x16x32_bf16 v[60:63], v[132:135], v[144:147], v[60:63]
    v_mfma_f32_16x16x32_bf16 v[32:35], v[136:139], v[140:143], v[32:35]
    s_add_u32 m0, s79, 148672
    s_mov_b32 s16, 1859584
    buffer_load_dwordx4 v213, s[8:11], s16 offen lds
    v_mfma_f32_16x16x32_bf16 v[64:67], v[136:139], v[144:147], v[64:67]
    s_waitcnt vmcnt(13)
    s_waitcnt lgkmcnt(0)
    s_barrier
    v_mfma_f32_16x16x32_bf16 v[4:7], v[68:71], v[100:103], v[4:7]
    ds_read_b128 v[140:143], v189 offset:0
    ds_read_b128 v[144:147], v189 offset:2048
    s_add_u32 m0, s79, 72704
    s_mov_b32 s16, 2097152
    buffer_load_dwordx4 v213, s[8:11], s16 offen lds
    v_mfma_f32_16x16x32_bf16 v[36:39], v[68:71], v[104:107], v[36:39]
    ds_read_b64_tr_b16 v[108:109], v192 offset:17408
    ds_read_b64_tr_b16 v[110:111], v192 offset:17664
    v_mfma_f32_16x16x32_bf16 v[8:11], v[72:75], v[100:103], v[8:11]
    ds_read_b64_tr_b16 v[112:113], v193 offset:17408
    ds_read_b64_tr_b16 v[114:115], v193 offset:17664
    s_add_u32 m0, s79, 73792
    s_mov_b32 s16, 2105344
    buffer_load_dwordx4 v213, s[8:11], s16 offen lds
    v_mfma_f32_16x16x32_bf16 v[40:43], v[72:75], v[104:107], v[40:43]
    ds_read_b64_tr_b16 v[116:117], v192 offset:17472
    ds_read_b64_tr_b16 v[118:119], v192 offset:17728
    v_mfma_f32_16x16x32_bf16 v[12:15], v[76:79], v[100:103], v[12:15]
    ds_read_b64_tr_b16 v[120:121], v193 offset:17472
    ds_read_b64_tr_b16 v[122:123], v193 offset:17728
    s_add_u32 m0, s79, 74880
    s_mov_b32 s16, 2113536
    buffer_load_dwordx4 v213, s[8:11], s16 offen lds
    v_mfma_f32_16x16x32_bf16 v[44:47], v[76:79], v[104:107], v[44:47]
    ds_read_b64_tr_b16 v[124:125], v192 offset:17536
    ds_read_b64_tr_b16 v[126:127], v192 offset:17792
    v_mfma_f32_16x16x32_bf16 v[16:19], v[80:83], v[100:103], v[16:19]
    ds_read_b64_tr_b16 v[128:129], v193 offset:17536
    ds_read_b64_tr_b16 v[130:131], v193 offset:17792
    s_add_u32 m0, s79, 75968
    s_mov_b32 s16, 2121728
    buffer_load_dwordx4 v213, s[8:11], s16 offen lds
    v_mfma_f32_16x16x32_bf16 v[48:51], v[80:83], v[104:107], v[48:51]
    ds_read_b64_tr_b16 v[132:133], v192 offset:17600
    ds_read_b64_tr_b16 v[134:135], v192 offset:17856
    v_mfma_f32_16x16x32_bf16 v[20:23], v[84:87], v[100:103], v[20:23]
    ds_read_b64_tr_b16 v[136:137], v193 offset:17600
    ds_read_b64_tr_b16 v[138:139], v193 offset:17856
    v_mfma_f32_16x16x32_bf16 v[52:55], v[84:87], v[104:107], v[52:55]
    v_mfma_f32_16x16x32_bf16 v[24:27], v[88:91], v[100:103], v[24:27]
    v_mfma_f32_16x16x32_bf16 v[56:59], v[88:91], v[104:107], v[56:59]
    v_mfma_f32_16x16x32_bf16 v[28:31], v[92:95], v[100:103], v[28:31]
    v_mfma_f32_16x16x32_bf16 v[60:63], v[92:95], v[104:107], v[60:63]
    v_mfma_f32_16x16x32_bf16 v[32:35], v[96:99], v[100:103], v[32:35]
    v_mfma_f32_16x16x32_bf16 v[64:67], v[96:99], v[104:107], v[64:67]
    s_waitcnt vmcnt(8)
    s_waitcnt lgkmcnt(0)
    s_barrier
    v_mfma_f32_16x16x32_bf16 v[4:7], v[108:111], v[140:143], v[4:7]
    ds_read_b128 v[100:103], v190 offset:0
    ds_read_b128 v[104:107], v190 offset:2048
    s_add_u32 m0, s72, 52224
    s_mov_b32 s16, 512
    buffer_load_dwordx4 v212, s[24:27], s16 offen lds
    v_mfma_f32_16x16x32_bf16 v[36:39], v[108:111], v[144:147], v[36:39]
    ds_read_b64_tr_b16 v[68:69], v192 offset:34816
    ds_read_b64_tr_b16 v[70:71], v192 offset:35072
    s_add_u32 m0, s72, 56320
    s_mov_b32 s16, 33280
    buffer_load_dwordx4 v212, s[24:27], s16 offen lds
    v_mfma_f32_16x16x32_bf16 v[8:11], v[112:115], v[140:143], v[8:11]
    ds_read_b64_tr_b16 v[72:73], v193 offset:34816
    ds_read_b64_tr_b16 v[74:75], v193 offset:35072
    s_add_u32 m0, s72, 60416
    s_mov_b32 s16, 66048
    buffer_load_dwordx4 v212, s[24:27], s16 offen lds
    v_mfma_f32_16x16x32_bf16 v[40:43], v[112:115], v[144:147], v[40:43]
    ds_read_b64_tr_b16 v[76:77], v192 offset:34880
    ds_read_b64_tr_b16 v[78:79], v192 offset:35136
    v_mfma_f32_16x16x32_bf16 v[12:15], v[116:119], v[140:143], v[12:15]
    ds_read_b64_tr_b16 v[80:81], v193 offset:34880
    ds_read_b64_tr_b16 v[82:83], v193 offset:35136
    s_add_u32 m0, s72, 64512
    s_mov_b32 s16, 98816
    buffer_load_dwordx4 v212, s[24:27], s16 offen lds
    v_mfma_f32_16x16x32_bf16 v[44:47], v[116:119], v[144:147], v[44:47]
    ds_read_b64_tr_b16 v[84:85], v192 offset:34944
    ds_read_b64_tr_b16 v[86:87], v192 offset:35200
    v_mfma_f32_16x16x32_bf16 v[16:19], v[120:123], v[140:143], v[16:19]
    ds_read_b64_tr_b16 v[88:89], v193 offset:34944
    ds_read_b64_tr_b16 v[90:91], v193 offset:35200
    s_add_u32 m0, s72, 68608
    s_mov_b32 s16, 131584
    buffer_load_dwordx4 v212, s[24:27], s16 offen lds
    v_mfma_f32_16x16x32_bf16 v[48:51], v[120:123], v[144:147], v[48:51]
    ds_read_b64_tr_b16 v[92:93], v192 offset:35008
    ds_read_b64_tr_b16 v[94:95], v192 offset:35264
    v_mfma_f32_16x16x32_bf16 v[20:23], v[124:127], v[140:143], v[20:23]
    ds_read_b64_tr_b16 v[96:97], v193 offset:35008
    ds_read_b64_tr_b16 v[98:99], v193 offset:35264
    s_add_u32 m0, s79, 90112
    s_mov_b32 s16, 2359296
    buffer_load_dwordx4 v213, s[8:11], s16 offen lds
    v_mfma_f32_16x16x32_bf16 v[52:55], v[124:127], v[144:147], v[52:55]
    v_mfma_f32_16x16x32_bf16 v[24:27], v[128:131], v[140:143], v[24:27]
    s_add_u32 m0, s79, 91200
    s_mov_b32 s16, 2367488
    buffer_load_dwordx4 v213, s[8:11], s16 offen lds
    v_mfma_f32_16x16x32_bf16 v[56:59], v[128:131], v[144:147], v[56:59]
    v_mfma_f32_16x16x32_bf16 v[28:31], v[132:135], v[140:143], v[28:31]
    s_add_u32 m0, s79, 92288
    s_mov_b32 s16, 2375680
    buffer_load_dwordx4 v213, s[8:11], s16 offen lds
    v_mfma_f32_16x16x32_bf16 v[60:63], v[132:135], v[144:147], v[60:63]
    v_mfma_f32_16x16x32_bf16 v[32:35], v[136:139], v[140:143], v[32:35]
    s_add_u32 m0, s79, 93376
    s_mov_b32 s16, 2383872
    buffer_load_dwordx4 v213, s[8:11], s16 offen lds
    v_mfma_f32_16x16x32_bf16 v[64:67], v[136:139], v[144:147], v[64:67]
    s_waitcnt vmcnt(13)
    s_waitcnt lgkmcnt(0)
    s_barrier
    v_mfma_f32_16x16x32_bf16 v[4:7], v[68:71], v[100:103], v[4:7]
    ds_read_b128 v[140:143], v191 offset:0
    ds_read_b128 v[144:147], v191 offset:2048
    s_add_u32 m0, s79, 107520
    s_mov_b32 s16, 2621440
    buffer_load_dwordx4 v213, s[8:11], s16 offen lds
    v_mfma_f32_16x16x32_bf16 v[36:39], v[68:71], v[104:107], v[36:39]
    ds_read_b64_tr_b16 v[108:109], v194 offset:0
    ds_read_b64_tr_b16 v[110:111], v194 offset:256
    v_mfma_f32_16x16x32_bf16 v[8:11], v[72:75], v[100:103], v[8:11]
    ds_read_b64_tr_b16 v[112:113], v195 offset:0
    ds_read_b64_tr_b16 v[114:115], v195 offset:256
    s_add_u32 m0, s79, 108608
    s_mov_b32 s16, 2629632
    buffer_load_dwordx4 v213, s[8:11], s16 offen lds
    v_mfma_f32_16x16x32_bf16 v[40:43], v[72:75], v[104:107], v[40:43]
    ds_read_b64_tr_b16 v[116:117], v194 offset:64
    ds_read_b64_tr_b16 v[118:119], v194 offset:320
    v_mfma_f32_16x16x32_bf16 v[12:15], v[76:79], v[100:103], v[12:15]
    ds_read_b64_tr_b16 v[120:121], v195 offset:64
    ds_read_b64_tr_b16 v[122:123], v195 offset:320
    s_add_u32 m0, s79, 109696
    s_mov_b32 s16, 2637824
    buffer_load_dwordx4 v213, s[8:11], s16 offen lds
    v_mfma_f32_16x16x32_bf16 v[44:47], v[76:79], v[104:107], v[44:47]
    ds_read_b64_tr_b16 v[124:125], v194 offset:128
    ds_read_b64_tr_b16 v[126:127], v194 offset:384
    v_mfma_f32_16x16x32_bf16 v[16:19], v[80:83], v[100:103], v[16:19]
    ds_read_b64_tr_b16 v[128:129], v195 offset:128
    ds_read_b64_tr_b16 v[130:131], v195 offset:384
    s_add_u32 m0, s79, 110784
    s_mov_b32 s16, 2646016
    buffer_load_dwordx4 v213, s[8:11], s16 offen lds
    v_mfma_f32_16x16x32_bf16 v[48:51], v[80:83], v[104:107], v[48:51]
    ds_read_b64_tr_b16 v[132:133], v194 offset:192
    ds_read_b64_tr_b16 v[134:135], v194 offset:448
    v_mfma_f32_16x16x32_bf16 v[20:23], v[84:87], v[100:103], v[20:23]
    ds_read_b64_tr_b16 v[136:137], v195 offset:192
    ds_read_b64_tr_b16 v[138:139], v195 offset:448
    v_mfma_f32_16x16x32_bf16 v[52:55], v[84:87], v[104:107], v[52:55]
    v_mfma_f32_16x16x32_bf16 v[24:27], v[88:91], v[100:103], v[24:27]
    v_mfma_f32_16x16x32_bf16 v[56:59], v[88:91], v[104:107], v[56:59]
    v_mfma_f32_16x16x32_bf16 v[28:31], v[92:95], v[100:103], v[28:31]
    v_mfma_f32_16x16x32_bf16 v[60:63], v[92:95], v[104:107], v[60:63]
    v_mfma_f32_16x16x32_bf16 v[32:35], v[96:99], v[100:103], v[32:35]
    v_mfma_f32_16x16x32_bf16 v[64:67], v[96:99], v[104:107], v[64:67]
    s_waitcnt vmcnt(8)
    s_waitcnt lgkmcnt(0)
    s_barrier
    v_mfma_f32_16x16x32_bf16 v[4:7], v[108:111], v[140:143], v[4:7]
    ds_read_b128 v[100:103], v188 offset:0
    ds_read_b128 v[104:107], v188 offset:2048
    s_add_u32 m0, s72, 124928
    s_mov_b32 s16, 640
    buffer_load_dwordx4 v212, s[24:27], s16 offen lds
    v_mfma_f32_16x16x32_bf16 v[36:39], v[108:111], v[144:147], v[36:39]
    ds_read_b64_tr_b16 v[68:69], v192 offset:0
    ds_read_b64_tr_b16 v[70:71], v192 offset:256
    s_add_u32 m0, s72, 129024
    s_mov_b32 s16, 33408
    buffer_load_dwordx4 v212, s[24:27], s16 offen lds
    v_mfma_f32_16x16x32_bf16 v[8:11], v[112:115], v[140:143], v[8:11]
    ds_read_b64_tr_b16 v[72:73], v193 offset:0
    ds_read_b64_tr_b16 v[74:75], v193 offset:256
    s_add_u32 m0, s72, 133120
    s_mov_b32 s16, 66176
    buffer_load_dwordx4 v212, s[24:27], s16 offen lds
    v_mfma_f32_16x16x32_bf16 v[40:43], v[112:115], v[144:147], v[40:43]
    ds_read_b64_tr_b16 v[76:77], v192 offset:64
    ds_read_b64_tr_b16 v[78:79], v192 offset:320
    v_mfma_f32_16x16x32_bf16 v[12:15], v[116:119], v[140:143], v[12:15]
    ds_read_b64_tr_b16 v[80:81], v193 offset:64
    ds_read_b64_tr_b16 v[82:83], v193 offset:320
    s_add_u32 m0, s72, 137216
    s_mov_b32 s16, 98944
    buffer_load_dwordx4 v212, s[24:27], s16 offen lds
    v_mfma_f32_16x16x32_bf16 v[44:47], v[116:119], v[144:147], v[44:47]
    ds_read_b64_tr_b16 v[84:85], v192 offset:128
    ds_read_b64_tr_b16 v[86:87], v192 offset:384
    v_mfma_f32_16x16x32_bf16 v[16:19], v[120:123], v[140:143], v[16:19]
    ds_read_b64_tr_b16 v[88:89], v193 offset:128
    ds_read_b64_tr_b16 v[90:91], v193 offset:384
    s_add_u32 m0, s72, 141312
    s_mov_b32 s16, 131712
    buffer_load_dwordx4 v212, s[24:27], s16 offen lds
    v_mfma_f32_16x16x32_bf16 v[48:51], v[120:123], v[144:147], v[48:51]
    ds_read_b64_tr_b16 v[92:93], v192 offset:192
    ds_read_b64_tr_b16 v[94:95], v192 offset:448
    v_mfma_f32_16x16x32_bf16 v[20:23], v[124:127], v[140:143], v[20:23]
    ds_read_b64_tr_b16 v[96:97], v193 offset:192
    ds_read_b64_tr_b16 v[98:99], v193 offset:448
    s_add_u32 m0, s79, 145408
    s_mov_b32 s16, 2883584
    buffer_load_dwordx4 v213, s[8:11], s16 offen lds
    v_mfma_f32_16x16x32_bf16 v[52:55], v[124:127], v[144:147], v[52:55]
    v_mfma_f32_16x16x32_bf16 v[24:27], v[128:131], v[140:143], v[24:27]
    s_add_u32 m0, s79, 146496
    s_mov_b32 s16, 2891776
    buffer_load_dwordx4 v213, s[8:11], s16 offen lds
    v_mfma_f32_16x16x32_bf16 v[56:59], v[128:131], v[144:147], v[56:59]
    v_mfma_f32_16x16x32_bf16 v[28:31], v[132:135], v[140:143], v[28:31]
    s_add_u32 m0, s79, 147584
    s_mov_b32 s16, 2899968
    buffer_load_dwordx4 v213, s[8:11], s16 offen lds
    v_mfma_f32_16x16x32_bf16 v[60:63], v[132:135], v[144:147], v[60:63]
    v_mfma_f32_16x16x32_bf16 v[32:35], v[136:139], v[140:143], v[32:35]
    s_add_u32 m0, s79, 148672
    s_mov_b32 s16, 2908160
    buffer_load_dwordx4 v213, s[8:11], s16 offen lds
    v_mfma_f32_16x16x32_bf16 v[64:67], v[136:139], v[144:147], v[64:67]
    s_waitcnt vmcnt(13)
    s_waitcnt lgkmcnt(0)
    s_barrier
    v_mfma_f32_16x16x32_bf16 v[4:7], v[68:71], v[100:103], v[4:7]
    ds_read_b128 v[140:143], v189 offset:0
    ds_read_b128 v[144:147], v189 offset:2048
    s_add_u32 m0, s79, 72704
    s_mov_b32 s16, 3145728
    buffer_load_dwordx4 v213, s[8:11], s16 offen lds
    v_mfma_f32_16x16x32_bf16 v[36:39], v[68:71], v[104:107], v[36:39]
    ds_read_b64_tr_b16 v[108:109], v192 offset:17408
    ds_read_b64_tr_b16 v[110:111], v192 offset:17664
    v_mfma_f32_16x16x32_bf16 v[8:11], v[72:75], v[100:103], v[8:11]
    ds_read_b64_tr_b16 v[112:113], v193 offset:17408
    ds_read_b64_tr_b16 v[114:115], v193 offset:17664
    s_add_u32 m0, s79, 73792
    s_mov_b32 s16, 3153920
    buffer_load_dwordx4 v213, s[8:11], s16 offen lds
    v_mfma_f32_16x16x32_bf16 v[40:43], v[72:75], v[104:107], v[40:43]
    ds_read_b64_tr_b16 v[116:117], v192 offset:17472
    ds_read_b64_tr_b16 v[118:119], v192 offset:17728
    v_mfma_f32_16x16x32_bf16 v[12:15], v[76:79], v[100:103], v[12:15]
    ds_read_b64_tr_b16 v[120:121], v193 offset:17472
    ds_read_b64_tr_b16 v[122:123], v193 offset:17728
    s_add_u32 m0, s79, 74880
    s_mov_b32 s16, 3162112
    buffer_load_dwordx4 v213, s[8:11], s16 offen lds
    v_mfma_f32_16x16x32_bf16 v[44:47], v[76:79], v[104:107], v[44:47]
    ds_read_b64_tr_b16 v[124:125], v192 offset:17536
    ds_read_b64_tr_b16 v[126:127], v192 offset:17792
    v_mfma_f32_16x16x32_bf16 v[16:19], v[80:83], v[100:103], v[16:19]
    ds_read_b64_tr_b16 v[128:129], v193 offset:17536
    ds_read_b64_tr_b16 v[130:131], v193 offset:17792
    s_add_u32 m0, s79, 75968
    s_mov_b32 s16, 3170304
    buffer_load_dwordx4 v213, s[8:11], s16 offen lds
    v_mfma_f32_16x16x32_bf16 v[48:51], v[80:83], v[104:107], v[48:51]
    ds_read_b64_tr_b16 v[132:133], v192 offset:17600
    ds_read_b64_tr_b16 v[134:135], v192 offset:17856
    v_mfma_f32_16x16x32_bf16 v[20:23], v[84:87], v[100:103], v[20:23]
    ds_read_b64_tr_b16 v[136:137], v193 offset:17600
    ds_read_b64_tr_b16 v[138:139], v193 offset:17856
    v_mfma_f32_16x16x32_bf16 v[52:55], v[84:87], v[104:107], v[52:55]
    v_mfma_f32_16x16x32_bf16 v[24:27], v[88:91], v[100:103], v[24:27]
    v_mfma_f32_16x16x32_bf16 v[56:59], v[88:91], v[104:107], v[56:59]
    v_mfma_f32_16x16x32_bf16 v[28:31], v[92:95], v[100:103], v[28:31]
    v_mfma_f32_16x16x32_bf16 v[60:63], v[92:95], v[104:107], v[60:63]
    v_mfma_f32_16x16x32_bf16 v[32:35], v[96:99], v[100:103], v[32:35]
    v_mfma_f32_16x16x32_bf16 v[64:67], v[96:99], v[104:107], v[64:67]
    s_waitcnt vmcnt(8)
    s_waitcnt lgkmcnt(0)
    s_barrier
    v_mfma_f32_16x16x32_bf16 v[4:7], v[108:111], v[140:143], v[4:7]
    ds_read_b128 v[100:103], v190 offset:0
    ds_read_b128 v[104:107], v190 offset:2048
    s_add_u32 m0, s72, 52224
    s_mov_b32 s16, 768
    buffer_load_dwordx4 v212, s[24:27], s16 offen lds
    v_mfma_f32_16x16x32_bf16 v[36:39], v[108:111], v[144:147], v[36:39]
    ds_read_b64_tr_b16 v[68:69], v192 offset:34816
    ds_read_b64_tr_b16 v[70:71], v192 offset:35072
    s_add_u32 m0, s72, 56320
    s_mov_b32 s16, 33536
    buffer_load_dwordx4 v212, s[24:27], s16 offen lds
    v_mfma_f32_16x16x32_bf16 v[8:11], v[112:115], v[140:143], v[8:11]
    ds_read_b64_tr_b16 v[72:73], v193 offset:34816
    ds_read_b64_tr_b16 v[74:75], v193 offset:35072
    s_add_u32 m0, s72, 60416
    s_mov_b32 s16, 66304
    buffer_load_dwordx4 v212, s[24:27], s16 offen lds
    v_mfma_f32_16x16x32_bf16 v[40:43], v[112:115], v[144:147], v[40:43]
    ds_read_b64_tr_b16 v[76:77], v192 offset:34880
    ds_read_b64_tr_b16 v[78:79], v192 offset:35136
    s_add_u32 m0, s72, 64512
    s_mov_b32 s16, 99072
    buffer_load_dwordx4 v212, s[24:27], s16 offen lds
    v_mfma_f32_16x16x32_bf16 v[12:15], v[116:119], v[140:143], v[12:15]
    ds_read_b64_tr_b16 v[80:81], v193 offset:34880
    ds_read_b64_tr_b16 v[82:83], v193 offset:35136
    s_add_u32 m0, s72, 68608
    s_mov_b32 s16, 131840
    buffer_load_dwordx4 v212, s[24:27], s16 offen lds
    v_mfma_f32_16x16x32_bf16 v[44:47], v[116:119], v[144:147], v[44:47]
    ds_read_b64_tr_b16 v[84:85], v192 offset:34944
    ds_read_b64_tr_b16 v[86:87], v192 offset:35200
    s_add_u32 m0, s79, 90112
    s_mov_b32 s16, 3407872
    buffer_load_dwordx4 v213, s[8:11], s16 offen lds
    v_mfma_f32_16x16x32_bf16 v[16:19], v[120:123], v[140:143], v[16:19]
    ds_read_b64_tr_b16 v[88:89], v193 offset:34944
    ds_read_b64_tr_b16 v[90:91], v193 offset:35200
    s_add_u32 m0, s79, 91200
    s_mov_b32 s16, 3416064
    buffer_load_dwordx4 v213, s[8:11], s16 offen lds
    v_mfma_f32_16x16x32_bf16 v[48:51], v[120:123], v[144:147], v[48:51]
    ds_read_b64_tr_b16 v[92:93], v192 offset:35008
    ds_read_b64_tr_b16 v[94:95], v192 offset:35264
    v_mfma_f32_16x16x32_bf16 v[20:23], v[124:127], v[140:143], v[20:23]
    ds_read_b64_tr_b16 v[96:97], v193 offset:35008
    ds_read_b64_tr_b16 v[98:99], v193 offset:35264
    s_add_u32 m0, s79, 92288
    s_mov_b32 s16, 3424256
    buffer_load_dwordx4 v213, s[8:11], s16 offen lds
    v_mfma_f32_16x16x32_bf16 v[52:55], v[124:127], v[144:147], v[52:55]
    v_mfma_f32_16x16x32_bf16 v[24:27], v[128:131], v[140:143], v[24:27]
    s_add_u32 m0, s79, 93376
    s_mov_b32 s16, 3432448
    buffer_load_dwordx4 v213, s[8:11], s16 offen lds
    v_mfma_f32_16x16x32_bf16 v[56:59], v[128:131], v[144:147], v[56:59]
    v_mfma_f32_16x16x32_bf16 v[28:31], v[132:135], v[140:143], v[28:31]
    s_cmp_eq_u32 s49, 0
    s_mov_b32 s70, 34816
    s_cselect_b32 s70, 0, s70
    s_add_u32 s70, s70, s69
    s_mov_b32 s65, s64
    s_sub_u32 s59, 1, s49
    s_sub_u32 s73, s73, s59
    s_lshl_b32 s59, s59, 13
    s_add_u32 s64, s64, s59
    s_add_u32 s64, s64, 8192
    s_sub_u32 s73, s73, 1
    s_mov_b32 m0, s70
    s_nop 0
    buffer_load_dwordx4 v202, s[4:7], s65 offen nt lds
    v_mfma_f32_16x16x32_bf16 v[60:63], v[132:135], v[144:147], v[60:63]
    v_mfma_f32_16x16x32_bf16 v[32:35], v[136:139], v[140:143], v[32:35]
    s_add_u32 s70, s70, s68
    s_mov_b32 m0, s70
    s_add_u32 s65, s65, s66
    buffer_load_dwordx4 v202, s[4:7], s65 offen nt lds
    v_mfma_f32_16x16x32_bf16 v[64:67], v[136:139], v[144:147], v[64:67]
    s_waitcnt vmcnt(15)
    s_waitcnt lgkmcnt(0)
    s_barrier
    v_mfma_f32_16x16x32_bf16 v[4:7], v[68:71], v[100:103], v[4:7]
    ds_read_b128 v[140:143], v191 offset:0
    ds_read_b128 v[144:147], v191 offset:2048
    s_add_u32 m0, s79, 107520
    s_mov_b32 s16, 3670016
    buffer_load_dwordx4 v213, s[8:11], s16 offen lds
    v_mfma_f32_16x16x32_bf16 v[36:39], v[68:71], v[104:107], v[36:39]
    ds_read_b64_tr_b16 v[108:109], v194 offset:0
    ds_read_b64_tr_b16 v[110:111], v194 offset:256
    v_mfma_f32_16x16x32_bf16 v[8:11], v[72:75], v[100:103], v[8:11]
    ds_read_b64_tr_b16 v[112:113], v195 offset:0
    ds_read_b64_tr_b16 v[114:115], v195 offset:256
    s_add_u32 m0, s79, 108608
    s_mov_b32 s16, 3678208
    buffer_load_dwordx4 v213, s[8:11], s16 offen lds
    v_mfma_f32_16x16x32_bf16 v[40:43], v[72:75], v[104:107], v[40:43]
    ds_read_b64_tr_b16 v[116:117], v194 offset:64
    ds_read_b64_tr_b16 v[118:119], v194 offset:320
    v_mfma_f32_16x16x32_bf16 v[12:15], v[76:79], v[100:103], v[12:15]
    ds_read_b64_tr_b16 v[120:121], v195 offset:64
    ds_read_b64_tr_b16 v[122:123], v195 offset:320
    s_add_u32 m0, s79, 109696
    s_mov_b32 s16, 3686400
    buffer_load_dwordx4 v213, s[8:11], s16 offen lds
    v_mfma_f32_16x16x32_bf16 v[44:47], v[76:79], v[104:107], v[44:47]
    ds_read_b64_tr_b16 v[124:125], v194 offset:128
    ds_read_b64_tr_b16 v[126:127], v194 offset:384
    v_mfma_f32_16x16x32_bf16 v[16:19], v[80:83], v[100:103], v[16:19]
    ds_read_b64_tr_b16 v[128:129], v195 offset:128
    ds_read_b64_tr_b16 v[130:131], v195 offset:384
    s_add_u32 m0, s79, 110784
    s_mov_b32 s16, 3694592
    buffer_load_dwordx4 v213, s[8:11], s16 offen lds
    v_mfma_f32_16x16x32_bf16 v[48:51], v[80:83], v[104:107], v[48:51]
    ds_read_b64_tr_b16 v[132:133], v194 offset:192
    ds_read_b64_tr_b16 v[134:135], v194 offset:448
    v_mfma_f32_16x16x32_bf16 v[20:23], v[84:87], v[100:103], v[20:23]
    ds_read_b64_tr_b16 v[136:137], v195 offset:192
    ds_read_b64_tr_b16 v[138:139], v195 offset:448
    s_add_u32 s70, s70, s68
    s_mov_b32 m0, s70
    s_add_u32 s65, s65, s66
    buffer_load_dwordx4 v202, s[4:7], s65 offen nt lds
    v_mfma_f32_16x16x32_bf16 v[52:55], v[84:87], v[104:107], v[52:55]
    v_mfma_f32_16x16x32_bf16 v[24:27], v[88:91], v[100:103], v[24:27]
    s_add_u32 s70, s70, s68
    s_mov_b32 m0, s70
    s_add_u32 s65, s65, s66
    buffer_load_dwordx4 v202, s[4:7], s65 offen nt lds
    v_mfma_f32_16x16x32_bf16 v[56:59], v[88:91], v[104:107], v[56:59]
    v_mfma_f32_16x16x32_bf16 v[28:31], v[92:95], v[100:103], v[28:31]
    v_mfma_f32_16x16x32_bf16 v[60:63], v[92:95], v[104:107], v[60:63]
    v_mfma_f32_16x16x32_bf16 v[32:35], v[96:99], v[100:103], v[32:35]
    v_mfma_f32_16x16x32_bf16 v[64:67], v[96:99], v[104:107], v[64:67]
    s_waitcnt vmcnt(12)
    s_waitcnt lgkmcnt(0)
    s_barrier
    v_mfma_f32_16x16x32_bf16 v[4:7], v[108:111], v[140:143], v[4:7]
    ds_read_b128 v[100:103], v188 offset:0
    ds_read_b128 v[104:107], v188 offset:2048
    s_add_u32 m0, s72, 124928
    s_mov_b32 s16, 896
    buffer_load_dwordx4 v212, s[24:27], s16 offen lds
    v_mfma_f32_16x16x32_bf16 v[36:39], v[108:111], v[144:147], v[36:39]
    ds_read_b64_tr_b16 v[68:69], v192 offset:0
    ds_read_b64_tr_b16 v[70:71], v192 offset:256
    s_add_u32 m0, s72, 129024
    s_mov_b32 s16, 33664
    buffer_load_dwordx4 v212, s[24:27], s16 offen lds
    v_mfma_f32_16x16x32_bf16 v[8:11], v[112:115], v[140:143], v[8:11]
    ds_read_b64_tr_b16 v[72:73], v193 offset:0
    ds_read_b64_tr_b16 v[74:75], v193 offset:256
    s_add_u32 m0, s72, 133120
    s_mov_b32 s16, 66432
    buffer_load_dwordx4 v212, s[24:27], s16 offen lds
    v_mfma_f32_16x16x32_bf16 v[40:43], v[112:115], v[144:147], v[40:43]
    ds_read_b64_tr_b16 v[76:77], v192 offset:64
    ds_read_b64_tr_b16 v[78:79], v192 offset:320
    s_add_u32 m0, s72, 137216
    s_mov_b32 s16, 99200
    buffer_load_dwordx4 v212, s[24:27], s16 offen lds
    v_mfma_f32_16x16x32_bf16 v[12:15], v[116:119], v[140:143], v[12:15]
    ds_read_b64_tr_b16 v[80:81], v193 offset:64
    ds_read_b64_tr_b16 v[82:83], v193 offset:320
    s_add_u32 m0, s72, 141312
    s_mov_b32 s16, 131968
    buffer_load_dwordx4 v212, s[24:27], s16 offen lds
    v_mfma_f32_16x16x32_bf16 v[44:47], v[116:119], v[144:147], v[44:47]
    ds_read_b64_tr_b16 v[84:85], v192 offset:128
    ds_read_b64_tr_b16 v[86:87], v192 offset:384
    s_add_u32 m0, s79, 145408
    s_mov_b32 s16, 3932160
    buffer_load_dwordx4 v213, s[8:11], s16 offen lds
    v_mfma_f32_16x16x32_bf16 v[16:19], v[120:123], v[140:143], v[16:19]
    ds_read_b64_tr_b16 v[88:89], v193 offset:128
    ds_read_b64_tr_b16 v[90:91], v193 offset:384
    s_add_u32 m0, s79, 146496
    s_mov_b32 s16, 3940352
    buffer_load_dwordx4 v213, s[8:11], s16 offen lds
    v_mfma_f32_16x16x32_bf16 v[48:51], v[120:123], v[144:147], v[48:51]
    ds_read_b64_tr_b16 v[92:93], v192 offset:192
    ds_read_b64_tr_b16 v[94:95], v192 offset:448
    v_mfma_f32_16x16x32_bf16 v[20:23], v[124:127], v[140:143], v[20:23]
    ds_read_b64_tr_b16 v[96:97], v193 offset:192
    ds_read_b64_tr_b16 v[98:99], v193 offset:448
    s_add_u32 m0, s79, 147584
    s_mov_b32 s16, 3948544
    buffer_load_dwordx4 v213, s[8:11], s16 offen lds
    v_mfma_f32_16x16x32_bf16 v[52:55], v[124:127], v[144:147], v[52:55]
    v_mfma_f32_16x16x32_bf16 v[24:27], v[128:131], v[140:143], v[24:27]
    s_add_u32 m0, s79, 148672
    s_mov_b32 s16, 3956736
    buffer_load_dwordx4 v213, s[8:11], s16 offen lds
    v_mfma_f32_16x16x32_bf16 v[56:59], v[128:131], v[144:147], v[56:59]
    v_mfma_f32_16x16x32_bf16 v[28:31], v[132:135], v[140:143], v[28:31]
    s_add_u32 s70, s70, s68
    s_mov_b32 m0, s70
    s_add_u32 s65, s65, s67
    buffer_load_dwordx4 v202, s[4:7], s65 offen nt lds
    v_mfma_f32_16x16x32_bf16 v[60:63], v[132:135], v[144:147], v[60:63]
    v_mfma_f32_16x16x32_bf16 v[32:35], v[136:139], v[140:143], v[32:35]
    s_add_u32 s70, s70, s68
    s_mov_b32 m0, s70
    s_add_u32 s65, s65, s66
    buffer_load_dwordx4 v202, s[4:7], s65 offen nt lds
    v_mfma_f32_16x16x32_bf16 v[64:67], v[136:139], v[144:147], v[64:67]
    s_waitcnt vmcnt(19)
    s_waitcnt lgkmcnt(0)
    s_barrier
    v_mfma_f32_16x16x32_bf16 v[4:7], v[68:71], v[100:103], v[4:7]
    ds_read_b128 v[140:143], v189 offset:0
    ds_read_b128 v[144:147], v189 offset:2048
    s_add_u32 s70, s70, s68
    s_mov_b32 m0, s70
    s_add_u32 s65, s65, s66
    buffer_load_dwordx4 v202, s[4:7], s65 offen nt lds
    v_mfma_f32_16x16x32_bf16 v[36:39], v[68:71], v[104:107], v[36:39]
    ds_read_b64_tr_b16 v[108:109], v192 offset:17408
    ds_read_b64_tr_b16 v[110:111], v192 offset:17664
    v_mfma_f32_16x16x32_bf16 v[8:11], v[72:75], v[100:103], v[8:11]
    ds_read_b64_tr_b16 v[112:113], v193 offset:17408
    ds_read_b64_tr_b16 v[114:115], v193 offset:17664
    s_add_u32 s70, s70, s68
    s_mov_b32 m0, s70
    s_add_u32 s65, s65, s66
    buffer_load_dwordx4 v202, s[4:7], s65 offen nt lds
    v_mfma_f32_16x16x32_bf16 v[40:43], v[72:75], v[104:107], v[40:43]
    ds_read_b64_tr_b16 v[116:117], v192 offset:17472
    ds_read_b64_tr_b16 v[118:119], v192 offset:17728
    v_mfma_f32_16x16x32_bf16 v[12:15], v[76:79], v[100:103], v[12:15]
    ds_read_b64_tr_b16 v[120:121], v193 offset:17472
    ds_read_b64_tr_b16 v[122:123], v193 offset:17728
    v_mfma_f32_16x16x32_bf16 v[44:47], v[76:79], v[104:107], v[44:47]
    ds_read_b64_tr_b16 v[124:125], v192 offset:17536
    ds_read_b64_tr_b16 v[126:127], v192 offset:17792
    v_mfma_f32_16x16x32_bf16 v[16:19], v[80:83], v[100:103], v[16:19]
    ds_read_b64_tr_b16 v[128:129], v193 offset:17536
    ds_read_b64_tr_b16 v[130:131], v193 offset:17792
    v_mfma_f32_16x16x32_bf16 v[48:51], v[80:83], v[104:107], v[48:51]
    ds_read_b64_tr_b16 v[132:133], v192 offset:17600
    ds_read_b64_tr_b16 v[134:135], v192 offset:17856
    v_mfma_f32_16x16x32_bf16 v[20:23], v[84:87], v[100:103], v[20:23]
    ds_read_b64_tr_b16 v[136:137], v193 offset:17600
    ds_read_b64_tr_b16 v[138:139], v193 offset:17856
    v_mfma_f32_16x16x32_bf16 v[52:55], v[84:87], v[104:107], v[52:55]
    v_mfma_f32_16x16x32_bf16 v[24:27], v[88:91], v[100:103], v[24:27]
    v_mfma_f32_16x16x32_bf16 v[56:59], v[88:91], v[104:107], v[56:59]
    v_mfma_f32_16x16x32_bf16 v[28:31], v[92:95], v[100:103], v[28:31]
    v_mfma_f32_16x16x32_bf16 v[60:63], v[92:95], v[104:107], v[60:63]
    v_mfma_f32_16x16x32_bf16 v[32:35], v[96:99], v[100:103], v[32:35]
    v_mfma_f32_16x16x32_bf16 v[64:67], v[96:99], v[104:107], v[64:67]
    s_waitcnt vmcnt(4)
    s_waitcnt lgkmcnt(0)
    s_barrier
    v_mfma_f32_16x16x32_bf16 v[4:7], v[108:111], v[140:143], v[4:7]
    ds_read_b128 v[100:103], v190 offset:0
    ds_read_b128 v[104:107], v190 offset:2048
    s_cmp_eq_u32 s49, 0
    s_mov_b32 s70, 52224
    s_cselect_b32 s70, 69632, s70
    s_add_u32 s70, s70, s69
    s_mov_b32 s65, s64
    s_add_u32 s64, s64, 8192
    s_sub_u32 s73, s73, 1
    s_mov_b32 m0, s70
    s_nop 0
    buffer_load_dwordx4 v202, s[4:7], s65 offen nt lds
    v_mfma_f32_16x16x32_bf16 v[36:39], v[108:111], v[144:147], v[36:39]
    ds_read_b64_tr_b16 v[68:69], v192 offset:34816
    ds_read_b64_tr_b16 v[70:71], v192 offset:35072
    v_mfma_f32_16x16x32_bf16 v[8:11], v[112:115], v[140:143], v[8:11]
    ds_read_b64_tr_b16 v[72:73], v193 offset:34816
    ds_read_b64_tr_b16 v[74:75], v193 offset:35072
    s_add_u32 s70, s70, s68
    s_mov_b32 m0, s70
    s_add_u32 s65, s65, s66
    buffer_load_dwordx4 v202, s[4:7], s65 offen nt lds
    v_mfma_f32_16x16x32_bf16 v[40:43], v[112:115], v[144:147], v[40:43]
    ds_read_b64_tr_b16 v[76:77], v192 offset:34880
    ds_read_b64_tr_b16 v[78:79], v192 offset:35136
    v_mfma_f32_16x16x32_bf16 v[12:15], v[116:119], v[140:143], v[12:15]
    ds_read_b64_tr_b16 v[80:81], v193 offset:34880
    ds_read_b64_tr_b16 v[82:83], v193 offset:35136
    s_add_u32 s70, s70, s68
    s_mov_b32 m0, s70
    s_add_u32 s65, s65, s66
    buffer_load_dwordx4 v202, s[4:7], s65 offen nt lds
    v_mfma_f32_16x16x32_bf16 v[44:47], v[116:119], v[144:147], v[44:47]
    ds_read_b64_tr_b16 v[84:85], v192 offset:34944
    ds_read_b64_tr_b16 v[86:87], v192 offset:35200
    v_mfma_f32_16x16x32_bf16 v[16:19], v[120:123], v[140:143], v[16:19]
    ds_read_b64_tr_b16 v[88:89], v193 offset:34944
    ds_read_b64_tr_b16 v[90:91], v193 offset:35200
    s_add_u32 s70, s70, s68
    s_mov_b32 m0, s70
    s_add_u32 s65, s65, s66
    buffer_load_dwordx4 v202, s[4:7], s65 offen nt lds
    v_mfma_f32_16x16x32_bf16 v[48:51], v[120:123], v[144:147], v[48:51]
    ds_read_b64_tr_b16 v[92:93], v192 offset:35008
    ds_read_b64_tr_b16 v[94:95], v192 offset:35264
    v_mfma_f32_16x16x32_bf16 v[20:23], v[124:127], v[140:143], v[20:23]
    ds_read_b64_tr_b16 v[96:97], v193 offset:35008
    ds_read_b64_tr_b16 v[98:99], v193 offset:35264
    v_mfma_f32_16x16x32_bf16 v[52:55], v[124:127], v[144:147], v[52:55]
    v_mfma_f32_16x16x32_bf16 v[24:27], v[128:131], v[140:143], v[24:27]
    v_mfma_f32_16x16x32_bf16 v[56:59], v[128:131], v[144:147], v[56:59]
    v_mfma_f32_16x16x32_bf16 v[28:31], v[132:135], v[140:143], v[28:31]
    v_mfma_f32_16x16x32_bf16 v[60:63], v[132:135], v[144:147], v[60:63]
    v_mfma_f32_16x16x32_bf16 v[32:35], v[136:139], v[140:143], v[32:35]
    v_mfma_f32_16x16x32_bf16 v[64:67], v[136:139], v[144:147], v[64:67]
    s_waitcnt lgkmcnt(0)
    s_barrier
    v_mfma_f32_16x16x32_bf16 v[4:7], v[68:71], v[100:103], v[4:7]
    ds_read_b128 v[140:143], v191 offset:0
    ds_read_b128 v[144:147], v191 offset:2048
    s_add_u32 s70, s70, s68
    s_mov_b32 m0, s70
    s_add_u32 s65, s65, s67
    buffer_load_dwordx4 v202, s[4:7], s65 offen nt lds
    v_mfma_f32_16x16x32_bf16 v[36:39], v[68:71], v[104:107], v[36:39]
    ds_read_b64_tr_b16 v[108:109], v194 offset:0
    ds_read_b64_tr_b16 v[110:111], v194 offset:256
    v_mfma_f32_16x16x32_bf16 v[8:11], v[72:75], v[100:103], v[8:11]
    ds_read_b64_tr_b16 v[112:113], v195 offset:0
    ds_read_b64_tr_b16 v[114:115], v195 offset:256
    s_add_u32 s70, s70, s68
    s_mov_b32 m0, s70
    s_add_u32 s65, s65, s66
    buffer_load_dwordx4 v202, s[4:7], s65 offen nt lds
    v_mfma_f32_16x16x32_bf16 v[40:43], v[72:75], v[104:107], v[40:43]
    ds_read_b64_tr_b16 v[116:117], v194 offset:64
    ds_read_b64_tr_b16 v[118:119], v194 offset:320
    v_mfma_f32_16x16x32_bf16 v[12:15], v[76:79], v[100:103], v[12:15]
    ds_read_b64_tr_b16 v[120:121], v195 offset:64
    ds_read_b64_tr_b16 v[122:123], v195 offset:320
    s_add_u32 s70, s70, s68
    s_mov_b32 m0, s70
    s_add_u32 s65, s65, s66
    buffer_load_dwordx4 v202, s[4:7], s65 offen nt lds
    v_mfma_f32_16x16x32_bf16 v[44:47], v[76:79], v[104:107], v[44:47]
    ds_read_b64_tr_b16 v[124:125], v194 offset:128
    ds_read_b64_tr_b16 v[126:127], v194 offset:384
    v_mfma_f32_16x16x32_bf16 v[16:19], v[80:83], v[100:103], v[16:19]
    ds_read_b64_tr_b16 v[128:129], v195 offset:128
    ds_read_b64_tr_b16 v[130:131], v195 offset:384
    s_add_u32 s70, s70, s68
    s_mov_b32 m0, s70
    s_add_u32 s65, s65, s66
    buffer_load_dwordx4 v202, s[4:7], s65 offen nt lds
    v_mfma_f32_16x16x32_bf16 v[48:51], v[80:83], v[104:107], v[48:51]
    ds_read_b64_tr_b16 v[132:133], v194 offset:192
    ds_read_b64_tr_b16 v[134:135], v194 offset:448
    v_mfma_f32_16x16x32_bf16 v[20:23], v[84:87], v[100:103], v[20:23]
    ds_read_b64_tr_b16 v[136:137], v195 offset:192
    ds_read_b64_tr_b16 v[138:139], v195 offset:448
    v_mfma_f32_16x16x32_bf16 v[52:55], v[84:87], v[104:107], v[52:55]
    v_mfma_f32_16x16x32_bf16 v[24:27], v[88:91], v[100:103], v[24:27]
    v_mfma_f32_16x16x32_bf16 v[56:59], v[88:91], v[104:107], v[56:59]
    v_mfma_f32_16x16x32_bf16 v[28:31], v[92:95], v[100:103], v[28:31]
    v_mfma_f32_16x16x32_bf16 v[60:63], v[92:95], v[104:107], v[60:63]
    v_mfma_f32_16x16x32_bf16 v[32:35], v[96:99], v[100:103], v[32:35]
    v_mfma_f32_16x16x32_bf16 v[64:67], v[96:99], v[104:107], v[64:67]
    s_waitcnt vmcnt(8)
    s_waitcnt lgkmcnt(0)
    s_barrier
    v_mfma_f32_16x16x32_bf16 v[4:7], v[108:111], v[140:143], v[4:7]
    v_add_u32 v184, 0, v180
    v_add_u32 v185, 0, v181
    ds_read_b128 v[148:151], v184 offset:0
    ds_read_b128 v[156:159], v184 offset:64
    ds_read_b128 v[164:167], v184 offset:128
    ds_read_b128 v[172:175], v184 offset:192
    ds_read_b128 v[152:155], v185 offset:0
    ds_read_b128 v[160:163], v185 offset:64
    ds_read_b128 v[168:171], v185 offset:128
    ds_read_b128 v[176:179], v185 offset:192
    v_mfma_f32_16x16x32_bf16 v[36:39], v[108:111], v[144:147], v[36:39]
    v_mfma_f32_16x16x32_bf16 v[8:11], v[112:115], v[140:143], v[8:11]
    v_mfma_f32_16x16x32_bf16 v[40:43], v[112:115], v[144:147], v[40:43]
    v_mfma_f32_16x16x32_bf16 v[12:15], v[116:119], v[140:143], v[12:15]
    v_mfma_f32_16x16x32_bf16 v[44:47], v[116:119], v[144:147], v[44:47]
    v_mfma_f32_16x16x32_bf16 v[16:19], v[120:123], v[140:143], v[16:19]
    v_mfma_f32_16x16x32_bf16 v[48:51], v[120:123], v[144:147], v[48:51]
    v_mfma_f32_16x16x32_bf16 v[20:23], v[124:127], v[140:143], v[20:23]
    v_mfma_f32_16x16x32_bf16 v[52:55], v[124:127], v[144:147], v[52:55]
    v_mfma_f32_16x16x32_bf16 v[24:27], v[128:131], v[140:143], v[24:27]
    v_pk_mul_f32 v[4:5], v[4:5], s[62:63]
    v_pk_mul_f32 v[6:7], v[6:7], s[62:63]
    v_mfma_f32_16x16x32_bf16 v[56:59], v[128:131], v[144:147], v[56:59]
    v_pk_mul_f32 v[8:9], v[8:9], s[62:63]
    v_pk_mul_f32 v[10:11], v[10:11], s[62:63]
    v_mfma_f32_16x16x32_bf16 v[28:31], v[132:135], v[140:143], v[28:31]
    v_cvt_pk_bf16_f32 v68, v4, v5
    v_cvt_pk_bf16_f32 v69, v6, v7
    v_mfma_f32_16x16x32_bf16 v[60:63], v[132:135], v[144:147], v[60:63]
    v_cvt_pk_bf16_f32 v70, v8, v9
    v_cvt_pk_bf16_f32 v71, v10, v11
    v_mfma_f32_16x16x32_bf16 v[32:35], v[136:139], v[140:143], v[32:35]
    v_pk_mul_f32 v[36:37], v[36:37], s[62:63]
    v_pk_mul_f32 v[38:39], v[38:39], s[62:63]
    v_mfma_f32_16x16x32_bf16 v[64:67], v[136:139], v[144:147], v[64:67]
    v_pk_mul_f32 v[40:41], v[40:41], s[62:63]
    v_pk_mul_f32 v[42:43], v[42:43], s[62:63]
    v_mov_b32 v200, 163824
    v_mov_b32 v201, 0
    ds_write_b32 v200, v201
    s_lshl_b32 s78, s42, 3
    s_add_u32 s78, s78, s44
    s_lshl_b32 s78, s78, 2
    s_add_u32 s59, s78, s43
    s_mul_i32 s59, s59, 327680
    s_add_u32 s59, s59, s100
    s_add_u32 s12, s40, s59
    s_addc_u32 s13, s41, 0
    s_mov_b32 s14, 253952
    s_mov_b32 s15, 0x20000
    s_add_u32 s59, s78, s45
    s_mul_i32 s59, s59, 81920
    s_add_u32 s59, s59, s100
    s_lshl_b32 s59, s59, 1
    s_add_u32 s59, s59, 33554432
    s_add_u32 s24, s40, s59
    s_addc_u32 s25, s41, 0
    s_mov_b32 s26, 16384
    s_mov_b32 s27, 0x20000
    s_mov_b32 s8, s38
    s_mov_b32 s9, s39
    s_mov_b32 s10, 16
    s_mov_b32 s11, 0x20000
    v_and_b32 v205, 15, v0
    v_lshlrev_b32 v205, 7, v205
    s_cmp_eq_u32 s49, 0
    s_mov_b32 s70, 87040
    s_cselect_b32 s70, 104448, s70
    s_add_u32 m0, s70, s69
    s_mov_b32 s65, s64
    buffer_load_dwordx4 v202, s[4:7], s65 offen nt lds
    s_add_u32 m0, m0, s68
    s_add_u32 s65, s65, s66
    buffer_load_dwordx4 v202, s[4:7], s65 offen nt lds
    s_add_u32 m0, m0, s68
    s_add_u32 s65, s65, s66
    buffer_load_dwordx4 v202, s[4:7], s65 offen nt lds
    s_add_u32 m0, m0, s68
    s_add_u32 s65, s65, s66
    buffer_load_dwordx4 v202, s[4:7], s65 offen nt lds
    s_add_u32 m0, m0, s68
    s_add_u32 s65, s65, s67
    buffer_load_dwordx4 v202, s[4:7], s65 offen nt lds
    s_add_u32 m0, m0, s68
    s_add_u32 s65, s65, s66
    buffer_load_dwordx4 v202, s[4:7], s65 offen nt lds
    s_add_u32 m0, m0, s68
    s_add_u32 s65, s65, s66
    buffer_load_dwordx4 v202, s[4:7], s65 offen nt lds
    s_add_u32 m0, m0, s68
    s_add_u32 s65, s65, s66
    buffer_load_dwordx4 v202, s[4:7], s65 offen nt lds
    s_add_u32 s64, s64, s71
    s_sub_u32 s73, s73, 1
    s_cmp_lg_u32 s73, 0
    s_cbranch_scc1 L_H_keep1
    s_mov_b64 s[4:5], s[28:29]
    s_mov_b32 s6, s2
    s_mov_b32 s64, s0
    s_mov_b32 s66, 1024
    s_mov_b32 s67, 13312
    s_mov_b32 s71, 32768
    v_mov_b32 v202, v217
    s_cmp_lg_u32 s49, 0
    s_cbranch_scc1 L_H_vsw1
    s_mov_b32 s76, 0
    s_mov_b32 s68, 0
    s_mov_b32 s69, 157696
    s_branch L_H_keep1
L_H_vsw1:
L_H_keep1:
    s_add_u32 s78, s73, s76
    s_cmp_lg_u32 s78, -1
    s_cbranch_scc1 L_H_not1
    s_cmp_lg_u32 s76, 0
    s_cbranch_scc1 L_H_not1
    buffer_load_dword v218, v214, s[28:31], s1 offen
    buffer_load_dword v218, v215, s[28:31], s1 offen
L_H_not1:
L_skipHc:
    v_cvt_pk_bf16_f32 v84, v36, v37
    v_cvt_pk_bf16_f32 v85, v38, v39
    v_cvt_pk_bf16_f32 v86, v40, v41
    v_cvt_pk_bf16_f32 v87, v42, v43
    v_pk_mul_f32 v[12:13], v[12:13], s[62:63]
    v_pk_mul_f32 v[14:15], v[14:15], s[62:63]
    v_pk_mul_f32 v[16:17], v[16:17], s[62:63]
    v_pk_mul_f32 v[18:19], v[18:19], s[62:63]
    v_cvt_pk_bf16_f32 v72, v12, v13
    v_cvt_pk_bf16_f32 v73, v14, v15
    v_cvt_pk_bf16_f32 v74, v16, v17
    v_cvt_pk_bf16_f32 v75, v18, v19
    v_pk_mul_f32 v[44:45], v[44:45], s[62:63]
    v_pk_mul_f32 v[46:47], v[46:47], s[62:63]
    v_pk_mul_f32 v[48:49], v[48:49], s[62:63]
    v_pk_mul_f32 v[50:51], v[50:51], s[62:63]
    v_cvt_pk_bf16_f32 v88, v44, v45
    v_cvt_pk_bf16_f32 v89, v46, v47
    v_cvt_pk_bf16_f32 v90, v48, v49
    v_cvt_pk_bf16_f32 v91, v50, v51
    v_pk_mul_f32 v[20:21], v[20:21], s[62:63]
    v_pk_mul_f32 v[22:23], v[22:23], s[62:63]
    v_pk_mul_f32 v[24:25], v[24:25], s[62:63]
    v_pk_mul_f32 v[26:27], v[26:27], s[62:63]
    v_cvt_pk_bf16_f32 v76, v20, v21
    v_cvt_pk_bf16_f32 v77, v22, v23
    v_cvt_pk_bf16_f32 v78, v24, v25
    v_cvt_pk_bf16_f32 v79, v26, v27
    v_pk_mul_f32 v[52:53], v[52:53], s[62:63]
    v_pk_mul_f32 v[54:55], v[54:55], s[62:63]
    v_pk_mul_f32 v[56:57], v[56:57], s[62:63]
    v_pk_mul_f32 v[58:59], v[58:59], s[62:63]
    v_cvt_pk_bf16_f32 v92, v52, v53
    v_cvt_pk_bf16_f32 v93, v54, v55
    v_cvt_pk_bf16_f32 v94, v56, v57
    v_cvt_pk_bf16_f32 v95, v58, v59
    v_pk_mul_f32 v[28:29], v[28:29], s[62:63]
    v_pk_mul_f32 v[30:31], v[30:31], s[62:63]
    v_pk_mul_f32 v[32:33], v[32:33], s[62:63]
    v_pk_mul_f32 v[34:35], v[34:35], s[62:63]
    v_cvt_pk_bf16_f32 v80, v28, v29
    v_cvt_pk_bf16_f32 v81, v30, v31
    v_cvt_pk_bf16_f32 v82, v32, v33
    v_cvt_pk_bf16_f32 v83, v34, v35
    v_pk_mul_f32 v[60:61], v[60:61], s[62:63]
    v_pk_mul_f32 v[62:63], v[62:63], s[62:63]
    v_pk_mul_f32 v[64:65], v[64:65], s[62:63]
    v_pk_mul_f32 v[66:67], v[66:67], s[62:63]
    v_cvt_pk_bf16_f32 v96, v60, v61
    v_cvt_pk_bf16_f32 v97, v62, v63
    v_cvt_pk_bf16_f32 v98, v64, v65
    v_cvt_pk_bf16_f32 v99, v66, v67
    v_permlane32_swap_b32 v68, v70
    v_permlane32_swap_b32 v69, v71
    v_permlane32_swap_b32 v72, v74
    v_permlane32_swap_b32 v73, v75
    v_permlane32_swap_b32 v76, v78
    v_permlane32_swap_b32 v77, v79
    v_permlane32_swap_b32 v80, v82
    v_permlane32_swap_b32 v81, v83
    v_permlane32_swap_b32 v84, v86
    v_permlane32_swap_b32 v85, v87
    v_permlane32_swap_b32 v88, v90
    v_permlane32_swap_b32 v89, v91
    v_permlane32_swap_b32 v92, v94
    v_permlane32_swap_b32 v93, v95
    v_permlane32_swap_b32 v96, v98
    v_permlane32_swap_b32 v97, v99
    v_permlane16_swap_b32 v68, v70
    v_permlane16_swap_b32 v69, v71
    v_permlane16_swap_b32 v72, v74
    v_permlane16_swap_b32 v73, v75
    v_permlane16_swap_b32 v76, v78
    v_permlane16_swap_b32 v77, v79
    v_permlane16_swap_b32 v80, v82
    v_permlane16_swap_b32 v81, v83
    v_permlane16_swap_b32 v84, v86
    v_permlane16_swap_b32 v85, v87
    v_permlane16_swap_b32 v88, v90
    v_permlane16_swap_b32 v89, v91
    v_permlane16_swap_b32 v92, v94
    v_permlane16_swap_b32 v93, v95
    v_permlane16_swap_b32 v96, v98
    v_permlane16_swap_b32 v97, v99
    v_mov_b32 v196, 0x3f803f80
    v_mov_b32 v197, 0x3f803f80
    v_mov_b32 v198, 0x3f803f80
    v_mov_b32 v199, 0x3f803f80
    s_waitcnt lgkmcnt(0)
    s_cmp_eq_u32 s49, 0
    s_cselect_b32 s70, s53, s58
    s_and_b32 s70, s70, s76
    s_add_u32 m0, s70, s69
    s_waitcnt vmcnt(16)
    s_barrier
    s_mov_b32 s65, s64
    buffer_load_dwordx4 v202, s[4:7], s65 offen nt lds
    s_waitcnt lgkmcnt(4)
    v_mfma_f32_16x16x32_bf16 v[100:103], v[148:151], v[68:71], 0
    v_add_u32 v186, s55, v182
    v_add_u32 v187, s55, v183
    s_add_u32 m0, m0, s68
    s_add_u32 s65, s65, s66
    buffer_load_dwordx4 v202, s[4:7], s65 offen nt lds
    v_mfma_f32_16x16x32_bf16 v[100:103], v[156:159], v[72:75], v[100:103]
    v_add_u32 v184, s50, v180
    v_add_u32 v185, s50, v181
    s_add_u32 m0, m0, s68
    s_add_u32 s65, s65, s66
    buffer_load_dwordx4 v202, s[4:7], s65 offen nt lds
    v_mfma_f32_16x16x32_bf16 v[100:103], v[164:167], v[76:79], v[100:103]
    s_mov_b32 s59, s50
    s_mov_b32 s50, s51
    s_add_u32 m0, m0, s68
    s_add_u32 s65, s65, s66
    buffer_load_dwordx4 v202, s[4:7], s65 offen nt lds
    v_mfma_f32_16x16x32_bf16 v[100:103], v[172:175], v[80:83], v[100:103]
    s_mov_b32 s51, s52
    s_mov_b32 s52, s53
    s_add_u32 m0, m0, s68
    s_add_u32 s65, s65, s67
    buffer_load_dwordx4 v202, s[4:7], s65 offen nt lds
    s_waitcnt lgkmcnt(0)
    v_mfma_f32_16x16x32_bf16 v[104:107], v[152:155], v[68:71], 0
    s_mov_b32 s53, s54
    s_mov_b32 s54, s59
    s_add_u32 m0, m0, s68
    s_add_u32 s65, s65, s66
    buffer_load_dwordx4 v202, s[4:7], s65 offen nt lds
    v_mfma_f32_16x16x32_bf16 v[104:107], v[160:163], v[72:75], v[104:107]
    s_mov_b32 s59, s55
    s_mov_b32 s55, s56
    s_add_u32 m0, m0, s68
    s_add_u32 s65, s65, s66
    buffer_load_dwordx4 v202, s[4:7], s65 offen nt lds
    v_mfma_f32_16x16x32_bf16 v[104:107], v[168:171], v[76:79], v[104:107]
    s_mov_b32 s56, s57
    s_mov_b32 s57, s58
    s_add_u32 m0, m0, s68
    s_add_u32 s65, s65, s66
    buffer_load_dwordx4 v202, s[4:7], s65 offen nt lds
    s_add_u32 s64, s64, s71
    s_sub_u32 s73, s73, 1
    s_cmp_lg_u32 s73, 0
    s_cbranch_scc1 L_H_keep2
    s_mov_b64 s[4:5], s[28:29]
    s_mov_b32 s6, s2
    s_mov_b32 s64, s0
    s_mov_b32 s66, 1024
    s_mov_b32 s67, 13312
    s_mov_b32 s71, 32768
    v_mov_b32 v202, v217
    s_cmp_lg_u32 s49, 0
    s_cbranch_scc1 L_H_vsw2
    s_mov_b32 s76, 0
    s_mov_b32 s68, 0
    s_mov_b32 s69, 157696
    s_branch L_H_keep2
L_H_vsw2:
L_H_keep2:
    s_add_u32 s78, s73, s76
    s_cmp_lg_u32 s78, -1
    s_cbranch_scc1 L_H_not2
    s_cmp_lg_u32 s76, 0
    s_cbranch_scc1 L_H_not2
    buffer_load_dword v218, v214, s[28:31], s1 offen
    buffer_load_dword v218, v215, s[28:31], s1 offen
L_H_not2:
    v_mfma_f32_16x16x32_bf16 v[104:107], v[176:179], v[80:83], v[104:107]
    s_mov_b32 s58, s59
    v_mfma_f32_16x16x32_bf16 v[108:111], v[148:151], v[84:87], 0
    ds_read_b64_tr_b16 v[148:149], v186 offset:0
    ds_read_b64_tr_b16 v[150:151], v186 offset:4352
    v_mfma_f32_16x16x32_bf16 v[108:111], v[156:159], v[88:91], v[108:111]
    ds_read_b64_tr_b16 v[156:157], v186 offset:64
    ds_read_b64_tr_b16 v[158:159], v186 offset:4416
    v_mfma_f32_16x16x32_bf16 v[108:111], v[164:167], v[92:95], v[108:111]
    ds_read_b64_tr_b16 v[164:165], v186 offset:128
    ds_read_b64_tr_b16 v[166:167], v186 offset:4480
    v_max3_f32 v200, v100, v101, v102
    v_max3_f32 v200, v200, v103, v104
    v_max3_f32 v200, v200, v105, v106
    v_max_f32 v200, v200, v107
    v_mfma_f32_16x16x32_bf16 v[108:111], v[172:175], v[96:99], v[108:111]
    ds_read_b64_tr_b16 v[172:173], v186 offset:192
    ds_read_b64_tr_b16 v[174:175], v186 offset:4544
    v_mov_b32 v201, v200
    s_nop 1
    v_permlane32_swap_b32 v200, v201
    v_max_f32 v200, v200, v201
    v_mfma_f32_16x16x32_bf16 v[112:115], v[152:155], v[84:87], 0
    ds_read_b64_tr_b16 v[152:153], v187 offset:0
    ds_read_b64_tr_b16 v[154:155], v187 offset:4352
    v_mov_b32 v201, v200
    s_nop 1
    v_permlane16_swap_b32 v200, v201
    v_max_f32 v200, v200, v201
    v_mfma_f32_16x16x32_bf16 v[112:115], v[160:163], v[88:91], v[112:115]
    ds_read_b64_tr_b16 v[160:161], v187 offset:64
    ds_read_b64_tr_b16 v[162:163], v187 offset:4416
    v_sub_f32 v100, v100, v200
    v_sub_f32 v101, v101, v200
    v_sub_f32 v102, v102, v200
    v_sub_f32 v103, v103, v200
    v_mfma_f32_16x16x32_bf16 v[112:115], v[168:171], v[92:95], v[112:115]
    ds_read_b64_tr_b16 v[168:169], v187 offset:128
    ds_read_b64_tr_b16 v[170:171], v187 offset:4480
    v_sub_f32 v104, v104, v200
    v_sub_f32 v105, v105, v200
    v_sub_f32 v106, v106, v200
    v_sub_f32 v107, v107, v200
    v_mfma_f32_16x16x32_bf16 v[112:115], v[176:179], v[96:99], v[112:115]
    ds_read_b64_tr_b16 v[176:177], v187 offset:192
    ds_read_b64_tr_b16 v[178:179], v187 offset:4544
    v_sub_f32 v116, 0, v200
    v_sub_f32 v117, 0, v200
    v_sub_f32 v118, 0, v200
    v_sub_f32 v119, 0, v200
    v_exp_f32 v100, v100
    v_exp_f32 v101, v101
    v_exp_f32 v102, v102
    v_exp_f32 v103, v103
    v_cvt_pk_bf16_f32 v100, v100, v101
    v_cvt_pk_bf16_f32 v101, v102, v103
    v_exp_f32 v104, v104
    v_exp_f32 v105, v105
    v_exp_f32 v106, v106
    v_exp_f32 v107, v107
    v_cvt_pk_bf16_f32 v102, v104, v105
    v_cvt_pk_bf16_f32 v103, v106, v107
    s_waitcnt lgkmcnt(8)
    s_nop 0
    v_mfma_f32_16x16x32_bf16 v[4:7], v[148:151], v[100:103], 0
    v_max3_f32 v200, v108, v109, v110
    v_max3_f32 v200, v200, v111, v112
    v_mfma_f32_16x16x32_bf16 v[12:15], v[156:159], v[100:103], 0
    v_max3_f32 v200, v200, v113, v114
    v_max_f32 v200, v200, v115
    v_mfma_f32_16x16x32_bf16 v[20:23], v[164:167], v[100:103], 0
    v_mov_b32 v201, v200
    s_nop 1
    v_mfma_f32_16x16x32_bf16 v[28:31], v[172:175], v[100:103], 0
    v_permlane32_swap_b32 v200, v201
    v_max_f32 v200, v200, v201
    s_waitcnt lgkmcnt(0)
    v_mfma_f32_16x16x32_bf16 v[8:11], v[152:155], v[100:103], 0
    v_mov_b32 v201, v200
    s_nop 1
    v_mfma_f32_16x16x32_bf16 v[16:19], v[160:163], v[100:103], 0
    v_permlane16_swap_b32 v200, v201
    v_max_f32 v200, v200, v201
    v_mfma_f32_16x16x32_bf16 v[24:27], v[168:171], v[100:103], 0
    v_sub_f32 v108, v108, v200
    v_sub_f32 v109, v109, v200
    v_mfma_f32_16x16x32_bf16 v[32:35], v[176:179], v[100:103], 0
    v_mfma_f32_16x16x32_bf16 v[188:191], v[196:199], v[100:103], 0
    v_sub_f32 v110, v110, v200
    v_sub_f32 v111, v111, v200
    v_sub_f32 v112, v112, v200
    v_sub_f32 v113, v113, v200
    v_sub_f32 v114, v114, v200
    v_sub_f32 v115, v115, v200
    v_sub_f32 v120, 0, v200
    v_sub_f32 v121, 0, v200
    v_sub_f32 v122, 0, v200
    v_sub_f32 v123, 0, v200
    v_exp_f32 v108, v108
    v_exp_f32 v109, v109
    v_exp_f32 v110, v110
    v_exp_f32 v111, v111
    v_cvt_pk_bf16_f32 v108, v108, v109
    v_cvt_pk_bf16_f32 v109, v110, v111
    v_exp_f32 v112, v112
    v_exp_f32 v113, v113
    v_exp_f32 v114, v114
    v_exp_f32 v115, v115
    v_cvt_pk_bf16_f32 v110, v112, v113
    v_cvt_pk_bf16_f32 v111, v114, v115
    s_nop 1
    v_mfma_f32_16x16x32_bf16 v[36:39], v[148:151], v[108:111], 0
    ds_read_b128 v[148:151], v184 offset:0
    v_mfma_f32_16x16x32_bf16 v[44:47], v[156:159], v[108:111], 0
    ds_read_b128 v[156:159], v184 offset:64
    v_mfma_f32_16x16x32_bf16 v[52:55], v[164:167], v[108:111], 0
    ds_read_b128 v[164:167], v184 offset:128
    v_mfma_f32_16x16x32_bf16 v[60:63], v[172:175], v[108:111], 0
    ds_read_b128 v[172:175], v184 offset:192
    v_mfma_f32_16x16x32_bf16 v[40:43], v[152:155], v[108:111], 0
    ds_read_b128 v[152:155], v185 offset:0
    v_mfma_f32_16x16x32_bf16 v[48:51], v[160:163], v[108:111], 0
    ds_read_b128 v[160:163], v185 offset:64
    v_mfma_f32_16x16x32_bf16 v[56:59], v[168:171], v[108:111], 0
    ds_read_b128 v[168:171], v185 offset:128
    v_mfma_f32_16x16x32_bf16 v[64:67], v[176:179], v[108:111], 0
    v_mfma_f32_16x16x32_bf16 v[192:195], v[196:199], v[108:111], 0
    ds_read_b128 v[176:179], v185 offset:192
    s_mov_b32 s60, 1
L_att_H:
    s_cmp_eq_u32 s49, 0
    s_cselect_b32 s70, s53, s58
    s_and_b32 s70, s70, s76
    s_add_u32 m0, s70, s69
    s_waitcnt vmcnt(16)
    s_barrier
    s_cmp_lg_u32 s3, 4
    s_cbranch_scc1 L_nogate
    s_cmp_lg_u32 s60, 10
    s_cbranch_scc1 L_gate1
    buffer_load_dword v204, off, s[8:11], 0 sc1
L_gate1:
    s_cmp_lg_u32 s60, 15
    s_cbranch_scc1 L_gate2
    buffer_load_dword v206, v205, s[20:23], 0 offen sc1
L_gate2:
    s_cmp_lg_u32 s60, 13
    s_cbranch_scc1 L_nogate
    s_mov_b32 s78, 0
    s_branch L_checkgn
    s_mov_b32 s78, 0
L_pollgn:
    buffer_load_dword v204, off, s[8:11], 0 sc1
    s_add_u32 s78, s78, 1
    s_waitcnt vmcnt(0)
L_checkgn:
    v_readfirstlane_b32 s59, v204
    s_nop 0
    s_bitcmp1_b32 s59, 0
    s_cbranch_scc1 L_donegn
    s_sleep 4
    s_cmp_lt_u32 s78, 0x10000
    s_cbranch_scc1 L_pollgn
L_donegn:
    v_mov_b32 v208, 1
    s_mov_b64 exec, 1
    buffer_store_dword v208, off, s[20:23], s75 sc1
    s_mov_b64 exec, -1
L_nogate:
    s_mov_b32 s65, s64
    buffer_load_dwordx4 v202, s[4:7], s65 offen nt lds
    s_waitcnt lgkmcnt(4)
    v_mfma_f32_16x16x32_bf16 v[100:103], v[148:151], v[68:71], v[116:119]
    v_add_u32 v186, s55, v182
    v_add_u32 v187, s55, v183
    s_add_u32 m0, m0, s68
    s_add_u32 s65, s65, s66
    buffer_load_dwordx4 v202, s[4:7], s65 offen nt lds
    v_mfma_f32_16x16x32_bf16 v[100:103], v[156:159], v[72:75], v[100:103]
    v_add_u32 v184, s50, v180
    v_add_u32 v185, s50, v181
    s_add_u32 m0, m0, s68
    s_add_u32 s65, s65, s66
    buffer_load_dwordx4 v202, s[4:7], s65 offen nt lds
    v_mfma_f32_16x16x32_bf16 v[100:103], v[164:167], v[76:79], v[100:103]
    s_mov_b32 s59, s50
    s_mov_b32 s50, s51
    s_add_u32 m0, m0, s68
    s_add_u32 s65, s65, s66
    buffer_load_dwordx4 v202, s[4:7], s65 offen nt lds
    v_mfma_f32_16x16x32_bf16 v[100:103], v[172:175], v[80:83], v[100:103]
    s_mov_b32 s51, s52
    s_mov_b32 s52, s53
    s_add_u32 m0, m0, s68
    s_add_u32 s65, s65, s67
    buffer_load_dwordx4 v202, s[4:7], s65 offen nt lds
    s_waitcnt lgkmcnt(0)
    v_mfma_f32_16x16x32_bf16 v[104:107], v[152:155], v[68:71], v[116:119]
    s_mov_b32 s53, s54
    s_mov_b32 s54, s59
    v_exp_f32 v100, v100
    s_add_u32 m0, m0, s68
    s_add_u32 s65, s65, s66
    buffer_load_dwordx4 v202, s[4:7], s65 offen nt lds
    v_mfma_f32_16x16x32_bf16 v[104:107], v[160:163], v[72:75], v[104:107]
    s_mov_b32 s59, s55
    s_mov_b32 s55, s56
    v_exp_f32 v101, v101
    s_add_u32 m0, m0, s68
    s_add_u32 s65, s65, s66
    buffer_load_dwordx4 v202, s[4:7], s65 offen nt lds
    v_mfma_f32_16x16x32_bf16 v[104:107], v[168:171], v[76:79], v[104:107]
    s_mov_b32 s56, s57
    s_mov_b32 s57, s58
    v_exp_f32 v102, v102
    s_add_u32 m0, m0, s68
    s_add_u32 s65, s65, s66
    buffer_load_dwordx4 v202, s[4:7], s65 offen nt lds
    s_add_u32 s64, s64, s71
    s_sub_u32 s73, s73, 1
    s_cmp_lg_u32 s73, 0
    s_cbranch_scc1 L_H_keep3
    s_mov_b64 s[4:5], s[28:29]
    s_mov_b32 s6, s2
    s_mov_b32 s64, s0
    s_mov_b32 s66, 1024
    s_mov_b32 s67, 13312
    s_mov_b32 s71, 32768
    v_mov_b32 v202, v217
    s_cmp_lg_u32 s49, 0
    s_cbranch_scc1 L_H_vsw3
    s_mov_b32 s76, 0
    s_mov_b32 s68, 0
    s_mov_b32 s69, 157696
    s_branch L_H_keep3
L_H_vsw3:
L_H_keep3:
    s_add_u32 s78, s73, s76
    s_cmp_lg_u32 s78, -1
    s_cbranch_scc1 L_H_not3
    s_cmp_lg_u32 s76, 0
    s_cbranch_scc1 L_H_not3
    buffer_load_dword v218, v214, s[28:31], s1 offen
    buffer_load_dword v218, v215, s[28:31], s1 offen
L_H_not3:
    v_mfma_f32_16x16x32_bf16 v[104:107], v[176:179], v[80:83], v[104:107]
    s_mov_b32 s58, s59
    v_exp_f32 v103, v103
    v_mfma_f32_16x16x32_bf16 v[108:111], v[148:151], v[84:87], v[120:123]
    ds_read_b64_tr_b16 v[148:149], v186 offset:0
    ds_read_b64_tr_b16 v[150:151], v186 offset:4352
    v_cvt_pk_bf16_f32 v100, v100, v101
    v_cvt_pk_bf16_f32 v101, v102, v103
    v_mfma_f32_16x16x32_bf16 v[108:111], v[156:159], v[88:91], v[108:111]
    ds_read_b64_tr_b16 v[156:157], v186 offset:64
    ds_read_b64_tr_b16 v[158:159], v186 offset:4416
    v_exp_f32 v104, v104
    v_mfma_f32_16x16x32_bf16 v[108:111], v[164:167], v[92:95], v[108:111]
    ds_read_b64_tr_b16 v[164:165], v186 offset:128
    ds_read_b64_tr_b16 v[166:167], v186 offset:4480
    v_exp_f32 v105, v105
    v_mfma_f32_16x16x32_bf16 v[108:111], v[172:175], v[96:99], v[108:111]
    ds_read_b64_tr_b16 v[172:173], v186 offset:192
    ds_read_b64_tr_b16 v[174:175], v186 offset:4544
    v_exp_f32 v106, v106
    v_mfma_f32_16x16x32_bf16 v[112:115], v[152:155], v[84:87], v[120:123]
    ds_read_b64_tr_b16 v[152:153], v187 offset:0
    ds_read_b64_tr_b16 v[154:155], v187 offset:4352
    v_exp_f32 v107, v107
    v_mfma_f32_16x16x32_bf16 v[112:115], v[160:163], v[88:91], v[112:115]
    ds_read_b64_tr_b16 v[160:161], v187 offset:64
    ds_read_b64_tr_b16 v[162:163], v187 offset:4416
    v_cvt_pk_bf16_f32 v102, v104, v105
    v_cvt_pk_bf16_f32 v103, v106, v107
    v_mfma_f32_16x16x32_bf16 v[112:115], v[168:171], v[92:95], v[112:115]
    ds_read_b64_tr_b16 v[168:169], v187 offset:128
    ds_read_b64_tr_b16 v[170:171], v187 offset:4480
    v_exp_f32 v108, v108
    v_mfma_f32_16x16x32_bf16 v[112:115], v[176:179], v[96:99], v[112:115]
    ds_read_b64_tr_b16 v[176:177], v187 offset:192
    ds_read_b64_tr_b16 v[178:179], v187 offset:4544
    v_exp_f32 v109, v109
    s_waitcnt lgkmcnt(8)
    v_mfma_f32_16x16x32_bf16 v[4:7], v[148:151], v[100:103], v[4:7]
    v_exp_f32 v110, v110
    v_mfma_f32_16x16x32_bf16 v[12:15], v[156:159], v[100:103], v[12:15]
    v_exp_f32 v111, v111
    v_mfma_f32_16x16x32_bf16 v[20:23], v[164:167], v[100:103], v[20:23]
    v_cvt_pk_bf16_f32 v108, v108, v109
    v_cvt_pk_bf16_f32 v109, v110, v111
    v_mfma_f32_16x16x32_bf16 v[28:31], v[172:175], v[100:103], v[28:31]
    v_exp_f32 v112, v112
    s_waitcnt lgkmcnt(0)
    v_mfma_f32_16x16x32_bf16 v[8:11], v[152:155], v[100:103], v[8:11]
    v_exp_f32 v113, v113
    v_mfma_f32_16x16x32_bf16 v[16:19], v[160:163], v[100:103], v[16:19]
    v_exp_f32 v114, v114
    v_mfma_f32_16x16x32_bf16 v[24:27], v[168:171], v[100:103], v[24:27]
    v_exp_f32 v115, v115
    v_mfma_f32_16x16x32_bf16 v[32:35], v[176:179], v[100:103], v[32:35]
    v_mfma_f32_16x16x32_bf16 v[188:191], v[196:199], v[100:103], v[188:191]
    v_cvt_pk_bf16_f32 v110, v112, v113
    v_cvt_pk_bf16_f32 v111, v114, v115
    s_nop 1
    v_mfma_f32_16x16x32_bf16 v[36:39], v[148:151], v[108:111], v[36:39]
    ds_read_b128 v[148:151], v184 offset:0
    v_mfma_f32_16x16x32_bf16 v[44:47], v[156:159], v[108:111], v[44:47]
    ds_read_b128 v[156:159], v184 offset:64
    v_mfma_f32_16x16x32_bf16 v[52:55], v[164:167], v[108:111], v[52:55]
    ds_read_b128 v[164:167], v184 offset:128
    v_mfma_f32_16x16x32_bf16 v[60:63], v[172:175], v[108:111], v[60:63]
    ds_read_b128 v[172:175], v184 offset:192
    v_mfma_f32_16x16x32_bf16 v[40:43], v[152:155], v[108:111], v[40:43]
    ds_read_b128 v[152:155], v185 offset:0
    v_mfma_f32_16x16x32_bf16 v[48:51], v[160:163], v[108:111], v[48:51]
    ds_read_b128 v[160:163], v185 offset:64
    v_mfma_f32_16x16x32_bf16 v[56:59], v[168:171], v[108:111], v[56:59]
    ds_read_b128 v[168:171], v185 offset:128
    v_mfma_f32_16x16x32_bf16 v[64:67], v[176:179], v[108:111], v[64:67]
    v_mfma_f32_16x16x32_bf16 v[192:195], v[196:199], v[108:111], v[192:195]
    ds_read_b128 v[176:179], v185 offset:192
    s_add_u32 s60, s60, 1
    s_cmp_lt_u32 s60, 16
    s_cbranch_scc1 L_att_H
    v_mov_b32 v200, 0x4b800000
    v_mov_b32 v201, 163824
    v_cmp_nle_f32 vcc, v188, v200
    s_nop 0
    s_cbranch_vccnz L_voteH
    v_cmp_nle_f32 vcc, v192, v200
    s_nop 0
    s_cbranch_vccnz L_voteH
    s_branch L_epi_H
L_voteH:
    ds_write_b32 v201, v201
L_epi_H:
    v_rcp_f32 v188, v188
    s_nop 0
    v_rcp_f32 v192, v192
    v_lshlrev_b32 v196, 4, v0
    v_add_u32 v197, 4096, v196
    s_mul_i32 s17, s45, 81920
    v_pk_mul_f32 v[4:5], v[4:5], v[188:189] op_sel_hi:[1,0]
    v_pk_mul_f32 v[6:7], v[6:7], v[188:189] op_sel_hi:[1,0]
    v_pk_mul_f32 v[8:9], v[8:9], v[188:189] op_sel_hi:[1,0]
    v_pk_mul_f32 v[10:11], v[10:11], v[188:189] op_sel_hi:[1,0]
    v_cvt_pk_bf16_f32 v100, v4, v5
    v_cvt_pk_bf16_f32 v101, v6, v7
    v_cvt_pk_bf16_f32 v102, v8, v9
    v_cvt_pk_bf16_f32 v103, v10, v11
    v_pk_mul_f32 v[36:37], v[36:37], v[192:193] op_sel_hi:[1,0]
    v_pk_mul_f32 v[38:39], v[38:39], v[192:193] op_sel_hi:[1,0]
    v_pk_mul_f32 v[40:41], v[40:41], v[192:193] op_sel_hi:[1,0]
    v_pk_mul_f32 v[42:43], v[42:43], v[192:193] op_sel_hi:[1,0]
    v_cvt_pk_bf16_f32 v104, v36, v37
    v_cvt_pk_bf16_f32 v105, v38, v39
    v_cvt_pk_bf16_f32 v106, v40, v41
    v_cvt_pk_bf16_f32 v107, v42, v43
    v_pk_mul_f32 v[12:13], v[12:13], v[188:189] op_sel_hi:[1,0]
    v_pk_mul_f32 v[14:15], v[14:15], v[188:189] op_sel_hi:[1,0]
    v_pk_mul_f32 v[16:17], v[16:17], v[188:189] op_sel_hi:[1,0]
    v_pk_mul_f32 v[18:19], v[18:19], v[188:189] op_sel_hi:[1,0]
    v_cvt_pk_bf16_f32 v108, v12, v13
    v_cvt_pk_bf16_f32 v109, v14, v15
    v_cvt_pk_bf16_f32 v110, v16, v17
    v_cvt_pk_bf16_f32 v111, v18, v19
    v_pk_mul_f32 v[44:45], v[44:45], v[192:193] op_sel_hi:[1,0]
    v_pk_mul_f32 v[46:47], v[46:47], v[192:193] op_sel_hi:[1,0]
    v_pk_mul_f32 v[48:49], v[48:49], v[192:193] op_sel_hi:[1,0]
    v_pk_mul_f32 v[50:51], v[50:51], v[192:193] op_sel_hi:[1,0]
    v_cvt_pk_bf16_f32 v112, v44, v45
    v_cvt_pk_bf16_f32 v113, v46, v47
    v_cvt_pk_bf16_f32 v114, v48, v49
    v_cvt_pk_bf16_f32 v115, v50, v51
    v_pk_mul_f32 v[20:21], v[20:21], v[188:189] op_sel_hi:[1,0]
    v_pk_mul_f32 v[22:23], v[22:23], v[188:189] op_sel_hi:[1,0]
    v_pk_mul_f32 v[24:25], v[24:25], v[188:189] op_sel_hi:[1,0]
    v_pk_mul_f32 v[26:27], v[26:27], v[188:189] op_sel_hi:[1,0]
    v_cvt_pk_bf16_f32 v116, v20, v21
    v_cvt_pk_bf16_f32 v117, v22, v23
    v_cvt_pk_bf16_f32 v118, v24, v25
    v_cvt_pk_bf16_f32 v119, v26, v27
    v_pk_mul_f32 v[52:53], v[52:53], v[192:193] op_sel_hi:[1,0]
    v_pk_mul_f32 v[54:55], v[54:55], v[192:193] op_sel_hi:[1,0]
    v_pk_mul_f32 v[56:57], v[56:57], v[192:193] op_sel_hi:[1,0]
    v_pk_mul_f32 v[58:59], v[58:59], v[192:193] op_sel_hi:[1,0]
    v_cvt_pk_bf16_f32 v120, v52, v53
    v_cvt_pk_bf16_f32 v121, v54, v55
    v_cvt_pk_bf16_f32 v122, v56, v57
    v_cvt_pk_bf16_f32 v123, v58, v59
    v_pk_mul_f32 v[28:29], v[28:29], v[188:189] op_sel_hi:[1,0]
    v_pk_mul_f32 v[30:31], v[30:31], v[188:189] op_sel_hi:[1,0]
    v_pk_mul_f32 v[32:33], v[32:33], v[188:189] op_sel_hi:[1,0]
    v_pk_mul_f32 v[34:35], v[34:35], v[188:189] op_sel_hi:[1,0]
    v_cvt_pk_bf16_f32 v124, v28, v29
    v_cvt_pk_bf16_f32 v125, v30, v31
    v_cvt_pk_bf16_f32 v126, v32, v33
    v_cvt_pk_bf16_f32 v127, v34, v35
    v_pk_mul_f32 v[60:61], v[60:61], v[192:193] op_sel_hi:[1,0]
    v_pk_mul_f32 v[62:63], v[62:63], v[192:193] op_sel_hi:[1,0]
    v_pk_mul_f32 v[64:65], v[64:65], v[192:193] op_sel_hi:[1,0]
    v_pk_mul_f32 v[66:67], v[66:67], v[192:193] op_sel_hi:[1,0]
    v_cvt_pk_bf16_f32 v128, v60, v61
    v_cvt_pk_bf16_f32 v129, v62, v63
    v_cvt_pk_bf16_f32 v130, v64, v65
    v_cvt_pk_bf16_f32 v131, v66, v67
    s_lshl_b32 s79, s49, 7
    s_add_u32 s59, s79, 34816
    s_xor_b32 s78, s59, 128
    v_add_u32 v184, s59, v182
    v_add_u32 v185, s59, v183
    v_add_u32 v186, s78, v182
    v_add_u32 v187, s78, v183
    v_mov_b32 v2, 163824
    s_waitcnt vmcnt(8)
    s_cmp_lg_u32 s3, 4
    s_cbranch_scc1 L_doneg
    s_mov_b32 s78, 0
    s_branch L_checkg
    s_mov_b32 s78, 0
L_pollg:
    buffer_load_dword v206, v205, s[20:23], 0 offen sc1
    s_add_u32 s78, s78, 1
    s_waitcnt vmcnt(0)
L_checkg:
    v_cmp_le_u32 vcc, 1, v206
    s_nop 0
    s_cmp_eq_u64 vcc, -1
    s_cbranch_scc1 L_doneg
    s_sleep 4
    s_cmp_lt_u32 s78, 0x10000
    s_cbranch_scc1 L_pollg
L_doneg:
    s_waitcnt lgkmcnt(0)
    s_barrier
    ds_read_b32 v2, v2
    ds_read_b64_tr_b16 v[148:149], v184 offset:0
    ds_read_b64_tr_b16 v[150:151], v184 offset:4352
    ds_read_b64_tr_b16 v[152:153], v185 offset:0
    ds_read_b64_tr_b16 v[154:155], v185 offset:4352
    ds_read_b64_tr_b16 v[156:157], v184 offset:64
    ds_read_b64_tr_b16 v[158:159], v184 offset:4416
    ds_read_b64_tr_b16 v[160:161], v185 offset:64
    ds_read_b64_tr_b16 v[162:163], v185 offset:4416
    ds_read_b64_tr_b16 v[164:165], v186 offset:0
    ds_read_b64_tr_b16 v[166:167], v186 offset:4352
    ds_read_b64_tr_b16 v[168:169], v187 offset:0
    ds_read_b64_tr_b16 v[170:171], v187 offset:4352
    ds_read_b64_tr_b16 v[172:173], v186 offset:64
    ds_read_b64_tr_b16 v[174:175], v186 offset:4416
    ds_read_b64_tr_b16 v[176:177], v187 offset:64
    ds_read_b64_tr_b16 v[178:179], v187 offset:4416
    s_waitcnt lgkmcnt(15)
    v_readfirstlane_b32 s59, v2
    s_nop 0
    s_cmp_lg_u32 s59, 0
    s_cbranch_scc1 L_redo_H
    buffer_store_dwordx4 v[100:103], v196, s[12:15], s17 offen offset:0 sc1
    buffer_store_dwordx4 v[104:107], v197, s[12:15], s17 offen offset:0 sc1
    buffer_store_dwordx4 v[108:111], v196, s[12:15], s17 offen offset:1024 sc1
    buffer_store_dwordx4 v[112:115], v197, s[12:15], s17 offen offset:1024 sc1
    s_add_u32 s59, s45, 0
    s_and_b32 s59, s59, 3
    s_mul_i32 s17, s59, 81920
    s_add_u32 s59, s45, 1
    s_and_b32 s59, s59, 3
    s_mul_i32 s65, s59, 81920
    s_add_u32 s59, s45, 2
    s_and_b32 s59, s59, 3
    s_mul_i32 s66, s59, 81920
    s_add_u32 s59, s45, 3
    s_and_b32 s59, s59, 3
    s_mul_i32 s67, s59, 81920
    s_mov_b32 s4, s34
    s_mov_b32 s5, s35
    s_mov_b32 s6, 1047808
    s_mov_b32 s7, 0x20000
    s_add_u32 s59, s45, 0
    s_and_b32 s59, s59, 3
    s_lshl_b32 s59, s59, 1
    s_add_u32 s59, s59, s48
    s_lshl_b32 s59, s59, 3
    s_add_u32 s59, s59, s49
    s_lshl_b32 s68, s59, 14
    s_add_u32 s59, s45, 1
    s_and_b32 s59, s59, 3
    s_lshl_b32 s59, s59, 1
    s_add_u32 s59, s59, s48
    s_lshl_b32 s59, s59, 3
    s_add_u32 s59, s59, s49
    s_lshl_b32 s70, s59, 14
    s_add_u32 s59, s45, 2
    s_and_b32 s59, s59, 3
    s_lshl_b32 s59, s59, 1
    s_add_u32 s59, s59, s48
    s_lshl_b32 s59, s59, 3
    s_add_u32 s59, s59, s49
    s_lshl_b32 s71, s59, 14
    s_add_u32 s59, s45, 3
    s_and_b32 s59, s59, 3
    s_lshl_b32 s59, s59, 1
    s_add_u32 s59, s59, s48
    s_lshl_b32 s59, s59, 3
    s_add_u32 s59, s59, s49
    s_lshl_b32 s72, s59, 14
    s_lshl_b32 s59, s48, 1
    s_add_u32 s59, s59, s49
    s_mul_i32 s69, s59, 4352
    v_add_u32 v2, s100, v196
    s_add_u32 s59, s79, 52224
    s_xor_b32 s78, s59, 128
    v_add_u32 v184, s59, v182
    v_add_u32 v185, s59, v183
    v_add_u32 v186, s78, v182
    v_add_u32 v187, s78, v183
    s_waitcnt lgkmcnt(14)
    v_mfma_f32_16x16x32_bf16 v[4:7], v[148:151], v[100:103], 0
    v_mfma_f32_16x16x32_bf16 v[36:39], v[148:151], v[104:107], 0
    ds_read_b64_tr_b16 v[68:69], v184 offset:0
    ds_read_b64_tr_b16 v[70:71], v184 offset:4352
    buffer_store_dwordx4 v[116:119], v196, s[12:15], s17 offen offset:2048 sc1
    s_waitcnt lgkmcnt(14)
    v_mfma_f32_16x16x32_bf16 v[8:11], v[152:155], v[100:103], 0
    v_mfma_f32_16x16x32_bf16 v[40:43], v[152:155], v[104:107], 0
    ds_read_b64_tr_b16 v[72:73], v185 offset:0
    ds_read_b64_tr_b16 v[74:75], v185 offset:4352
    s_add_u32 m0, s69, 139264
    s_add_u32 s16, s68, 98304
    buffer_load_dwordx4 v217, s[4:7], s16 offen lds
    buffer_store_dwordx4 v[120:123], v197, s[12:15], s17 offen offset:2048 sc1
    s_waitcnt lgkmcnt(14)
    v_mfma_f32_16x16x32_bf16 v[12:15], v[156:159], v[100:103], 0
    v_mfma_f32_16x16x32_bf16 v[44:47], v[156:159], v[104:107], 0
    ds_read_b64_tr_b16 v[76:77], v184 offset:64
    ds_read_b64_tr_b16 v[78:79], v184 offset:4416
    buffer_store_dwordx4 v[124:127], v196, s[12:15], s17 offen offset:3072 sc1
    s_waitcnt lgkmcnt(14)
    v_mfma_f32_16x16x32_bf16 v[16:19], v[160:163], v[100:103], 0
    v_mfma_f32_16x16x32_bf16 v[48:51], v[160:163], v[104:107], 0
    ds_read_b64_tr_b16 v[80:81], v185 offset:64
    ds_read_b64_tr_b16 v[82:83], v185 offset:4416
    s_add_u32 m0, s69, 140352
    s_add_u32 s16, s68, 99328
    buffer_load_dwordx4 v217, s[4:7], s16 offen lds
    buffer_store_dwordx4 v[128:131], v197, s[12:15], s17 offen offset:3072 sc1
    s_waitcnt lgkmcnt(14)
    v_mfma_f32_16x16x32_bf16 v[20:23], v[164:167], v[100:103], 0
    v_mfma_f32_16x16x32_bf16 v[52:55], v[164:167], v[104:107], 0
    ds_read_b64_tr_b16 v[84:85], v186 offset:0
    ds_read_b64_tr_b16 v[86:87], v186 offset:4352
    s_waitcnt lgkmcnt(14)
    v_mfma_f32_16x16x32_bf16 v[24:27], v[168:171], v[100:103], 0
    v_mfma_f32_16x16x32_bf16 v[56:59], v[168:171], v[104:107], 0
    ds_read_b64_tr_b16 v[88:89], v187 offset:0
    ds_read_b64_tr_b16 v[90:91], v187 offset:4352
    s_add_u32 m0, s69, 141440
    s_add_u32 s16, s68, 100352
    buffer_load_dwordx4 v217, s[4:7], s16 offen lds
    s_waitcnt lgkmcnt(14)
    v_mfma_f32_16x16x32_bf16 v[28:31], v[172:175], v[100:103], 0
    v_mfma_f32_16x16x32_bf16 v[60:63], v[172:175], v[104:107], 0
    ds_read_b64_tr_b16 v[92:93], v186 offset:64
    ds_read_b64_tr_b16 v[94:95], v186 offset:4416
    s_waitcnt lgkmcnt(14)
    v_mfma_f32_16x16x32_bf16 v[32:35], v[176:179], v[100:103], 0
    v_mfma_f32_16x16x32_bf16 v[64:67], v[176:179], v[104:107], 0
    ds_read_b64_tr_b16 v[96:97], v187 offset:64
    ds_read_b64_tr_b16 v[98:99], v187 offset:4416
    s_add_u32 m0, s69, 142528
    s_add_u32 s16, s68, 101376
    buffer_load_dwordx4 v217, s[4:7], s16 offen lds
    s_add_u32 s59, s79, 87040
    s_xor_b32 s78, s59, 128
    v_add_u32 v184, s59, v182
    v_add_u32 v185, s59, v183
    v_add_u32 v186, s78, v182
    v_add_u32 v187, s78, v183
    s_waitcnt vmcnt(12)
    s_barrier
    s_waitcnt lgkmcnt(4)
    v_mfma_f32_16x16x32_bf16 v[4:7], v[68:71], v[108:111], v[4:7]
    v_mfma_f32_16x16x32_bf16 v[36:39], v[68:71], v[112:115], v[36:39]
    ds_read_b64_tr_b16 v[148:149], v184 offset:0
    ds_read_b64_tr_b16 v[150:151], v184 offset:4352
    v_mfma_f32_16x16x32_bf16 v[8:11], v[72:75], v[108:111], v[8:11]
    v_mfma_f32_16x16x32_bf16 v[40:43], v[72:75], v[112:115], v[40:43]
    ds_read_b64_tr_b16 v[152:153], v185 offset:0
    ds_read_b64_tr_b16 v[154:155], v185 offset:4352
    s_add_u32 m0, s69, 0
    s_add_u32 s16, s70, 0
    buffer_load_dwordx4 v217, s[4:7], s16 offen lds
    v_mfma_f32_16x16x32_bf16 v[12:15], v[76:79], v[108:111], v[12:15]
    v_mfma_f32_16x16x32_bf16 v[44:47], v[76:79], v[112:115], v[44:47]
    ds_read_b64_tr_b16 v[156:157], v184 offset:64
    ds_read_b64_tr_b16 v[158:159], v184 offset:4416
    v_mfma_f32_16x16x32_bf16 v[16:19], v[80:83], v[108:111], v[16:19]
    v_mfma_f32_16x16x32_bf16 v[48:51], v[80:83], v[112:115], v[48:51]
    ds_read_b64_tr_b16 v[160:161], v185 offset:64
    ds_read_b64_tr_b16 v[162:163], v185 offset:4416
    s_add_u32 m0, s69, 1088
    s_add_u32 s16, s70, 1024
    buffer_load_dwordx4 v217, s[4:7], s16 offen lds
    v_mfma_f32_16x16x32_bf16 v[20:23], v[84:87], v[108:111], v[20:23]
    v_mfma_f32_16x16x32_bf16 v[52:55], v[84:87], v[112:115], v[52:55]
    ds_read_b64_tr_b16 v[164:165], v186 offset:0
    ds_read_b64_tr_b16 v[166:167], v186 offset:4352
    v_mfma_f32_16x16x32_bf16 v[24:27], v[88:91], v[108:111], v[24:27]
    v_mfma_f32_16x16x32_bf16 v[56:59], v[88:91], v[112:115], v[56:59]
    ds_read_b64_tr_b16 v[168:169], v187 offset:0
    ds_read_b64_tr_b16 v[170:171], v187 offset:4352
    s_add_u32 m0, s69, 2176
    s_add_u32 s16, s70, 2048
    buffer_load_dwordx4 v217, s[4:7], s16 offen lds
    s_waitcnt lgkmcnt(14)
    v_mfma_f32_16x16x32_bf16 v[28:31], v[92:95], v[108:111], v[28:31]
    v_mfma_f32_16x16x32_bf16 v[60:63], v[92:95], v[112:115], v[60:63]
    ds_read_b64_tr_b16 v[172:173], v186 offset:64
    ds_read_b64_tr_b16 v[174:175], v186 offset:4416
    s_waitcnt lgkmcnt(14)
    v_mfma_f32_16x16x32_bf16 v[32:35], v[96:99], v[108:111], v[32:35]
    v_mfma_f32_16x16x32_bf16 v[64:67], v[96:99], v[112:115], v[64:67]
    ds_read_b64_tr_b16 v[176:177], v187 offset:64
    ds_read_b64_tr_b16 v[178:179], v187 offset:4416
    s_add_u32 m0, s69, 3264
    s_add_u32 s16, s70, 3072
    buffer_load_dwordx4 v217, s[4:7], s16 offen lds
    s_add_u32 s59, s79, 139264
    s_xor_b32 s78, s59, 128
    v_add_u32 v184, s59, v182
    v_add_u32 v185, s59, v183
    v_add_u32 v186, s78, v182
    v_add_u32 v187, s78, v183
    s_waitcnt vmcnt(4)
    s_barrier
    s_waitcnt lgkmcnt(4)
    v_mfma_f32_16x16x32_bf16 v[4:7], v[148:151], v[116:119], v[4:7]
    v_mfma_f32_16x16x32_bf16 v[36:39], v[148:151], v[120:123], v[36:39]
    ds_read_b64_tr_b16 v[68:69], v184 offset:0
    ds_read_b64_tr_b16 v[70:71], v184 offset:4352
    v_mfma_f32_16x16x32_bf16 v[8:11], v[152:155], v[116:119], v[8:11]
    v_mfma_f32_16x16x32_bf16 v[40:43], v[152:155], v[120:123], v[40:43]
    ds_read_b64_tr_b16 v[72:73], v185 offset:0
    ds_read_b64_tr_b16 v[74:75], v185 offset:4352
    s_add_u32 m0, s69, 17408
    s_add_u32 s16, s70, 32768
    buffer_load_dwordx4 v217, s[4:7], s16 offen lds
    v_mfma_f32_16x16x32_bf16 v[12:15], v[156:159], v[116:119], v[12:15]
    v_mfma_f32_16x16x32_bf16 v[44:47], v[156:159], v[120:123], v[44:47]
    ds_read_b64_tr_b16 v[76:77], v184 offset:64
    ds_read_b64_tr_b16 v[78:79], v184 offset:4416
    v_mfma_f32_16x16x32_bf16 v[16:19], v[160:163], v[116:119], v[16:19]
    v_mfma_f32_16x16x32_bf16 v[48:51], v[160:163], v[120:123], v[48:51]
    ds_read_b64_tr_b16 v[80:81], v185 offset:64
    ds_read_b64_tr_b16 v[82:83], v185 offset:4416
    s_add_u32 m0, s69, 18496
    s_add_u32 s16, s70, 33792
    buffer_load_dwordx4 v217, s[4:7], s16 offen lds
    v_mfma_f32_16x16x32_bf16 v[20:23], v[164:167], v[116:119], v[20:23]
    v_mfma_f32_16x16x32_bf16 v[52:55], v[164:167], v[120:123], v[52:55]
    ds_read_b64_tr_b16 v[84:85], v186 offset:0
    ds_read_b64_tr_b16 v[86:87], v186 offset:4352
    v_mfma_f32_16x16x32_bf16 v[24:27], v[168:171], v[116:119], v[24:27]
    v_mfma_f32_16x16x32_bf16 v[56:59], v[168:171], v[120:123], v[56:59]
    ds_read_b64_tr_b16 v[88:89], v187 offset:0
    ds_read_b64_tr_b16 v[90:91], v187 offset:4352
    s_add_u32 m0, s69, 19584
    s_add_u32 s16, s70, 34816
    buffer_load_dwordx4 v217, s[4:7], s16 offen lds
    s_waitcnt lgkmcnt(14)
    v_mfma_f32_16x16x32_bf16 v[28:31], v[172:175], v[116:119], v[28:31]
    v_mfma_f32_16x16x32_bf16 v[60:63], v[172:175], v[120:123], v[60:63]
    ds_read_b64_tr_b16 v[92:93], v186 offset:64
    ds_read_b64_tr_b16 v[94:95], v186 offset:4416
    s_waitcnt lgkmcnt(14)
    v_mfma_f32_16x16x32_bf16 v[32:35], v[176:179], v[116:119], v[32:35]
    v_mfma_f32_16x16x32_bf16 v[64:67], v[176:179], v[120:123], v[64:67]
    ds_read_b64_tr_b16 v[96:97], v187 offset:64
    ds_read_b64_tr_b16 v[98:99], v187 offset:4416
    s_add_u32 m0, s69, 20672
    s_add_u32 s16, s70, 35840
    buffer_load_dwordx4 v217, s[4:7], s16 offen lds
    s_add_u32 s59, s79, 0
    s_xor_b32 s78, s59, 128
    v_add_u32 v184, s59, v182
    v_add_u32 v185, s59, v183
    v_add_u32 v186, s78, v182
    v_add_u32 v187, s78, v183
    s_waitcnt vmcnt(4)
    s_barrier
    s_cmp_lg_u32 s3, 4
    s_cbranch_scc1 L_nopolla
    v_mov_b32 v208, 2
    s_mov_b64 exec, 1
    buffer_store_dword v208, off, s[20:23], s75 sc1
    s_mov_b64 exec, -1
    v_and_b32 v209, 3, v0
    v_lshlrev_b32 v209, 7, v209
    s_lshl_b32 s73, s43, 9
    s_mov_b32 s78, 0
L_polla:
    buffer_load_dword v208, v209, s[20:23], s73 offen sc1
    s_add_u32 s78, s78, 1
    s_waitcnt vmcnt(0)
L_checka:
    v_cmp_le_u32 vcc, 2, v208
    s_nop 0
    s_cmp_eq_u64 vcc, -1
    s_cbranch_scc1 L_donea
    s_sleep 4
    s_cmp_lt_u32 s78, 0x10000
    s_cbranch_scc1 L_polla
L_donea:
L_nopolla:
    s_barrier
    buffer_load_dwordx4 v[100:103], v196, s[12:15], s65 offen offset:0 sc1
    buffer_load_dwordx4 v[104:107], v197, s[12:15], s65 offen offset:0 sc1
    buffer_load_dwordx4 v[108:111], v196, s[12:15], s65 offen offset:1024 sc1
    buffer_load_dwordx4 v[112:115], v197, s[12:15], s65 offen offset:1024 sc1
    s_waitcnt lgkmcnt(4)
    v_mfma_f32_16x16x32_bf16 v[4:7], v[68:71], v[124:127], v[4:7]
    v_mfma_f32_16x16x32_bf16 v[36:39], v[68:71], v[128:131], v[36:39]
    ds_read_b64_tr_b16 v[148:149], v184 offset:0
    ds_read_b64_tr_b16 v[150:151], v184 offset:4352
    v_mfma_f32_16x16x32_bf16 v[8:11], v[72:75], v[124:127], v[8:11]
    v_mfma_f32_16x16x32_bf16 v[40:43], v[72:75], v[128:131], v[40:43]
    ds_read_b64_tr_b16 v[152:153], v185 offset:0
    ds_read_b64_tr_b16 v[154:155], v185 offset:4352
    s_add_u32 m0, s69, 69632
    s_add_u32 s16, s70, 65536
    buffer_load_dwordx4 v217, s[4:7], s16 offen lds
    v_mfma_f32_16x16x32_bf16 v[12:15], v[76:79], v[124:127], v[12:15]
    v_mfma_f32_16x16x32_bf16 v[44:47], v[76:79], v[128:131], v[44:47]
    ds_read_b64_tr_b16 v[156:157], v184 offset:64
    ds_read_b64_tr_b16 v[158:159], v184 offset:4416
    v_mfma_f32_16x16x32_bf16 v[16:19], v[80:83], v[124:127], v[16:19]
    v_mfma_f32_16x16x32_bf16 v[48:51], v[80:83], v[128:131], v[48:51]
    ds_read_b64_tr_b16 v[160:161], v185 offset:64
    ds_read_b64_tr_b16 v[162:163], v185 offset:4416
    s_add_u32 m0, s69, 70720
    s_add_u32 s16, s70, 66560
    buffer_load_dwordx4 v217, s[4:7], s16 offen lds
    v_mfma_f32_16x16x32_bf16 v[20:23], v[84:87], v[124:127], v[20:23]
    v_mfma_f32_16x16x32_bf16 v[52:55], v[84:87], v[128:131], v[52:55]
    ds_read_b64_tr_b16 v[164:165], v186 offset:0
    ds_read_b64_tr_b16 v[166:167], v186 offset:4352
    v_mfma_f32_16x16x32_bf16 v[24:27], v[88:91], v[124:127], v[24:27]
    v_mfma_f32_16x16x32_bf16 v[56:59], v[88:91], v[128:131], v[56:59]
    ds_read_b64_tr_b16 v[168:169], v187 offset:0
    ds_read_b64_tr_b16 v[170:171], v187 offset:4352
    s_add_u32 m0, s69, 71808
    s_add_u32 s16, s70, 67584
    buffer_load_dwordx4 v217, s[4:7], s16 offen lds
    s_waitcnt lgkmcnt(14)
    v_mfma_f32_16x16x32_bf16 v[28:31], v[92:95], v[124:127], v[28:31]
    v_mfma_f32_16x16x32_bf16 v[60:63], v[92:95], v[128:131], v[60:63]
    ds_read_b64_tr_b16 v[172:173], v186 offset:64
    ds_read_b64_tr_b16 v[174:175], v186 offset:4416
    s_waitcnt lgkmcnt(14)
    v_mfma_f32_16x16x32_bf16 v[32:35], v[96:99], v[124:127], v[32:35]
    v_mfma_f32_16x16x32_bf16 v[64:67], v[96:99], v[128:131], v[64:67]
    ds_read_b64_tr_b16 v[176:177], v187 offset:64
    ds_read_b64_tr_b16 v[178:179], v187 offset:4416
    s_add_u32 m0, s69, 72896
    s_add_u32 s16, s70, 68608
    buffer_load_dwordx4 v217, s[4:7], s16 offen lds
    s_add_u32 s59, s79, 17408
    s_xor_b32 s78, s59, 128
    v_add_u32 v184, s59, v182
    v_add_u32 v185, s59, v183
    v_add_u32 v186, s78, v182
    v_add_u32 v187, s78, v183
    s_waitcnt vmcnt(8)
    s_barrier
    s_waitcnt vmcnt(6)
    s_waitcnt lgkmcnt(4)
    v_mfma_f32_16x16x32_bf16 v[4:7], v[148:151], v[100:103], v[4:7]
    v_mfma_f32_16x16x32_bf16 v[36:39], v[148:151], v[104:107], v[36:39]
    ds_read_b64_tr_b16 v[68:69], v184 offset:0
    ds_read_b64_tr_b16 v[70:71], v184 offset:4352
    v_mfma_f32_16x16x32_bf16 v[8:11], v[152:155], v[100:103], v[8:11]
    v_mfma_f32_16x16x32_bf16 v[40:43], v[152:155], v[104:107], v[40:43]
    ds_read_b64_tr_b16 v[72:73], v185 offset:0
    ds_read_b64_tr_b16 v[74:75], v185 offset:4352
    s_add_u32 m0, s69, 104448
    s_add_u32 s16, s70, 98304
    buffer_load_dwordx4 v217, s[4:7], s16 offen lds
    v_mfma_f32_16x16x32_bf16 v[12:15], v[156:159], v[100:103], v[12:15]
    v_mfma_f32_16x16x32_bf16 v[44:47], v[156:159], v[104:107], v[44:47]
    ds_read_b64_tr_b16 v[76:77], v184 offset:64
    ds_read_b64_tr_b16 v[78:79], v184 offset:4416
    v_mfma_f32_16x16x32_bf16 v[16:19], v[160:163], v[100:103], v[16:19]
    v_mfma_f32_16x16x32_bf16 v[48:51], v[160:163], v[104:107], v[48:51]
    ds_read_b64_tr_b16 v[80:81], v185 offset:64
    ds_read_b64_tr_b16 v[82:83], v185 offset:4416
    s_add_u32 m0, s69, 105536
    s_add_u32 s16, s70, 99328
    buffer_load_dwordx4 v217, s[4:7], s16 offen lds
    v_mfma_f32_16x16x32_bf16 v[20:23], v[164:167], v[100:103], v[20:23]
    v_mfma_f32_16x16x32_bf16 v[52:55], v[164:167], v[104:107], v[52:55]
    ds_read_b64_tr_b16 v[84:85], v186 offset:0
    ds_read_b64_tr_b16 v[86:87], v186 offset:4352
    v_mfma_f32_16x16x32_bf16 v[24:27], v[168:171], v[100:103], v[24:27]
    v_mfma_f32_16x16x32_bf16 v[56:59], v[168:171], v[104:107], v[56:59]
    ds_read_b64_tr_b16 v[88:89], v187 offset:0
    ds_read_b64_tr_b16 v[90:91], v187 offset:4352
    s_add_u32 m0, s69, 106624
    s_add_u32 s16, s70, 100352
    buffer_load_dwordx4 v217, s[4:7], s16 offen lds
    s_waitcnt lgkmcnt(14)
    v_mfma_f32_16x16x32_bf16 v[28:31], v[172:175], v[100:103], v[28:31]
    v_mfma_f32_16x16x32_bf16 v[60:63], v[172:175], v[104:107], v[60:63]
    ds_read_b64_tr_b16 v[92:93], v186 offset:64
    ds_read_b64_tr_b16 v[94:95], v186 offset:4416
    s_waitcnt lgkmcnt(14)
    v_mfma_f32_16x16x32_bf16 v[32:35], v[176:179], v[100:103], v[32:35]
    v_mfma_f32_16x16x32_bf16 v[64:67], v[176:179], v[104:107], v[64:67]
    ds_read_b64_tr_b16 v[96:97], v187 offset:64
    ds_read_b64_tr_b16 v[98:99], v187 offset:4416
    s_add_u32 m0, s69, 107712
    s_add_u32 s16, s70, 101376
    buffer_load_dwordx4 v217, s[4:7], s16 offen lds
    s_add_u32 s59, s79, 69632
    s_xor_b32 s78, s59, 128
    v_add_u32 v184, s59, v182
    v_add_u32 v185, s59, v183
    v_add_u32 v186, s78, v182
    v_add_u32 v187, s78, v183
    s_waitcnt vmcnt(4)
    s_barrier
    buffer_load_dwordx4 v[116:119], v196, s[12:15], s65 offen offset:2048 sc1
    buffer_load_dwordx4 v[120:123], v197, s[12:15], s65 offen offset:2048 sc1
    s_waitcnt lgkmcnt(4)
    v_mfma_f32_16x16x32_bf16 v[4:7], v[68:71], v[108:111], v[4:7]
    v_mfma_f32_16x16x32_bf16 v[36:39], v[68:71], v[112:115], v[36:39]
    ds_read_b64_tr_b16 v[148:149], v184 offset:0
    ds_read_b64_tr_b16 v[150:151], v184 offset:4352
    v_mfma_f32_16x16x32_bf16 v[8:11], v[72:75], v[108:111], v[8:11]
    v_mfma_f32_16x16x32_bf16 v[40:43], v[72:75], v[112:115], v[40:43]
    ds_read_b64_tr_b16 v[152:153], v185 offset:0
    ds_read_b64_tr_b16 v[154:155], v185 offset:4352
    s_add_u32 m0, s69, 121856
    s_add_u32 s16, s71, 0
    buffer_load_dwordx4 v217, s[4:7], s16 offen lds
    v_mfma_f32_16x16x32_bf16 v[12:15], v[76:79], v[108:111], v[12:15]
    v_mfma_f32_16x16x32_bf16 v[44:47], v[76:79], v[112:115], v[44:47]
    ds_read_b64_tr_b16 v[156:157], v184 offset:64
    ds_read_b64_tr_b16 v[158:159], v184 offset:4416
    v_mfma_f32_16x16x32_bf16 v[16:19], v[80:83], v[108:111], v[16:19]
    v_mfma_f32_16x16x32_bf16 v[48:51], v[80:83], v[112:115], v[48:51]
    ds_read_b64_tr_b16 v[160:161], v185 offset:64
    ds_read_b64_tr_b16 v[162:163], v185 offset:4416
    s_add_u32 m0, s69, 122944
    s_add_u32 s16, s71, 1024
    buffer_load_dwordx4 v217, s[4:7], s16 offen lds
    v_mfma_f32_16x16x32_bf16 v[20:23], v[84:87], v[108:111], v[20:23]
    v_mfma_f32_16x16x32_bf16 v[52:55], v[84:87], v[112:115], v[52:55]
    ds_read_b64_tr_b16 v[164:165], v186 offset:0
    ds_read_b64_tr_b16 v[166:167], v186 offset:4352
    v_mfma_f32_16x16x32_bf16 v[24:27], v[88:91], v[108:111], v[24:27]
    v_mfma_f32_16x16x32_bf16 v[56:59], v[88:91], v[112:115], v[56:59]
    ds_read_b64_tr_b16 v[168:169], v187 offset:0
    ds_read_b64_tr_b16 v[170:171], v187 offset:4352
    s_add_u32 m0, s69, 124032
    s_add_u32 s16, s71, 2048
    buffer_load_dwordx4 v217, s[4:7], s16 offen lds
    s_waitcnt lgkmcnt(14)
    v_mfma_f32_16x16x32_bf16 v[28:31], v[92:95], v[108:111], v[28:31]
    v_mfma_f32_16x16x32_bf16 v[60:63], v[92:95], v[112:115], v[60:63]
    ds_read_b64_tr_b16 v[172:173], v186 offset:64
    ds_read_b64_tr_b16 v[174:175], v186 offset:4416
    s_waitcnt lgkmcnt(14)
    v_mfma_f32_16x16x32_bf16 v[32:35], v[96:99], v[108:111], v[32:35]
    v_mfma_f32_16x16x32_bf16 v[64:67], v[96:99], v[112:115], v[64:67]
    ds_read_b64_tr_b16 v[176:177], v187 offset:64
    ds_read_b64_tr_b16 v[178:179], v187 offset:4416
    s_add_u32 m0, s69, 125120
    s_add_u32 s16, s71, 3072
    buffer_load_dwordx4 v217, s[4:7], s16 offen lds
    s_add_u32 s59, s79, 104448
    s_xor_b32 s78, s59, 128
    v_add_u32 v184, s59, v182
    v_add_u32 v185, s59, v183
    v_add_u32 v186, s78, v182
    v_add_u32 v187, s78, v183
    s_waitcnt vmcnt(6)
    s_barrier
    buffer_load_dwordx4 v[124:127], v196, s[12:15], s65 offen offset:3072 sc1
    buffer_load_dwordx4 v[128:131], v197, s[12:15], s65 offen offset:3072 sc1
    s_waitcnt vmcnt(6)
    s_waitcnt lgkmcnt(4)
    v_mfma_f32_16x16x32_bf16 v[4:7], v[148:151], v[116:119], v[4:7]
    v_mfma_f32_16x16x32_bf16 v[36:39], v[148:151], v[120:123], v[36:39]
    ds_read_b64_tr_b16 v[68:69], v184 offset:0
    ds_read_b64_tr_b16 v[70:71], v184 offset:4352
    v_mfma_f32_16x16x32_bf16 v[8:11], v[152:155], v[116:119], v[8:11]
    v_mfma_f32_16x16x32_bf16 v[40:43], v[152:155], v[120:123], v[40:43]
    ds_read_b64_tr_b16 v[72:73], v185 offset:0
    ds_read_b64_tr_b16 v[74:75], v185 offset:4352
    s_add_u32 m0, s69, 34816
    s_add_u32 s16, s71, 32768
    buffer_load_dwordx4 v217, s[4:7], s16 offen lds
    v_mfma_f32_16x16x32_bf16 v[12:15], v[156:159], v[116:119], v[12:15]
    v_mfma_f32_16x16x32_bf16 v[44:47], v[156:159], v[120:123], v[44:47]
    ds_read_b64_tr_b16 v[76:77], v184 offset:64
    ds_read_b64_tr_b16 v[78:79], v184 offset:4416
    v_mfma_f32_16x16x32_bf16 v[16:19], v[160:163], v[116:119], v[16:19]
    v_mfma_f32_16x16x32_bf16 v[48:51], v[160:163], v[120:123], v[48:51]
    ds_read_b64_tr_b16 v[80:81], v185 offset:64
    ds_read_b64_tr_b16 v[82:83], v185 offset:4416
    s_add_u32 m0, s69, 35904
    s_add_u32 s16, s71, 33792
    buffer_load_dwordx4 v217, s[4:7], s16 offen lds
    v_mfma_f32_16x16x32_bf16 v[20:23], v[164:167], v[116:119], v[20:23]
    v_mfma_f32_16x16x32_bf16 v[52:55], v[164:167], v[120:123], v[52:55]
    ds_read_b64_tr_b16 v[84:85], v186 offset:0
    ds_read_b64_tr_b16 v[86:87], v186 offset:4352
    v_mfma_f32_16x16x32_bf16 v[24:27], v[168:171], v[116:119], v[24:27]
    v_mfma_f32_16x16x32_bf16 v[56:59], v[168:171], v[120:123], v[56:59]
    ds_read_b64_tr_b16 v[88:89], v187 offset:0
    ds_read_b64_tr_b16 v[90:91], v187 offset:4352
    s_add_u32 m0, s69, 36992
    s_add_u32 s16, s71, 34816
    buffer_load_dwordx4 v217, s[4:7], s16 offen lds
    s_waitcnt lgkmcnt(14)
    v_mfma_f32_16x16x32_bf16 v[28:31], v[172:175], v[116:119], v[28:31]
    v_mfma_f32_16x16x32_bf16 v[60:63], v[172:175], v[120:123], v[60:63]
    ds_read_b64_tr_b16 v[92:93], v186 offset:64
    ds_read_b64_tr_b16 v[94:95], v186 offset:4416
    s_waitcnt lgkmcnt(14)
    v_mfma_f32_16x16x32_bf16 v[32:35], v[176:179], v[116:119], v[32:35]
    v_mfma_f32_16x16x32_bf16 v[64:67], v[176:179], v[120:123], v[64:67]
    ds_read_b64_tr_b16 v[96:97], v187 offset:64
    ds_read_b64_tr_b16 v[98:99], v187 offset:4416
    s_add_u32 m0, s69, 38080
    s_add_u32 s16, s71, 35840
    buffer_load_dwordx4 v217, s[4:7], s16 offen lds
    s_add_u32 s59, s79, 121856
    s_xor_b32 s78, s59, 128
    v_add_u32 v184, s59, v182
    v_add_u32 v185, s59, v183
    v_add_u32 v186, s78, v182
    v_add_u32 v187, s78, v183
    s_waitcnt vmcnt(6)
    s_barrier
    buffer_load_dwordx4 v[100:103], v196, s[12:15], s66 offen offset:0 sc1
    buffer_load_dwordx4 v[104:107], v197, s[12:15], s66 offen offset:0 sc1
    s_waitcnt vmcnt(6)
    s_waitcnt lgkmcnt(4)
    v_mfma_f32_16x16x32_bf16 v[4:7], v[68:71], v[124:127], v[4:7]
    v_mfma_f32_16x16x32_bf16 v[36:39], v[68:71], v[128:131], v[36:39]
    ds_read_b64_tr_b16 v[148:149], v184 offset:0
    ds_read_b64_tr_b16 v[150:151], v184 offset:4352
    v_mfma_f32_16x16x32_bf16 v[8:11], v[72:75], v[124:127], v[8:11]
    v_mfma_f32_16x16x32_bf16 v[40:43], v[72:75], v[128:131], v[40:43]
    ds_read_b64_tr_b16 v[152:153], v185 offset:0
    ds_read_b64_tr_b16 v[154:155], v185 offset:4352
    s_add_u32 m0, s69, 52224
    s_add_u32 s16, s71, 65536
    buffer_load_dwordx4 v217, s[4:7], s16 offen lds
    v_mfma_f32_16x16x32_bf16 v[12:15], v[76:79], v[124:127], v[12:15]
    v_mfma_f32_16x16x32_bf16 v[44:47], v[76:79], v[128:131], v[44:47]
    ds_read_b64_tr_b16 v[156:157], v184 offset:64
    ds_read_b64_tr_b16 v[158:159], v184 offset:4416
    v_mfma_f32_16x16x32_bf16 v[16:19], v[80:83], v[124:127], v[16:19]
    v_mfma_f32_16x16x32_bf16 v[48:51], v[80:83], v[128:131], v[48:51]
    ds_read_b64_tr_b16 v[160:161], v185 offset:64
    ds_read_b64_tr_b16 v[162:163], v185 offset:4416
    s_add_u32 m0, s69, 53312
    s_add_u32 s16, s71, 66560
    buffer_load_dwordx4 v217, s[4:7], s16 offen lds
    v_mfma_f32_16x16x32_bf16 v[20:23], v[84:87], v[124:127], v[20:23]
    v_mfma_f32_16x16x32_bf16 v[52:55], v[84:87], v[128:131], v[52:55]
    ds_read_b64_tr_b16 v[164:165], v186 offset:0
    ds_read_b64_tr_b16 v[166:167], v186 offset:4352
    v_mfma_f32_16x16x32_bf16 v[24:27], v[88:91], v[124:127], v[24:27]
    v_mfma_f32_16x16x32_bf16 v[56:59], v[88:91], v[128:131], v[56:59]
    ds_read_b64_tr_b16 v[168:169], v187 offset:0
    ds_read_b64_tr_b16 v[170:171], v187 offset:4352
    s_add_u32 m0, s69, 54400
    s_add_u32 s16, s71, 67584
    buffer_load_dwordx4 v217, s[4:7], s16 offen lds
    s_waitcnt lgkmcnt(14)
    v_mfma_f32_16x16x32_bf16 v[28:31], v[92:95], v[124:127], v[28:31]
    v_mfma_f32_16x16x32_bf16 v[60:63], v[92:95], v[128:131], v[60:63]
    ds_read_b64_tr_b16 v[172:173], v186 offset:64
    ds_read_b64_tr_b16 v[174:175], v186 offset:4416
    s_waitcnt lgkmcnt(14)
    v_mfma_f32_16x16x32_bf16 v[32:35], v[96:99], v[124:127], v[32:35]
    v_mfma_f32_16x16x32_bf16 v[64:67], v[96:99], v[128:131], v[64:67]
    ds_read_b64_tr_b16 v[176:177], v187 offset:64
    ds_read_b64_tr_b16 v[178:179], v187 offset:4416
    s_add_u32 m0, s69, 55488
    s_add_u32 s16, s71, 68608
    buffer_load_dwordx4 v217, s[4:7], s16 offen lds
    s_add_u32 s59, s79, 34816
    s_xor_b32 s78, s59, 128
    v_add_u32 v184, s59, v182
    v_add_u32 v185, s59, v183
    v_add_u32 v186, s78, v182
    v_add_u32 v187, s78, v183
    s_waitcnt vmcnt(6)
    s_barrier
    buffer_load_dwordx4 v[108:111], v196, s[12:15], s66 offen offset:1024 sc1
    buffer_load_dwordx4 v[112:115], v197, s[12:15], s66 offen offset:1024 sc1
    s_waitcnt vmcnt(6)
    s_waitcnt lgkmcnt(4)
    v_mfma_f32_16x16x32_bf16 v[4:7], v[148:151], v[100:103], v[4:7]
    v_mfma_f32_16x16x32_bf16 v[36:39], v[148:151], v[104:107], v[36:39]
    ds_read_b64_tr_b16 v[68:69], v184 offset:0
    ds_read_b64_tr_b16 v[70:71], v184 offset:4352
    v_mfma_f32_16x16x32_bf16 v[8:11], v[152:155], v[100:103], v[8:11]
    v_mfma_f32_16x16x32_bf16 v[40:43], v[152:155], v[104:107], v[40:43]
    ds_read_b64_tr_b16 v[72:73], v185 offset:0
    ds_read_b64_tr_b16 v[74:75], v185 offset:4352
    s_add_u32 m0, s69, 87040
    s_add_u32 s16, s71, 98304
    buffer_load_dwordx4 v217, s[4:7], s16 offen lds
    v_mfma_f32_16x16x32_bf16 v[12:15], v[156:159], v[100:103], v[12:15]
    v_mfma_f32_16x16x32_bf16 v[44:47], v[156:159], v[104:107], v[44:47]
    ds_read_b64_tr_b16 v[76:77], v184 offset:64
    ds_read_b64_tr_b16 v[78:79], v184 offset:4416
    v_mfma_f32_16x16x32_bf16 v[16:19], v[160:163], v[100:103], v[16:19]
    v_mfma_f32_16x16x32_bf16 v[48:51], v[160:163], v[104:107], v[48:51]
    ds_read_b64_tr_b16 v[80:81], v185 offset:64
    ds_read_b64_tr_b16 v[82:83], v185 offset:4416
    s_add_u32 m0, s69, 88128
    s_add_u32 s16, s71, 99328
    buffer_load_dwordx4 v217, s[4:7], s16 offen lds
    v_mfma_f32_16x16x32_bf16 v[20:23], v[164:167], v[100:103], v[20:23]
    v_mfma_f32_16x16x32_bf16 v[52:55], v[164:167], v[104:107], v[52:55]
    ds_read_b64_tr_b16 v[84:85], v186 offset:0
    ds_read_b64_tr_b16 v[86:87], v186 offset:4352
    v_mfma_f32_16x16x32_bf16 v[24:27], v[168:171], v[100:103], v[24:27]
    v_mfma_f32_16x16x32_bf16 v[56:59], v[168:171], v[104:107], v[56:59]
    ds_read_b64_tr_b16 v[88:89], v187 offset:0
    ds_read_b64_tr_b16 v[90:91], v187 offset:4352
    s_add_u32 m0, s69, 89216
    s_add_u32 s16, s71, 100352
    buffer_load_dwordx4 v217, s[4:7], s16 offen lds
    s_waitcnt lgkmcnt(14)
    v_mfma_f32_16x16x32_bf16 v[28:31], v[172:175], v[100:103], v[28:31]
    v_mfma_f32_16x16x32_bf16 v[60:63], v[172:175], v[104:107], v[60:63]
    ds_read_b64_tr_b16 v[92:93], v186 offset:64
    ds_read_b64_tr_b16 v[94:95], v186 offset:4416
    s_waitcnt lgkmcnt(14)
    v_mfma_f32_16x16x32_bf16 v[32:35], v[176:179], v[100:103], v[32:35]
    v_mfma_f32_16x16x32_bf16 v[64:67], v[176:179], v[104:107], v[64:67]
    ds_read_b64_tr_b16 v[96:97], v187 offset:64
    ds_read_b64_tr_b16 v[98:99], v187 offset:4416
    s_add_u32 m0, s69, 90304
    s_add_u32 s16, s71, 101376
    buffer_load_dwordx4 v217, s[4:7], s16 offen lds
    s_add_u32 s59, s79, 52224
    s_xor_b32 s78, s59, 128
    v_add_u32 v184, s59, v182
    v_add_u32 v185, s59, v183
    v_add_u32 v186, s78, v182
    v_add_u32 v187, s78, v183
    s_waitcnt vmcnt(6)
    s_barrier
    buffer_load_dwordx4 v[116:119], v196, s[12:15], s66 offen offset:2048 sc1
    buffer_load_dwordx4 v[120:123], v197, s[12:15], s66 offen offset:2048 sc1
    s_waitcnt vmcnt(6)
    s_waitcnt lgkmcnt(4)
    v_mfma_f32_16x16x32_bf16 v[4:7], v[68:71], v[108:111], v[4:7]
    v_mfma_f32_16x16x32_bf16 v[36:39], v[68:71], v[112:115], v[36:39]
    ds_read_b64_tr_b16 v[148:149], v184 offset:0
    ds_read_b64_tr_b16 v[150:151], v184 offset:4352
    v_mfma_f32_16x16x32_bf16 v[8:11], v[72:75], v[108:111], v[8:11]
    v_mfma_f32_16x16x32_bf16 v[40:43], v[72:75], v[112:115], v[40:43]
    ds_read_b64_tr_b16 v[152:153], v185 offset:0
    ds_read_b64_tr_b16 v[154:155], v185 offset:4352
    s_add_u32 m0, s69, 139264
    s_add_u32 s16, s72, 0
    buffer_load_dwordx4 v217, s[4:7], s16 offen lds
    v_mfma_f32_16x16x32_bf16 v[12:15], v[76:79], v[108:111], v[12:15]
    v_mfma_f32_16x16x32_bf16 v[44:47], v[76:79], v[112:115], v[44:47]
    ds_read_b64_tr_b16 v[156:157], v184 offset:64
    ds_read_b64_tr_b16 v[158:159], v184 offset:4416
    v_mfma_f32_16x16x32_bf16 v[16:19], v[80:83], v[108:111], v[16:19]
    v_mfma_f32_16x16x32_bf16 v[48:51], v[80:83], v[112:115], v[48:51]
    ds_read_b64_tr_b16 v[160:161], v185 offset:64
    ds_read_b64_tr_b16 v[162:163], v185 offset:4416
    s_add_u32 m0, s69, 140352
    s_add_u32 s16, s72, 1024
    buffer_load_dwordx4 v217, s[4:7], s16 offen lds
    v_mfma_f32_16x16x32_bf16 v[20:23], v[84:87], v[108:111], v[20:23]
    v_mfma_f32_16x16x32_bf16 v[52:55], v[84:87], v[112:115], v[52:55]
    ds_read_b64_tr_b16 v[164:165], v186 offset:0
    ds_read_b64_tr_b16 v[166:167], v186 offset:4352
    v_mfma_f32_16x16x32_bf16 v[24:27], v[88:91], v[108:111], v[24:27]
    v_mfma_f32_16x16x32_bf16 v[56:59], v[88:91], v[112:115], v[56:59]
    ds_read_b64_tr_b16 v[168:169], v187 offset:0
    ds_read_b64_tr_b16 v[170:171], v187 offset:4352
    s_add_u32 m0, s69, 141440
    s_add_u32 s16, s72, 2048
    buffer_load_dwordx4 v217, s[4:7], s16 offen lds
    s_waitcnt lgkmcnt(14)
    v_mfma_f32_16x16x32_bf16 v[28:31], v[92:95], v[108:111], v[28:31]
    v_mfma_f32_16x16x32_bf16 v[60:63], v[92:95], v[112:115], v[60:63]
    ds_read_b64_tr_b16 v[172:173], v186 offset:64
    ds_read_b64_tr_b16 v[174:175], v186 offset:4416
    s_waitcnt lgkmcnt(14)
    v_mfma_f32_16x16x32_bf16 v[32:35], v[96:99], v[108:111], v[32:35]
    v_mfma_f32_16x16x32_bf16 v[64:67], v[96:99], v[112:115], v[64:67]
    ds_read_b64_tr_b16 v[176:177], v187 offset:64
    ds_read_b64_tr_b16 v[178:179], v187 offset:4416
    s_add_u32 m0, s69, 142528
    s_add_u32 s16, s72, 3072
    buffer_load_dwordx4 v217, s[4:7], s16 offen lds
    s_add_u32 s59, s79, 87040
    s_xor_b32 s78, s59, 128
    v_add_u32 v184, s59, v182
    v_add_u32 v185, s59, v183
    v_add_u32 v186, s78, v182
    v_add_u32 v187, s78, v183
    s_waitcnt vmcnt(6)
    s_barrier
    buffer_load_dwordx4 v[124:127], v196, s[12:15], s66 offen offset:3072 sc1
    buffer_load_dwordx4 v[128:131], v197, s[12:15], s66 offen offset:3072 sc1
    s_waitcnt vmcnt(6)
    s_waitcnt lgkmcnt(4)
    v_mfma_f32_16x16x32_bf16 v[4:7], v[148:151], v[116:119], v[4:7]
    v_mfma_f32_16x16x32_bf16 v[36:39], v[148:151], v[120:123], v[36:39]
    ds_read_b64_tr_b16 v[68:69], v184 offset:0
    ds_read_b64_tr_b16 v[70:71], v184 offset:4352
    v_mfma_f32_16x16x32_bf16 v[8:11], v[152:155], v[116:119], v[8:11]
    v_mfma_f32_16x16x32_bf16 v[40:43], v[152:155], v[120:123], v[40:43]
    ds_read_b64_tr_b16 v[72:73], v185 offset:0
    ds_read_b64_tr_b16 v[74:75], v185 offset:4352
    s_add_u32 m0, s69, 0
    s_add_u32 s16, s72, 32768
    buffer_load_dwordx4 v217, s[4:7], s16 offen lds
    v_mfma_f32_16x16x32_bf16 v[12:15], v[156:159], v[116:119], v[12:15]
    v_mfma_f32_16x16x32_bf16 v[44:47], v[156:159], v[120:123], v[44:47]
    ds_read_b64_tr_b16 v[76:77], v184 offset:64
    ds_read_b64_tr_b16 v[78:79], v184 offset:4416
    v_mfma_f32_16x16x32_bf16 v[16:19], v[160:163], v[116:119], v[16:19]
    v_mfma_f32_16x16x32_bf16 v[48:51], v[160:163], v[120:123], v[48:51]
    ds_read_b64_tr_b16 v[80:81], v185 offset:64
    ds_read_b64_tr_b16 v[82:83], v185 offset:4416
    s_add_u32 m0, s69, 1088
    s_add_u32 s16, s72, 33792
    buffer_load_dwordx4 v217, s[4:7], s16 offen lds
    v_mfma_f32_16x16x32_bf16 v[20:23], v[164:167], v[116:119], v[20:23]
    v_mfma_f32_16x16x32_bf16 v[52:55], v[164:167], v[120:123], v[52:55]
    ds_read_b64_tr_b16 v[84:85], v186 offset:0
    ds_read_b64_tr_b16 v[86:87], v186 offset:4352
    v_mfma_f32_16x16x32_bf16 v[24:27], v[168:171], v[116:119], v[24:27]
    v_mfma_f32_16x16x32_bf16 v[56:59], v[168:171], v[120:123], v[56:59]
    ds_read_b64_tr_b16 v[88:89], v187 offset:0
    ds_read_b64_tr_b16 v[90:91], v187 offset:4352
    s_add_u32 m0, s69, 2176
    s_add_u32 s16, s72, 34816
    buffer_load_dwordx4 v217, s[4:7], s16 offen lds
    s_waitcnt lgkmcnt(14)
    v_mfma_f32_16x16x32_bf16 v[28:31], v[172:175], v[116:119], v[28:31]
    v_mfma_f32_16x16x32_bf16 v[60:63], v[172:175], v[120:123], v[60:63]
    ds_read_b64_tr_b16 v[92:93], v186 offset:64
    ds_read_b64_tr_b16 v[94:95], v186 offset:4416
    s_waitcnt lgkmcnt(14)
    v_mfma_f32_16x16x32_bf16 v[32:35], v[176:179], v[116:119], v[32:35]
    v_mfma_f32_16x16x32_bf16 v[64:67], v[176:179], v[120:123], v[64:67]
    ds_read_b64_tr_b16 v[96:97], v187 offset:64
    ds_read_b64_tr_b16 v[98:99], v187 offset:4416
    s_add_u32 m0, s69, 3264
    s_add_u32 s16, s72, 35840
    buffer_load_dwordx4 v217, s[4:7], s16 offen lds
    s_add_u32 s59, s79, 139264
    s_xor_b32 s78, s59, 128
    v_add_u32 v184, s59, v182
    v_add_u32 v185, s59, v183
    v_add_u32 v186, s78, v182
    v_add_u32 v187, s78, v183
    s_waitcnt vmcnt(6)
    s_barrier
    buffer_load_dwordx4 v[100:103], v196, s[12:15], s67 offen offset:0 sc1
    buffer_load_dwordx4 v[104:107], v197, s[12:15], s67 offen offset:0 sc1
    s_waitcnt vmcnt(6)
    s_waitcnt lgkmcnt(4)
    v_mfma_f32_16x16x32_bf16 v[4:7], v[68:71], v[124:127], v[4:7]
    v_mfma_f32_16x16x32_bf16 v[36:39], v[68:71], v[128:131], v[36:39]
    ds_read_b64_tr_b16 v[148:149], v184 offset:0
    ds_read_b64_tr_b16 v[150:151], v184 offset:4352
    v_mfma_f32_16x16x32_bf16 v[8:11], v[72:75], v[124:127], v[8:11]
    v_mfma_f32_16x16x32_bf16 v[40:43], v[72:75], v[128:131], v[40:43]
    ds_read_b64_tr_b16 v[152:153], v185 offset:0
    ds_read_b64_tr_b16 v[154:155], v185 offset:4352
    s_add_u32 m0, s69, 17408
    s_add_u32 s16, s72, 65536
    buffer_load_dwordx4 v217, s[4:7], s16 offen lds
    v_mfma_f32_16x16x32_bf16 v[12:15], v[76:79], v[124:127], v[12:15]
    v_mfma_f32_16x16x32_bf16 v[44:47], v[76:79], v[128:131], v[44:47]
    ds_read_b64_tr_b16 v[156:157], v184 offset:64
    ds_read_b64_tr_b16 v[158:159], v184 offset:4416
    v_mfma_f32_16x16x32_bf16 v[16:19], v[80:83], v[124:127], v[16:19]
    v_mfma_f32_16x16x32_bf16 v[48:51], v[80:83], v[128:131], v[48:51]
    ds_read_b64_tr_b16 v[160:161], v185 offset:64
    ds_read_b64_tr_b16 v[162:163], v185 offset:4416
    s_add_u32 m0, s69, 18496
    s_add_u32 s16, s72, 66560
    buffer_load_dwordx4 v217, s[4:7], s16 offen lds
    v_mfma_f32_16x16x32_bf16 v[20:23], v[84:87], v[124:127], v[20:23]
    v_mfma_f32_16x16x32_bf16 v[52:55], v[84:87], v[128:131], v[52:55]
    ds_read_b64_tr_b16 v[164:165], v186 offset:0
    ds_read_b64_tr_b16 v[166:167], v186 offset:4352
    v_mfma_f32_16x16x32_bf16 v[24:27], v[88:91], v[124:127], v[24:27]
    v_mfma_f32_16x16x32_bf16 v[56:59], v[88:91], v[128:131], v[56:59]
    ds_read_b64_tr_b16 v[168:169], v187 offset:0
    ds_read_b64_tr_b16 v[170:171], v187 offset:4352
    s_add_u32 m0, s69, 19584
    s_add_u32 s16, s72, 67584
    buffer_load_dwordx4 v217, s[4:7], s16 offen lds
    s_waitcnt lgkmcnt(14)
    v_mfma_f32_16x16x32_bf16 v[28:31], v[92:95], v[124:127], v[28:31]
    v_mfma_f32_16x16x32_bf16 v[60:63], v[92:95], v[128:131], v[60:63]
    ds_read_b64_tr_b16 v[172:173], v186 offset:64
    ds_read_b64_tr_b16 v[174:175], v186 offset:4416
    s_waitcnt lgkmcnt(14)
    v_mfma_f32_16x16x32_bf16 v[32:35], v[96:99], v[124:127], v[32:35]
    v_mfma_f32_16x16x32_bf16 v[64:67], v[96:99], v[128:131], v[64:67]
    ds_read_b64_tr_b16 v[176:177], v187 offset:64
    ds_read_b64_tr_b16 v[178:179], v187 offset:4416
    s_add_u32 m0, s69, 20672
    s_add_u32 s16, s72, 68608
    buffer_load_dwordx4 v217, s[4:7], s16 offen lds
    s_add_u32 s59, s79, 0
    s_xor_b32 s78, s59, 128
    v_add_u32 v184, s59, v182
    v_add_u32 v185, s59, v183
    v_add_u32 v186, s78, v182
    v_add_u32 v187, s78, v183
    s_waitcnt vmcnt(6)
    s_barrier
    buffer_load_dwordx4 v[108:111], v196, s[12:15], s67 offen offset:1024 sc1
    buffer_load_dwordx4 v[112:115], v197, s[12:15], s67 offen offset:1024 sc1
    s_waitcnt vmcnt(6)
    s_waitcnt lgkmcnt(4)
    v_mfma_f32_16x16x32_bf16 v[4:7], v[148:151], v[100:103], v[4:7]
    v_mfma_f32_16x16x32_bf16 v[36:39], v[148:151], v[104:107], v[36:39]
    ds_read_b64_tr_b16 v[68:69], v184 offset:0
    ds_read_b64_tr_b16 v[70:71], v184 offset:4352
    v_mfma_f32_16x16x32_bf16 v[8:11], v[152:155], v[100:103], v[8:11]
    v_mfma_f32_16x16x32_bf16 v[40:43], v[152:155], v[104:107], v[40:43]
    ds_read_b64_tr_b16 v[72:73], v185 offset:0
    ds_read_b64_tr_b16 v[74:75], v185 offset:4352
    s_add_u32 m0, s69, 69632
    s_add_u32 s16, s72, 98304
    buffer_load_dwordx4 v217, s[4:7], s16 offen lds
    v_mfma_f32_16x16x32_bf16 v[12:15], v[156:159], v[100:103], v[12:15]
    v_mfma_f32_16x16x32_bf16 v[44:47], v[156:159], v[104:107], v[44:47]
    ds_read_b64_tr_b16 v[76:77], v184 offset:64
    ds_read_b64_tr_b16 v[78:79], v184 offset:4416
    v_mfma_f32_16x16x32_bf16 v[16:19], v[160:163], v[100:103], v[16:19]
    v_mfma_f32_16x16x32_bf16 v[48:51], v[160:163], v[104:107], v[48:51]
    ds_read_b64_tr_b16 v[80:81], v185 offset:64
    ds_read_b64_tr_b16 v[82:83], v185 offset:4416
    s_add_u32 m0, s69, 70720
    s_add_u32 s16, s72, 99328
    buffer_load_dwordx4 v217, s[4:7], s16 offen lds
    v_mfma_f32_16x16x32_bf16 v[20:23], v[164:167], v[100:103], v[20:23]
    v_mfma_f32_16x16x32_bf16 v[52:55], v[164:167], v[104:107], v[52:55]
    ds_read_b64_tr_b16 v[84:85], v186 offset:0
    ds_read_b64_tr_b16 v[86:87], v186 offset:4352
    v_mfma_f32_16x16x32_bf16 v[24:27], v[168:171], v[100:103], v[24:27]
    v_mfma_f32_16x16x32_bf16 v[56:59], v[168:171], v[104:107], v[56:59]
    ds_read_b64_tr_b16 v[88:89], v187 offset:0
    ds_read_b64_tr_b16 v[90:91], v187 offset:4352
    s_add_u32 m0, s69, 71808
    s_add_u32 s16, s72, 100352
    buffer_load_dwordx4 v217, s[4:7], s16 offen lds
    s_waitcnt lgkmcnt(14)
    v_mfma_f32_16x16x32_bf16 v[28:31], v[172:175], v[100:103], v[28:31]
    v_mfma_f32_16x16x32_bf16 v[60:63], v[172:175], v[104:107], v[60:63]
    ds_read_b64_tr_b16 v[92:93], v186 offset:64
    ds_read_b64_tr_b16 v[94:95], v186 offset:4416
    s_waitcnt lgkmcnt(14)
    v_mfma_f32_16x16x32_bf16 v[32:35], v[176:179], v[100:103], v[32:35]
    v_mfma_f32_16x16x32_bf16 v[64:67], v[176:179], v[104:107], v[64:67]
    ds_read_b64_tr_b16 v[96:97], v187 offset:64
    ds_read_b64_tr_b16 v[98:99], v187 offset:4416
    s_add_u32 m0, s69, 72896
    s_add_u32 s16, s72, 101376
    buffer_load_dwordx4 v217, s[4:7], s16 offen lds
    s_add_u32 s59, s79, 17408
    s_xor_b32 s78, s59, 128
    v_add_u32 v184, s59, v182
    v_add_u32 v185, s59, v183
    v_add_u32 v186, s78, v182
    v_add_u32 v187, s78, v183
    s_waitcnt vmcnt(6)
    s_barrier
    buffer_load_dwordx4 v[116:119], v196, s[12:15], s67 offen offset:2048 sc1
    buffer_load_dwordx4 v[120:123], v197, s[12:15], s67 offen offset:2048 sc1
    s_waitcnt vmcnt(6)
    s_waitcnt lgkmcnt(4)
    v_mfma_f32_16x16x32_bf16 v[4:7], v[68:71], v[108:111], v[4:7]
    v_mfma_f32_16x16x32_bf16 v[36:39], v[68:71], v[112:115], v[36:39]
    ds_read_b64_tr_b16 v[148:149], v184 offset:0
    ds_read_b64_tr_b16 v[150:151], v184 offset:4352
    v_mfma_f32_16x16x32_bf16 v[8:11], v[72:75], v[108:111], v[8:11]
    v_mfma_f32_16x16x32_bf16 v[40:43], v[72:75], v[112:115], v[40:43]
    ds_read_b64_tr_b16 v[152:153], v185 offset:0
    ds_read_b64_tr_b16 v[154:155], v185 offset:4352
    v_mfma_f32_16x16x32_bf16 v[12:15], v[76:79], v[108:111], v[12:15]
    v_mfma_f32_16x16x32_bf16 v[44:47], v[76:79], v[112:115], v[44:47]
    ds_read_b64_tr_b16 v[156:157], v184 offset:64
    ds_read_b64_tr_b16 v[158:159], v184 offset:4416
    v_mfma_f32_16x16x32_bf16 v[16:19], v[80:83], v[108:111], v[16:19]
    v_mfma_f32_16x16x32_bf16 v[48:51], v[80:83], v[112:115], v[48:51]
    ds_read_b64_tr_b16 v[160:161], v185 offset:64
    ds_read_b64_tr_b16 v[162:163], v185 offset:4416
    v_mfma_f32_16x16x32_bf16 v[20:23], v[84:87], v[108:111], v[20:23]
    v_mfma_f32_16x16x32_bf16 v[52:55], v[84:87], v[112:115], v[52:55]
    ds_read_b64_tr_b16 v[164:165], v186 offset:0
    ds_read_b64_tr_b16 v[166:167], v186 offset:4352
    v_mfma_f32_16x16x32_bf16 v[24:27], v[88:91], v[108:111], v[24:27]
    v_mfma_f32_16x16x32_bf16 v[56:59], v[88:91], v[112:115], v[56:59]
    ds_read_b64_tr_b16 v[168:169], v187 offset:0
    ds_read_b64_tr_b16 v[170:171], v187 offset:4352
    s_waitcnt lgkmcnt(14)
    v_mfma_f32_16x16x32_bf16 v[28:31], v[92:95], v[108:111], v[28:31]
    v_mfma_f32_16x16x32_bf16 v[60:63], v[92:95], v[112:115], v[60:63]
    ds_read_b64_tr_b16 v[172:173], v186 offset:64
    ds_read_b64_tr_b16 v[174:175], v186 offset:4416
    s_waitcnt lgkmcnt(14)
    v_mfma_f32_16x16x32_bf16 v[32:35], v[96:99], v[108:111], v[32:35]
    v_mfma_f32_16x16x32_bf16 v[64:67], v[96:99], v[112:115], v[64:67]
    ds_read_b64_tr_b16 v[176:177], v187 offset:64
    ds_read_b64_tr_b16 v[178:179], v187 offset:4416
    s_add_u32 s59, s79, 69632
    s_xor_b32 s78, s59, 128
    v_add_u32 v184, s59, v182
    v_add_u32 v185, s59, v183
    v_add_u32 v186, s78, v182
    v_add_u32 v187, s78, v183
    s_waitcnt vmcnt(2)
    s_barrier
    buffer_load_dwordx4 v[124:127], v196, s[12:15], s67 offen offset:3072 sc1
    buffer_load_dwordx4 v[128:131], v197, s[12:15], s67 offen offset:3072 sc1
    s_waitcnt vmcnt(2)
    s_waitcnt lgkmcnt(4)
    v_mfma_f32_16x16x32_bf16 v[4:7], v[148:151], v[116:119], v[4:7]
    v_mfma_f32_16x16x32_bf16 v[36:39], v[148:151], v[120:123], v[36:39]
    ds_read_b64_tr_b16 v[68:69], v184 offset:0
    ds_read_b64_tr_b16 v[70:71], v184 offset:4352
    v_mfma_f32_16x16x32_bf16 v[8:11], v[152:155], v[116:119], v[8:11]
    v_mfma_f32_16x16x32_bf16 v[40:43], v[152:155], v[120:123], v[40:43]
    ds_read_b64_tr_b16 v[72:73], v185 offset:0
    ds_read_b64_tr_b16 v[74:75], v185 offset:4352
    v_mfma_f32_16x16x32_bf16 v[12:15], v[156:159], v[116:119], v[12:15]
    v_mfma_f32_16x16x32_bf16 v[44:47], v[156:159], v[120:123], v[44:47]
    ds_read_b64_tr_b16 v[76:77], v184 offset:64
    ds_read_b64_tr_b16 v[78:79], v184 offset:4416
    v_mfma_f32_16x16x32_bf16 v[16:19], v[160:163], v[116:119], v[16:19]
    v_mfma_f32_16x16x32_bf16 v[48:51], v[160:163], v[120:123], v[48:51]
    ds_read_b64_tr_b16 v[80:81], v185 offset:64
    ds_read_b64_tr_b16 v[82:83], v185 offset:4416
    v_mfma_f32_16x16x32_bf16 v[20:23], v[164:167], v[116:119], v[20:23]
    v_mfma_f32_16x16x32_bf16 v[52:55], v[164:167], v[120:123], v[52:55]
    ds_read_b64_tr_b16 v[84:85], v186 offset:0
    ds_read_b64_tr_b16 v[86:87], v186 offset:4352
    v_mfma_f32_16x16x32_bf16 v[24:27], v[168:171], v[116:119], v[24:27]
    v_mfma_f32_16x16x32_bf16 v[56:59], v[168:171], v[120:123], v[56:59]
    ds_read_b64_tr_b16 v[88:89], v187 offset:0
    ds_read_b64_tr_b16 v[90:91], v187 offset:4352
    s_waitcnt lgkmcnt(14)
    v_mfma_f32_16x16x32_bf16 v[28:31], v[172:175], v[116:119], v[28:31]
    v_mfma_f32_16x16x32_bf16 v[60:63], v[172:175], v[120:123], v[60:63]
    ds_read_b64_tr_b16 v[92:93], v186 offset:64
    ds_read_b64_tr_b16 v[94:95], v186 offset:4416
    s_waitcnt lgkmcnt(14)
    v_mfma_f32_16x16x32_bf16 v[32:35], v[176:179], v[116:119], v[32:35]
    v_mfma_f32_16x16x32_bf16 v[64:67], v[176:179], v[120:123], v[64:67]
    ds_read_b64_tr_b16 v[96:97], v187 offset:64
    ds_read_b64_tr_b16 v[98:99], v187 offset:4416
    s_waitcnt vmcnt(0)
    s_waitcnt lgkmcnt(6)
    v_mfma_f32_16x16x32_bf16 v[20:23], v[84:87], v[124:127], v[20:23]
    v_mfma_f32_16x16x32_bf16 v[52:55], v[84:87], v[128:131], v[52:55]
    s_waitcnt lgkmcnt(4)
    v_mfma_f32_16x16x32_bf16 v[24:27], v[88:91], v[124:127], v[24:27]
    v_mfma_f32_16x16x32_bf16 v[56:59], v[88:91], v[128:131], v[56:59]
    s_waitcnt lgkmcnt(2)
    v_mfma_f32_16x16x32_bf16 v[28:31], v[92:95], v[124:127], v[28:31]
    v_mfma_f32_16x16x32_bf16 v[60:63], v[92:95], v[128:131], v[60:63]
    s_waitcnt lgkmcnt(0)
    v_mfma_f32_16x16x32_bf16 v[32:35], v[96:99], v[124:127], v[32:35]
    v_mfma_f32_16x16x32_bf16 v[64:67], v[96:99], v[128:131], v[64:67]
    v_mfma_f32_16x16x32_bf16 v[4:7], v[68:71], v[124:127], v[4:7]
    v_mfma_f32_16x16x32_bf16 v[36:39], v[68:71], v[128:131], v[36:39]
    s_barrier
    ds_write_b128 v2, v[20:23] offset:0
    ds_write_b128 v2, v[52:55] offset:4096
    ds_write_b128 v2, v[24:27] offset:1024
    v_mfma_f32_16x16x32_bf16 v[8:11], v[72:75], v[124:127], v[8:11]
    v_mfma_f32_16x16x32_bf16 v[40:43], v[72:75], v[128:131], v[40:43]
    ds_write_b128 v2, v[56:59] offset:5120
    ds_write_b128 v2, v[28:31] offset:2048
    ds_write_b128 v2, v[60:63] offset:6144
    v_mfma_f32_16x16x32_bf16 v[12:15], v[76:79], v[124:127], v[12:15]
    v_mfma_f32_16x16x32_bf16 v[44:47], v[76:79], v[128:131], v[44:47]
    ds_write_b128 v2, v[32:35] offset:3072
    ds_write_b128 v2, v[64:67] offset:7168
    v_mfma_f32_16x16x32_bf16 v[16:19], v[80:83], v[124:127], v[16:19]
    v_mfma_f32_16x16x32_bf16 v[48:51], v[80:83], v[128:131], v[48:51]
    s_mul_i32 s78, s49, -81920
    s_add_u32 s78, s78, 40960
    s_add_u32 s78, s78, s100
    v_add_u32 v3, s78, v196
    v_bfe_u32 v184, v0, 2, 2
    v_lshlrev_b32 v184, 11, v184
    v_lshrrev_b32 v200, 4, v0
    v_lshl_add_u32 v184, v200, 6, v184
    v_and_b32 v200, 3, v0
    v_lshl_add_u32 v184, v200, 4, v184
    v_bfe_u32 v185, v0, 1, 2
    v_lshlrev_b32 v185, 11, v185
    v_lshrrev_b32 v200, 3, v0
    v_lshl_add_u32 v185, v200, 4, v185
    v_and_b32 v200, 1, v0
    v_lshl_add_u32 v185, v200, 3, v185
    s_mul_i32 s59, s44, 40
    s_lshl_b32 s78, s77, 2
    s_add_u32 s59, s59, s78
    s_add_u32 s59, s59, s43
    s_lshl_b32 s59, s59, 2
    s_lshl_b32 s59, s59, 11
    s_lshl_b32 s78, s42, 10
    s_add_u32 s59, s59, s78
    s_lshl_b32 s78, s45, 8
    s_add_u32 s59, s59, s78
    s_lshl_b32 s78, s49, 7
    s_add_u32 s59, s59, s78
    s_add_u32 s8, s36, s59
    s_addc_u32 s9, s37, 0
    s_mov_b32 s10, 39040
    s_mov_b32 s11, 0x20000
    s_lshl_b32 s64, s43, 9
    s_lshl_b32 s65, s43, 11
    s_mov_b32 s62, 0x3f80
    s_mov_b32 s63, 0x3f800000
    s_waitcnt lgkmcnt(0)
    s_barrier
    ds_read_b128 v[68:71], v3 offset:0
    ds_read_b128 v[72:75], v3 offset:1024
    ds_read_b128 v[76:79], v3 offset:2048
    ds_read_b128 v[80:83], v3 offset:3072
    ds_read_b128 v[84:87], v3 offset:4096
    ds_read_b128 v[88:91], v3 offset:5120
    ds_read_b128 v[92:95], v3 offset:6144
    ds_read_b128 v[96:99], v3 offset:7168
    s_waitcnt lgkmcnt(7)
    v_add_f32 v4, v4, v68
    v_add_f32 v5, v5, v69
    v_add_f32 v6, v6, v70
    v_add_f32 v7, v7, v71
    s_waitcnt lgkmcnt(6)
    v_add_f32 v8, v8, v72
    v_add_f32 v9, v9, v73
    v_add_f32 v10, v10, v74
    v_add_f32 v11, v11, v75
    s_waitcnt lgkmcnt(5)
    v_add_f32 v12, v12, v76
    v_add_f32 v13, v13, v77
    v_add_f32 v14, v14, v78
    v_add_f32 v15, v15, v79
    s_waitcnt lgkmcnt(4)
    v_add_f32 v16, v16, v80
    v_add_f32 v17, v17, v81
    v_add_f32 v18, v18, v82
    v_add_f32 v19, v19, v83
    v_cvt_pk_bf16_f32 v4, v4, v5
    v_cvt_pk_bf16_f32 v5, v6, v7
    v_cvt_pk_bf16_f32 v6, v8, v9
    v_cvt_pk_bf16_f32 v7, v10, v11
    v_cvt_pk_bf16_f32 v12, v12, v13
    v_cvt_pk_bf16_f32 v13, v14, v15
    v_cvt_pk_bf16_f32 v14, v16, v17
    v_cvt_pk_bf16_f32 v15, v18, v19
    v_permlane32_swap_b32 v4, v6
    v_permlane32_swap_b32 v5, v7
    v_permlane32_swap_b32 v12, v14
    v_permlane32_swap_b32 v13, v15
    v_permlane16_swap_b32 v4, v6
    v_permlane16_swap_b32 v5, v7
    v_permlane16_swap_b32 v12, v14
    v_permlane16_swap_b32 v13, v15
    buffer_store_dwordx4 v[4:7], v184, s[24:27], s64 offen offset:0 sc1
    buffer_store_dwordx4 v[12:15], v184, s[24:27], s64 offen offset:256 sc1
    s_waitcnt lgkmcnt(3)
    v_add_f32 v36, v36, v84
    v_add_f32 v37, v37, v85
    v_add_f32 v38, v38, v86
    v_add_f32 v39, v39, v87
    s_waitcnt lgkmcnt(2)
    v_add_f32 v40, v40, v88
    v_add_f32 v41, v41, v89
    v_add_f32 v42, v42, v90
    v_add_f32 v43, v43, v91
    s_waitcnt lgkmcnt(1)
    v_add_f32 v44, v44, v92
    v_add_f32 v45, v45, v93
    v_add_f32 v46, v46, v94
    v_add_f32 v47, v47, v95
    s_waitcnt lgkmcnt(0)
    v_add_f32 v48, v48, v96
    v_add_f32 v49, v49, v97
    v_add_f32 v50, v50, v98
    v_add_f32 v51, v51, v99
    v_cvt_pk_bf16_f32 v36, v36, v37
    v_cvt_pk_bf16_f32 v37, v38, v39
    v_cvt_pk_bf16_f32 v38, v40, v41
    v_cvt_pk_bf16_f32 v39, v42, v43
    v_cvt_pk_bf16_f32 v44, v44, v45
    v_cvt_pk_bf16_f32 v45, v46, v47
    v_cvt_pk_bf16_f32 v46, v48, v49
    v_cvt_pk_bf16_f32 v47, v50, v51
    v_permlane32_swap_b32 v36, v38
    v_permlane32_swap_b32 v37, v39
    v_permlane32_swap_b32 v44, v46
    v_permlane32_swap_b32 v45, v47
    v_permlane16_swap_b32 v36, v38
    v_permlane16_swap_b32 v37, v39
    v_permlane16_swap_b32 v44, v46
    v_permlane16_swap_b32 v45, v47
    s_add_u32 s64, s64, 8192
    buffer_store_dwordx4 v[36:39], v184, s[24:27], s64 offen offset:0 sc1
    buffer_store_dwordx4 v[44:47], v184, s[24:27], s64 offen offset:256 sc1
    v_lshlrev_b32 v184, 3, v0
    s_waitcnt vmcnt(0)
    s_barrier
    s_cmp_lg_u32 s3, 4
    s_cbranch_scc1 L_nopollb
    v_mov_b32 v208, 3
    s_mov_b64 exec, 1
    buffer_store_dword v208, off, s[20:23], s75 sc1
    s_mov_b64 exec, -1
    v_lshlrev_b32 v209, 2, v209
    s_lshl_b32 s73, s45, 7
    s_mov_b32 s78, 0
L_pollb:
    buffer_load_dword v208, v209, s[20:23], s73 offen sc1
    s_add_u32 s78, s78, 1
    s_waitcnt vmcnt(0)
L_checkb:
    v_cmp_le_u32 vcc, 3, v208
    s_nop 0
    s_cmp_eq_u64 vcc, -1
    s_cbranch_scc1 L_doneb
    s_sleep 4
    s_cmp_lt_u32 s78, 0x10000
    s_cbranch_scc1 L_pollb
L_doneb:
L_nopollb:
    s_barrier
    buffer_load_dwordx2 v[68:69], v184, s[24:27], s65 offen offset:0 sc1
    buffer_load_dwordx2 v[70:71], v184, s[24:27], s65 offen offset:512 sc1
    buffer_load_dwordx2 v[72:73], v184, s[24:27], s65 offen offset:1024 sc1
    buffer_load_dwordx2 v[74:75], v184, s[24:27], s65 offen offset:1536 sc1
    s_add_u32 s65, s65, 8192
    buffer_load_dwordx2 v[76:77], v184, s[24:27], s65 offen offset:0 sc1
    buffer_load_dwordx2 v[78:79], v184, s[24:27], s65 offen offset:512 sc1
    buffer_load_dwordx2 v[80:81], v184, s[24:27], s65 offen offset:1024 sc1
    buffer_load_dwordx2 v[82:83], v184, s[24:27], s65 offen offset:1536 sc1
    s_waitcnt vmcnt(7)
    v_lshlrev_b32 v4, 16, v68
    v_and_b32 v5, 0xffff0000, v68
    v_lshlrev_b32 v6, 16, v69
    v_and_b32 v7, 0xffff0000, v69
    s_waitcnt vmcnt(6)
    v_dot2c_f32_bf16 v4, s62, v70
    v_dot2c_f32_bf16 v5, s63, v70
    v_dot2c_f32_bf16 v6, s62, v71
    v_dot2c_f32_bf16 v7, s63, v71
    s_waitcnt vmcnt(5)
    v_dot2c_f32_bf16 v4, s62, v72
    v_dot2c_f32_bf16 v5, s63, v72
    v_dot2c_f32_bf16 v6, s62, v73
    v_dot2c_f32_bf16 v7, s63, v73
    s_waitcnt vmcnt(4)
    v_dot2c_f32_bf16 v4, s62, v74
    v_dot2c_f32_bf16 v5, s63, v74
    v_dot2c_f32_bf16 v6, s62, v75
    v_dot2c_f32_bf16 v7, s63, v75
    s_nop 0
    v_cvt_pk_bf16_f32 v4, v4, v5
    s_nop 0
    v_cvt_pk_bf16_f32 v5, v6, v7
    s_mov_b32 s64, 0
    buffer_store_dwordx2 v[4:5], v185, s[8:11], s64 offen
    s_waitcnt vmcnt(4)
    v_lshlrev_b32 v36, 16, v76
    v_and_b32 v37, 0xffff0000, v76
    v_lshlrev_b32 v38, 16, v77
    v_and_b32 v39, 0xffff0000, v77
    s_waitcnt vmcnt(3)
    v_dot2c_f32_bf16 v36, s62, v78
    v_dot2c_f32_bf16 v37, s63, v78
    v_dot2c_f32_bf16 v38, s62, v79
    v_dot2c_f32_bf16 v39, s63, v79
    s_waitcnt vmcnt(2)
    v_dot2c_f32_bf16 v36, s62, v80
    v_dot2c_f32_bf16 v37, s63, v80
    v_dot2c_f32_bf16 v38, s62, v81
    v_dot2c_f32_bf16 v39, s63, v81
    s_waitcnt vmcnt(1)
    v_dot2c_f32_bf16 v36, s62, v82
    v_dot2c_f32_bf16 v37, s63, v82
    v_dot2c_f32_bf16 v38, s62, v83
    v_dot2c_f32_bf16 v39, s63, v83
    s_nop 0
    v_cvt_pk_bf16_f32 v36, v36, v37
    s_nop 0
    v_cvt_pk_bf16_f32 v37, v38, v39
    s_mov_b32 s64, 32768
    buffer_store_dwordx2 v[36:37], v185, s[8:11], s64 offen
    s_endpgm
L_redo_H:
    s_waitcnt vmcnt(0) lgkmcnt(0)
    s_barrier
    s_mov_b32 s50, 17408
    s_mov_b32 s51, 69632
    s_mov_b32 s52, 104448
    s_mov_b32 s53, 121856
    s_mov_b32 s54, 0
    s_mov_b32 s55, 34816
    s_mov_b32 s56, 52224
    s_mov_b32 s57, 87040
    s_mov_b32 s58, 139264
    s_mov_b32 s60, 0
    v_mov_b32 v200, 163824
    v_mov_b32 v201, 0
    ds_write_b32 v200, v201
    s_waitcnt lgkmcnt(0)
    s_lshl_b32 s59, s44, 5
    s_add_u32 s59, s59, s46
    s_add_u32 s59, s59, s48
    s_lshl_b32 s59, s59, 17
    s_cmp_eq_u32 s49, 0
    s_mov_b32 s68, 1088
    s_cselect_b32 s68, 1056, s68
    s_mov_b32 s67, 3328
    s_cselect_b32 s67, 256, s67
    s_mov_b32 s69, 8704
    s_cselect_b32 s69, 8448, s69
    s_mov_b32 s66, 256
    s_mul_i32 s69, s69, s48
    s_add_u32 s4, s18, s59
    s_addc_u32 s5, s19, 0
    s_mov_b32 s6, 131072
    s_mov_b32 s7, 0x20000
    v_mov_b32 v202, v216
    s_cmp_eq_u32 s49, 0
    s_mov_b32 s64, 0
    s_mov_b32 s73, 16
    s_mov_b32 s71, 8192
    s_mov_b32 s76, -1
    s_cmp_eq_u32 s49, 0
    s_mov_b32 s70, 34816
    s_cselect_b32 s70, 0, s70
    s_add_u32 m0, s70, s69
    s_mov_b32 s65, s64
    buffer_load_dwordx4 v202, s[4:7], s65 offen nt lds
    s_add_u32 m0, m0, s68
    s_add_u32 s65, s65, s66
    buffer_load_dwordx4 v202, s[4:7], s65 offen nt lds
    s_add_u32 m0, m0, s68
    s_add_u32 s65, s65, s66
    buffer_load_dwordx4 v202, s[4:7], s65 offen nt lds
    s_add_u32 m0, m0, s68
    s_add_u32 s65, s65, s66
    buffer_load_dwordx4 v202, s[4:7], s65 offen nt lds
    s_add_u32 m0, m0, s68
    s_add_u32 s65, s65, s67
    buffer_load_dwordx4 v202, s[4:7], s65 offen nt lds
    s_add_u32 m0, m0, s68
    s_add_u32 s65, s65, s66
    buffer_load_dwordx4 v202, s[4:7], s65 offen nt lds
    s_add_u32 m0, m0, s68
    s_add_u32 s65, s65, s66
    buffer_load_dwordx4 v202, s[4:7], s65 offen nt lds
    s_add_u32 m0, m0, s68
    s_add_u32 s65, s65, s66
    buffer_load_dwordx4 v202, s[4:7], s65 offen nt lds
    s_add_u32 s64, s64, s71
    s_sub_u32 s73, s73, 1
    s_cmp_lg_u32 s73, 0
    s_cbranch_scc1 L_H_keep4
    s_mov_b64 s[4:5], s[28:29]
    s_mov_b32 s6, s2
    s_mov_b32 s64, s0
    s_mov_b32 s66, 1024
    s_mov_b32 s67, 13312
    s_mov_b32 s71, 32768
    v_mov_b32 v202, v217
    s_cmp_lg_u32 s49, 0
    s_cbranch_scc1 L_H_vsw4
    s_mov_b32 s76, 0
    s_mov_b32 s68, 0
    s_mov_b32 s69, 157696
    s_branch L_H_keep4
L_H_vsw4:
L_H_keep4:
    s_add_u32 s78, s73, s76
    s_cmp_lg_u32 s78, -1
    s_cbranch_scc1 L_H_not4
    s_cmp_lg_u32 s76, 0
    s_cbranch_scc1 L_H_not4
    buffer_load_dword v218, v214, s[28:31], s1 offen
    buffer_load_dword v218, v215, s[28:31], s1 offen
L_H_not4:
L_skipr0:
    s_cmp_eq_u32 s49, 0
    s_mov_b32 s70, 52224
    s_cselect_b32 s70, 17408, s70
    s_add_u32 m0, s70, s69
    s_mov_b32 s65, s64
    buffer_load_dwordx4 v202, s[4:7], s65 offen nt lds
    s_add_u32 m0, m0, s68
    s_add_u32 s65, s65, s66
    buffer_load_dwordx4 v202, s[4:7], s65 offen nt lds
    s_add_u32 m0, m0, s68
    s_add_u32 s65, s65, s66
    buffer_load_dwordx4 v202, s[4:7], s65 offen nt lds
    s_add_u32 m0, m0, s68
    s_add_u32 s65, s65, s66
    buffer_load_dwordx4 v202, s[4:7], s65 offen nt lds
    s_add_u32 m0, m0, s68
    s_add_u32 s65, s65, s67
    buffer_load_dwordx4 v202, s[4:7], s65 offen nt lds
    s_add_u32 m0, m0, s68
    s_add_u32 s65, s65, s66
    buffer_load_dwordx4 v202, s[4:7], s65 offen nt lds
    s_add_u32 m0, m0, s68
    s_add_u32 s65, s65, s66
    buffer_load_dwordx4 v202, s[4:7], s65 offen nt lds
    s_add_u32 m0, m0, s68
    s_add_u32 s65, s65, s66
    buffer_load_dwordx4 v202, s[4:7], s65 offen nt lds
    s_add_u32 s64, s64, s71
    s_sub_u32 s73, s73, 1
    s_cmp_lg_u32 s73, 0
    s_cbranch_scc1 L_H_keep5
    s_mov_b64 s[4:5], s[28:29]
    s_mov_b32 s6, s2
    s_mov_b32 s64, s0
    s_mov_b32 s66, 1024
    s_mov_b32 s67, 13312
    s_mov_b32 s71, 32768
    v_mov_b32 v202, v217
    s_cmp_lg_u32 s49, 0
    s_cbranch_scc1 L_H_vsw5
    s_mov_b32 s76, 0
    s_mov_b32 s68, 0
    s_mov_b32 s69, 157696
    s_branch L_H_keep5
L_H_vsw5:
L_H_keep5:
    s_add_u32 s78, s73, s76
    s_cmp_lg_u32 s78, -1
    s_cbranch_scc1 L_H_not5
    s_cmp_lg_u32 s76, 0
    s_cbranch_scc1 L_H_not5
    buffer_load_dword v218, v214, s[28:31], s1 offen
    buffer_load_dword v218, v215, s[28:31], s1 offen
L_H_not5:
L_skipr1:
    s_cmp_eq_u32 s49, 0
    s_mov_b32 s70, 87040
    s_cselect_b32 s70, 69632, s70
    s_add_u32 m0, s70, s69
    s_mov_b32 s65, s64
    buffer_load_dwordx4 v202, s[4:7], s65 offen nt lds
    s_add_u32 m0, m0, s68
    s_add_u32 s65, s65, s66
    buffer_load_dwordx4 v202, s[4:7], s65 offen nt lds
    s_add_u32 m0, m0, s68
    s_add_u32 s65, s65, s66
    buffer_load_dwordx4 v202, s[4:7], s65 offen nt lds
    s_add_u32 m0, m0, s68
    s_add_u32 s65, s65, s66
    buffer_load_dwordx4 v202, s[4:7], s65 offen nt lds
    s_add_u32 m0, m0, s68
    s_add_u32 s65, s65, s67
    buffer_load_dwordx4 v202, s[4:7], s65 offen nt lds
    s_add_u32 m0, m0, s68
    s_add_u32 s65, s65, s66
    buffer_load_dwordx4 v202, s[4:7], s65 offen nt lds
    s_add_u32 m0, m0, s68
    s_add_u32 s65, s65, s66
    buffer_load_dwordx4 v202, s[4:7], s65 offen nt lds
    s_add_u32 m0, m0, s68
    s_add_u32 s65, s65, s66
    buffer_load_dwordx4 v202, s[4:7], s65 offen nt lds
    s_add_u32 s64, s64, s71
    s_sub_u32 s73, s73, 1
    s_cmp_lg_u32 s73, 0
    s_cbranch_scc1 L_H_keep6
    s_mov_b64 s[4:5], s[28:29]
    s_mov_b32 s6, s2
    s_mov_b32 s64, s0
    s_mov_b32 s66, 1024
    s_mov_b32 s67, 13312
    s_mov_b32 s71, 32768
    v_mov_b32 v202, v217
    s_cmp_lg_u32 s49, 0
    s_cbranch_scc1 L_H_vsw6
    s_mov_b32 s76, 0
    s_mov_b32 s68, 0
    s_mov_b32 s69, 157696
    s_branch L_H_keep6
L_H_vsw6:
L_H_keep6:
    s_add_u32 s78, s73, s76
    s_cmp_lg_u32 s78, -1
    s_cbranch_scc1 L_H_not6
    s_cmp_lg_u32 s76, 0
    s_cbranch_scc1 L_H_not6
    buffer_load_dword v218, v214, s[28:31], s1 offen
    buffer_load_dword v218, v215, s[28:31], s1 offen
L_H_not6:
L_skipr2:
    s_cmp_eq_u32 s49, 0
    s_cbranch_scc0 L_skipr3
    s_mov_b32 s70, 104448
    s_add_u32 m0, s70, s69
    s_mov_b32 s65, s64
    buffer_load_dwordx4 v202, s[4:7], s65 offen nt lds
    s_add_u32 m0, m0, s68
    s_add_u32 s65, s65, s66
    buffer_load_dwordx4 v202, s[4:7], s65 offen nt lds
    s_add_u32 m0, m0, s68
    s_add_u32 s65, s65, s66
    buffer_load_dwordx4 v202, s[4:7], s65 offen nt lds
    s_add_u32 m0, m0, s68
    s_add_u32 s65, s65, s66
    buffer_load_dwordx4 v202, s[4:7], s65 offen nt lds
    s_add_u32 m0, m0, s68
    s_add_u32 s65, s65, s67
    buffer_load_dwordx4 v202, s[4:7], s65 offen nt lds
    s_add_u32 m0, m0, s68
    s_add_u32 s65, s65, s66
    buffer_load_dwordx4 v202, s[4:7], s65 offen nt lds
    s_add_u32 m0, m0, s68
    s_add_u32 s65, s65, s66
    buffer_load_dwordx4 v202, s[4:7], s65 offen nt lds
    s_add_u32 m0, m0, s68
    s_add_u32 s65, s65, s66
    buffer_load_dwordx4 v202, s[4:7], s65 offen nt lds
    s_add_u32 s64, s64, s71
    s_sub_u32 s73, s73, 1
    s_cmp_lg_u32 s73, 0
    s_cbranch_scc1 L_H_keep7
    s_mov_b64 s[4:5], s[28:29]
    s_mov_b32 s6, s2
    s_mov_b32 s64, s0
    s_mov_b32 s66, 1024
    s_mov_b32 s67, 13312
    s_mov_b32 s71, 32768
    v_mov_b32 v202, v217
    s_cmp_lg_u32 s49, 0
    s_cbranch_scc1 L_H_vsw7
    s_mov_b32 s76, 0
    s_mov_b32 s68, 0
    s_mov_b32 s69, 157696
    s_branch L_H_keep7
L_H_vsw7:
L_H_keep7:
    s_add_u32 s78, s73, s76
    s_cmp_lg_u32 s78, -1
    s_cbranch_scc1 L_H_not7
    s_cmp_lg_u32 s76, 0
    s_cbranch_scc1 L_H_not7
    buffer_load_dword v218, v214, s[28:31], s1 offen
    buffer_load_dword v218, v215, s[28:31], s1 offen
L_H_not7:
L_skipr3:
    s_waitcnt vmcnt(16)
    s_barrier
    v_add_u32 v184, 0, v180
    v_add_u32 v185, 0, v181
    ds_read_b128 v[148:151], v184 offset:0
    ds_read_b128 v[156:159], v184 offset:64
    ds_read_b128 v[164:167], v184 offset:128
    ds_read_b128 v[172:175], v184 offset:192
    ds_read_b128 v[152:155], v185 offset:0
    ds_read_b128 v[160:163], v185 offset:64
    ds_read_b128 v[168:171], v185 offset:128
    ds_read_b128 v[176:179], v185 offset:192
    v_mov_b32 v4, 0
    v_mov_b32 v5, 0
    v_mov_b32 v6, 0
    v_mov_b32 v7, 0
    v_mov_b32 v8, 0
    v_mov_b32 v9, 0
    v_mov_b32 v10, 0
    v_mov_b32 v11, 0
    v_mov_b32 v12, 0
    v_mov_b32 v13, 0
    v_mov_b32 v14, 0
    v_mov_b32 v15, 0
    v_mov_b32 v16, 0
    v_mov_b32 v17, 0
    v_mov_b32 v18, 0
    v_mov_b32 v19, 0
    v_mov_b32 v20, 0
    v_mov_b32 v21, 0
    v_mov_b32 v22, 0
    v_mov_b32 v23, 0
    v_mov_b32 v24, 0
    v_mov_b32 v25, 0
    v_mov_b32 v26, 0
    v_mov_b32 v27, 0
    v_mov_b32 v28, 0
    v_mov_b32 v29, 0
    v_mov_b32 v30, 0
    v_mov_b32 v31, 0
    v_mov_b32 v32, 0
    v_mov_b32 v33, 0
    v_mov_b32 v34, 0
    v_mov_b32 v35, 0
    v_mov_b32 v36, 0
    v_mov_b32 v37, 0
    v_mov_b32 v38, 0
    v_mov_b32 v39, 0
    v_mov_b32 v40, 0
    v_mov_b32 v41, 0
    v_mov_b32 v42, 0
    v_mov_b32 v43, 0
    v_mov_b32 v44, 0
    v_mov_b32 v45, 0
    v_mov_b32 v46, 0
    v_mov_b32 v47, 0
    v_mov_b32 v48, 0
    v_mov_b32 v49, 0
    v_mov_b32 v50, 0
    v_mov_b32 v51, 0
    v_mov_b32 v52, 0
    v_mov_b32 v53, 0
    v_mov_b32 v54, 0
    v_mov_b32 v55, 0
    v_mov_b32 v56, 0
    v_mov_b32 v57, 0
    v_mov_b32 v58, 0
    v_mov_b32 v59, 0
    v_mov_b32 v60, 0
    v_mov_b32 v61, 0
    v_mov_b32 v62, 0
    v_mov_b32 v63, 0
    v_mov_b32 v64, 0
    v_mov_b32 v65, 0
    v_mov_b32 v66, 0
    v_mov_b32 v67, 0
    v_mov_b32 v116, 0
    v_mov_b32 v117, 0
    v_mov_b32 v118, 0
    v_mov_b32 v119, 0
    v_mov_b32 v120, 0
    v_mov_b32 v121, 0
    v_mov_b32 v122, 0
    v_mov_b32 v123, 0
    v_mov_b32 v188, 0
    v_mov_b32 v189, 0
    v_mov_b32 v190, 0
    v_mov_b32 v191, 0
    v_mov_b32 v192, 0
    v_mov_b32 v193, 0
    v_mov_b32 v194, 0
    v_mov_b32 v195, 0
    v_mov_b32 v196, 0x3f803f80
    v_mov_b32 v197, 0x3f803f80
    v_mov_b32 v198, 0x3f803f80
    v_mov_b32 v199, 0x3f803f80
L_safe_H:
    s_cmp_eq_u32 s49, 0
    s_cselect_b32 s70, s53, s58
    s_and_b32 s70, s70, s76
    s_add_u32 m0, s70, s69
    s_waitcnt vmcnt(16)
    s_barrier
    s_mov_b32 s65, s64
    buffer_load_dwordx4 v202, s[4:7], s65 offen nt lds
    s_waitcnt lgkmcnt(4)
    v_mfma_f32_16x16x32_bf16 v[100:103], v[148:151], v[68:71], v[116:119]
    v_add_u32 v186, s55, v182
    v_add_u32 v187, s55, v183
    s_add_u32 m0, m0, s68
    s_add_u32 s65, s65, s66
    buffer_load_dwordx4 v202, s[4:7], s65 offen nt lds
    v_mfma_f32_16x16x32_bf16 v[100:103], v[156:159], v[72:75], v[100:103]
    v_add_u32 v184, s50, v180
    v_add_u32 v185, s50, v181
    s_add_u32 m0, m0, s68
    s_add_u32 s65, s65, s66
    buffer_load_dwordx4 v202, s[4:7], s65 offen nt lds
    v_mfma_f32_16x16x32_bf16 v[100:103], v[164:167], v[76:79], v[100:103]
    s_mov_b32 s59, s50
    s_mov_b32 s50, s51
    s_add_u32 m0, m0, s68
    s_add_u32 s65, s65, s66
    buffer_load_dwordx4 v202, s[4:7], s65 offen nt lds
    v_mfma_f32_16x16x32_bf16 v[100:103], v[172:175], v[80:83], v[100:103]
    s_mov_b32 s51, s52
    s_mov_b32 s52, s53
    s_add_u32 m0, m0, s68
    s_add_u32 s65, s65, s67
    buffer_load_dwordx4 v202, s[4:7], s65 offen nt lds
    s_waitcnt lgkmcnt(0)
    v_mfma_f32_16x16x32_bf16 v[104:107], v[152:155], v[68:71], v[116:119]
    s_mov_b32 s53, s54
    s_mov_b32 s54, s59
    s_add_u32 m0, m0, s68
    s_add_u32 s65, s65, s66
    buffer_load_dwordx4 v202, s[4:7], s65 offen nt lds
    v_mfma_f32_16x16x32_bf16 v[104:107], v[160:163], v[72:75], v[104:107]
    s_mov_b32 s59, s55
    s_mov_b32 s55, s56
    s_add_u32 m0, m0, s68
    s_add_u32 s65, s65, s66
    buffer_load_dwordx4 v202, s[4:7], s65 offen nt lds
    v_mfma_f32_16x16x32_bf16 v[104:107], v[168:171], v[76:79], v[104:107]
    s_mov_b32 s56, s57
    s_mov_b32 s57, s58
    s_add_u32 m0, m0, s68
    s_add_u32 s65, s65, s66
    buffer_load_dwordx4 v202, s[4:7], s65 offen nt lds
    s_add_u32 s64, s64, s71
    s_sub_u32 s73, s73, 1
    s_cmp_lg_u32 s73, 0
    s_cbranch_scc1 L_H_keep8
    s_mov_b64 s[4:5], s[28:29]
    s_mov_b32 s6, s2
    s_mov_b32 s64, s0
    s_mov_b32 s66, 1024
    s_mov_b32 s67, 13312
    s_mov_b32 s71, 32768
    v_mov_b32 v202, v217
    s_cmp_lg_u32 s49, 0
    s_cbranch_scc1 L_H_vsw8
    s_mov_b32 s76, 0
    s_mov_b32 s68, 0
    s_mov_b32 s69, 157696
    s_branch L_H_keep8
L_H_vsw8:
L_H_keep8:
    s_add_u32 s78, s73, s76
    s_cmp_lg_u32 s78, -1
    s_cbranch_scc1 L_H_not8
    s_cmp_lg_u32 s76, 0
    s_cbranch_scc1 L_H_not8
    buffer_load_dword v218, v214, s[28:31], s1 offen
    buffer_load_dword v218, v215, s[28:31], s1 offen
L_H_not8:
    v_mfma_f32_16x16x32_bf16 v[104:107], v[176:179], v[80:83], v[104:107]
    s_mov_b32 s58, s59
    v_mfma_f32_16x16x32_bf16 v[108:111], v[148:151], v[84:87], v[120:123]
    ds_read_b64_tr_b16 v[148:149], v186 offset:0
    ds_read_b64_tr_b16 v[150:151], v186 offset:4352
    v_mfma_f32_16x16x32_bf16 v[108:111], v[156:159], v[88:91], v[108:111]
    ds_read_b64_tr_b16 v[156:157], v186 offset:64
    ds_read_b64_tr_b16 v[158:159], v186 offset:4416
    v_mfma_f32_16x16x32_bf16 v[108:111], v[164:167], v[92:95], v[108:111]
    ds_read_b64_tr_b16 v[164:165], v186 offset:128
    ds_read_b64_tr_b16 v[166:167], v186 offset:4480
    v_mfma_f32_16x16x32_bf16 v[108:111], v[172:175], v[96:99], v[108:111]
    ds_read_b64_tr_b16 v[172:173], v186 offset:192
    ds_read_b64_tr_b16 v[174:175], v186 offset:4544
    v_mfma_f32_16x16x32_bf16 v[112:115], v[152:155], v[84:87], v[120:123]
    ds_read_b64_tr_b16 v[152:153], v187 offset:0
    ds_read_b64_tr_b16 v[154:155], v187 offset:4352
    v_mfma_f32_16x16x32_bf16 v[112:115], v[160:163], v[88:91], v[112:115]
    ds_read_b64_tr_b16 v[160:161], v187 offset:64
    ds_read_b64_tr_b16 v[162:163], v187 offset:4416
    v_mfma_f32_16x16x32_bf16 v[112:115], v[168:171], v[92:95], v[112:115]
    ds_read_b64_tr_b16 v[168:169], v187 offset:128
    ds_read_b64_tr_b16 v[170:171], v187 offset:4480
    v_mfma_f32_16x16x32_bf16 v[112:115], v[176:179], v[96:99], v[112:115]
    ds_read_b64_tr_b16 v[176:177], v187 offset:192
    ds_read_b64_tr_b16 v[178:179], v187 offset:4544
    v_max3_f32 v200, v100, v101, v102
    v_max3_f32 v200, v200, v103, v104
    v_max3_f32 v200, v200, v105, v106
    v_max_f32 v200, v200, v107
    v_cmp_lt_f32 vcc, s61, v200
    s_nop 0
    s_cbranch_vccnz L_slow_H0
L_back_H0:
    v_exp_f32 v100, v100
    v_exp_f32 v101, v101
    v_exp_f32 v102, v102
    v_exp_f32 v103, v103
    v_cvt_pk_bf16_f32 v100, v100, v101
    v_cvt_pk_bf16_f32 v101, v102, v103
    v_exp_f32 v104, v104
    v_exp_f32 v105, v105
    v_exp_f32 v106, v106
    v_exp_f32 v107, v107
    v_cvt_pk_bf16_f32 v102, v104, v105
    v_cvt_pk_bf16_f32 v103, v106, v107
    v_max3_f32 v200, v108, v109, v110
    v_max3_f32 v200, v200, v111, v112
    v_max3_f32 v200, v200, v113, v114
    v_max_f32 v200, v200, v115
    v_cmp_lt_f32 vcc, s61, v200
    s_nop 0
    s_cbranch_vccnz L_slow_H1
L_back_H1:
    v_exp_f32 v108, v108
    v_exp_f32 v109, v109
    v_exp_f32 v110, v110
    v_exp_f32 v111, v111
    v_cvt_pk_bf16_f32 v108, v108, v109
    v_cvt_pk_bf16_f32 v109, v110, v111
    v_exp_f32 v112, v112
    v_exp_f32 v113, v113
    v_exp_f32 v114, v114
    v_exp_f32 v115, v115
    v_cvt_pk_bf16_f32 v110, v112, v113
    v_cvt_pk_bf16_f32 v111, v114, v115
    s_mov_b32 s47, 0
    s_mov_b32 s61, 0x41000000
    s_waitcnt lgkmcnt(8)
    v_mfma_f32_16x16x32_bf16 v[4:7], v[148:151], v[100:103], v[4:7]
    v_mfma_f32_16x16x32_bf16 v[12:15], v[156:159], v[100:103], v[12:15]
    v_mfma_f32_16x16x32_bf16 v[20:23], v[164:167], v[100:103], v[20:23]
    v_mfma_f32_16x16x32_bf16 v[28:31], v[172:175], v[100:103], v[28:31]
    s_waitcnt lgkmcnt(0)
    v_mfma_f32_16x16x32_bf16 v[8:11], v[152:155], v[100:103], v[8:11]
    v_mfma_f32_16x16x32_bf16 v[16:19], v[160:163], v[100:103], v[16:19]
    v_mfma_f32_16x16x32_bf16 v[24:27], v[168:171], v[100:103], v[24:27]
    v_mfma_f32_16x16x32_bf16 v[32:35], v[176:179], v[100:103], v[32:35]
    v_mfma_f32_16x16x32_bf16 v[188:191], v[196:199], v[100:103], v[188:191]
    v_mfma_f32_16x16x32_bf16 v[36:39], v[148:151], v[108:111], v[36:39]
    ds_read_b128 v[148:151], v184 offset:0
    v_mfma_f32_16x16x32_bf16 v[44:47], v[156:159], v[108:111], v[44:47]
    ds_read_b128 v[156:159], v184 offset:64
    v_mfma_f32_16x16x32_bf16 v[52:55], v[164:167], v[108:111], v[52:55]
    ds_read_b128 v[164:167], v184 offset:128
    v_mfma_f32_16x16x32_bf16 v[60:63], v[172:175], v[108:111], v[60:63]
    ds_read_b128 v[172:175], v184 offset:192
    v_mfma_f32_16x16x32_bf16 v[40:43], v[152:155], v[108:111], v[40:43]
    ds_read_b128 v[152:155], v185 offset:0
    v_mfma_f32_16x16x32_bf16 v[48:51], v[160:163], v[108:111], v[48:51]
    ds_read_b128 v[160:163], v185 offset:64
    v_mfma_f32_16x16x32_bf16 v[56:59], v[168:171], v[108:111], v[56:59]
    ds_read_b128 v[168:171], v185 offset:128
    v_mfma_f32_16x16x32_bf16 v[64:67], v[176:179], v[108:111], v[64:67]
    v_mfma_f32_16x16x32_bf16 v[192:195], v[196:199], v[108:111], v[192:195]
    ds_read_b128 v[176:179], v185 offset:192
    s_add_u32 s60, s60, 1
    s_cmp_lt_u32 s60, 16
    s_cbranch_scc1 L_safe_H
    s_waitcnt lgkmcnt(0)
    s_branch L_epi_H
L_slow_H0:
    v_mov_b32 v201, v200
    s_nop 1
    v_permlane32_swap_b32 v200, v201
    v_max_f32 v200, v200, v201
    v_mov_b32 v201, v200
    s_nop 1
    v_permlane16_swap_b32 v200, v201
    v_max_f32 v200, v200, v201
    v_max_f32 v200, s47, v200
    v_min_f32_e64 v201, -v200, 0
    v_exp_f32 v201, v201
    v_sub_f32 v100, v100, v200
    v_sub_f32 v101, v101, v200
    v_sub_f32 v102, v102, v200
    v_sub_f32 v103, v103, v200
    v_sub_f32 v104, v104, v200
    v_sub_f32 v105, v105, v200
    v_sub_f32 v106, v106, v200
    v_sub_f32 v107, v107, v200
    v_sub_f32 v116, v116, v200
    v_sub_f32 v117, v117, v200
    v_sub_f32 v118, v118, v200
    v_sub_f32 v119, v119, v200
    v_mul_f32 v188, v188, v201
    v_mul_f32 v189, v189, v201
    v_mul_f32 v190, v190, v201
    v_mul_f32 v191, v191, v201
    v_mul_f32 v4, v4, v201
    v_mul_f32 v5, v5, v201
    v_mul_f32 v6, v6, v201
    v_mul_f32 v7, v7, v201
    v_mul_f32 v8, v8, v201
    v_mul_f32 v9, v9, v201
    v_mul_f32 v10, v10, v201
    v_mul_f32 v11, v11, v201
    v_mul_f32 v12, v12, v201
    v_mul_f32 v13, v13, v201
    v_mul_f32 v14, v14, v201
    v_mul_f32 v15, v15, v201
    v_mul_f32 v16, v16, v201
    v_mul_f32 v17, v17, v201
    v_mul_f32 v18, v18, v201
    v_mul_f32 v19, v19, v201
    v_mul_f32 v20, v20, v201
    v_mul_f32 v21, v21, v201
    v_mul_f32 v22, v22, v201
    v_mul_f32 v23, v23, v201
    v_mul_f32 v24, v24, v201
    v_mul_f32 v25, v25, v201
    v_mul_f32 v26, v26, v201
    v_mul_f32 v27, v27, v201
    v_mul_f32 v28, v28, v201
    v_mul_f32 v29, v29, v201
    v_mul_f32 v30, v30, v201
    v_mul_f32 v31, v31, v201
    v_mul_f32 v32, v32, v201
    v_mul_f32 v33, v33, v201
    v_mul_f32 v34, v34, v201
    v_mul_f32 v35, v35, v201
    s_branch L_back_H0
L_slow_H1:
    v_mov_b32 v201, v200
    s_nop 1
    v_permlane32_swap_b32 v200, v201
    v_max_f32 v200, v200, v201
    v_mov_b32 v201, v200
    s_nop 1
    v_permlane16_swap_b32 v200, v201
    v_max_f32 v200, v200, v201
    v_max_f32 v200, s47, v200
    v_min_f32_e64 v201, -v200, 0
    v_exp_f32 v201, v201
    v_sub_f32 v108, v108, v200
    v_sub_f32 v109, v109, v200
    v_sub_f32 v110, v110, v200
    v_sub_f32 v111, v111, v200
    v_sub_f32 v112, v112, v200
    v_sub_f32 v113, v113, v200
    v_sub_f32 v114, v114, v200
    v_sub_f32 v115, v115, v200
    v_sub_f32 v120, v120, v200
    v_sub_f32 v121, v121, v200
    v_sub_f32 v122, v122, v200
    v_sub_f32 v123, v123, v200
    v_mul_f32 v192, v192, v201
    v_mul_f32 v193, v193, v201
    v_mul_f32 v194, v194, v201
    v_mul_f32 v195, v195, v201
    v_mul_f32 v36, v36, v201
    v_mul_f32 v37, v37, v201
    v_mul_f32 v38, v38, v201
    v_mul_f32 v39, v39, v201
    v_mul_f32 v40, v40, v201
    v_mul_f32 v41, v41, v201
    v_mul_f32 v42, v42, v201
    v_mul_f32 v43, v43, v201
    v_mul_f32 v44, v44, v201
    v_mul_f32 v45, v45, v201
    v_mul_f32 v46, v46, v201
    v_mul_f32 v47, v47, v201
    v_mul_f32 v48, v48, v201
    v_mul_f32 v49, v49, v201
    v_mul_f32 v50, v50, v201
    v_mul_f32 v51, v51, v201
    v_mul_f32 v52, v52, v201
    v_mul_f32 v53, v53, v201
    v_mul_f32 v54, v54, v201
    v_mul_f32 v55, v55, v201
    v_mul_f32 v56, v56, v201
    v_mul_f32 v57, v57, v201
    v_mul_f32 v58, v58, v201
    v_mul_f32 v59, v59, v201
    v_mul_f32 v60, v60, v201
    v_mul_f32 v61, v61, v201
    v_mul_f32 v62, v62, v201
    v_mul_f32 v63, v63, v201
    v_mul_f32 v64, v64, v201
    v_mul_f32 v65, v65, v201
    v_mul_f32 v66, v66, v201
    v_mul_f32 v67, v67, v201
    s_branch L_back_H1
L_F:
    s_mov_b32 s50, 17408
    s_mov_b32 s51, 69632
    s_mov_b32 s52, 104448
    s_mov_b32 s53, 121856
    s_mov_b32 s54, 0
    s_mov_b32 s55, 34816
    s_mov_b32 s56, 52224
    s_mov_b32 s57, 87040
    s_mov_b32 s58, 139264
    s_mov_b32 s61, 0xff800000
    s_mov_b32 s47, 0xff800000
    s_mov_b32 s62, 0x3e0293ee
    s_mov_b32 s63, s62
    s_mul_i32 s77, s48, 3
    s_mul_i32 s100, s49, 10
    s_add_u32 s100, s100, s77
    s_lshl_b32 s100, s100, 12
    v_lshrrev_b32 v1, 4, v0
    v_and_b32 v2, 15, v0
    s_lshl_b32 s59, s77, 11
    s_add_u32 s59, s59, 52224
    v_lshrrev_b32 v252, 1, v2
    v_xor_b32 v252, v252, v1
    v_lshlrev_b32 v3, 7, v2
    v_add_u32 v3, s59, v3
    v_xor_b32 v253, 0, v252
    v_lshl_add_u32 v236, v253, 4, v3
    v_add_u32 v238, 72704, v236
    v_xor_b32 v253, 4, v252
    v_lshl_add_u32 v237, v253, 4, v3
    v_add_u32 v239, 72704, v237
    v_and_b32 v3, 7, v2
    v_mul_u32_u24 v3, 1056, v3
    v_lshrrev_b32 v252, 3, v2
    v_lshl_add_u32 v3, v252, 8, v3
    s_mul_i32 s59, s49, 8448
    v_add_u32 v3, s59, v3
    v_lshl_add_u32 v228, v1, 4, v3
    v_xor_b32 v252, 1, v1
    v_lshl_add_u32 v229, v252, 4, v3
    v_add_u32 v229, 512, v229
    v_bfe_u32 v3, v0, 2, 2
    v_mul_u32_u24 v3, 1088, v3
    v_and_b32 v252, 3, v0
    v_lshl_add_u32 v3, v252, 3, v3
    s_mul_i32 s59, s49, 8704
    v_add_u32 v3, s59, v3
    v_and_b32 v252, 1, v1
    v_xor_b32 v253, 1, v252
    v_lshl_add_u32 v2, v1, 8, v3
    v_lshl_add_u32 v230, v252, 5, v2
    v_lshl_add_u32 v231, v253, 5, v2
    v_lshrrev_b32 v2, 1, v1
    v_mul_u32_u24 v2, 4352, v2
    v_add_u32 v2, v2, v3
    v_lshl_add_u32 v2, v252, 9, v2
    v_add_u32 v2, 72704, v2
    v_lshl_add_u32 v240, v252, 5, v2
    v_lshl_add_u32 v241, v253, 5, v2
    v_add_u32 v242, 72704, v240
    v_add_u32 v243, 72704, v241
    s_waitcnt lgkmcnt(0)
    s_cmp_eq_u32 s42, 0
    s_cselect_b64 s[18:19], s[18:19], s[28:29]
    s_cselect_b64 s[20:21], s[20:21], s[30:31]
    s_lshl_b32 s59, s44, 5
    s_add_u32 s59, s59, s46
    s_add_u32 s59, s59, s48
    s_lshl_b32 s59, s59, 17
    s_add_u32 s4, s18, s59
    s_addc_u32 s5, s19, 0
    s_mov_b32 s6, 131072
    s_mov_b32 s7, 0x20000
    s_lshl_b32 s64, s49, 10
    s_add_u32 s64, s64, 8192
    s_mul_i32 s70, s48, 8448
    s_mul_i32 s59, s49, 4224
    s_add_u32 s70, s70, s59
    v_lshrrev_b32 v1, 4, v0
    v_lshrrev_b32 v2, 5, v0
    v_xor_b32 v2, v2, v0
    v_and_b32 v2, 15, v2
    v_lshlrev_b32 v2, 4, v2
    v_lshl_add_u32 v244, v1, 11, v2
    s_lshl_b32 s59, s42, 3
    s_add_u32 s59, s59, s44
    s_lshl_b32 s78, s59, 4
    s_add_u32 s38, s38, s78
    s_addc_u32 s39, s39, 0
    s_lshl_b32 s59, s59, 11
    s_add_u32 s59, s59, 50331648
    s_add_u32 s20, s40, s59
    s_addc_u32 s21, s41, 0
    s_mov_b32 s22, 2048
    s_mov_b32 s23, 0x20000
    s_lshl_b32 s74, s43, 2
    s_add_u32 s74, s74, s45
    s_lshl_b32 s75, s74, 7
    v_mov_b32 v252, 0
    v_lshlrev_b32 v253, 7, v0
    s_or_b32 s75, s74, s3
    s_cbranch_scc1 L_noinit
    s_mov_b64 exec, 0xffff
    buffer_store_dword v252, v253, s[20:23], 0 offen sc1
    s_mov_b64 exec, -1
L_noinit:
    s_lshl_b32 s78, s42, 3
    s_add_u32 s78, s78, s44
    s_lshl_b32 s78, s78, 2
    s_add_u32 s59, s78, s43
    s_mul_i32 s59, s59, 327680
    s_add_u32 s59, s59, s100
    s_add_u32 s12, s40, s59
    s_addc_u32 s13, s41, 0
    s_mov_b32 s14, 258048
    s_mov_b32 s15, 0x20000
    s_add_u32 s59, s78, s45
    s_mul_i32 s59, s59, 81920
    s_add_u32 s59, s59, s100
    s_lshl_b32 s59, s59, 1
    s_add_u32 s59, s59, 33554432
    s_add_u32 s24, s40, s59
    s_addc_u32 s25, s41, 0
    s_mov_b32 s26, 24576
    s_mov_b32 s27, 0x20000
    s_barrier
    ds_read_b128 v[132:135], v236 offset:0
    ds_read_b128 v[136:139], v236 offset:2048
    ds_read_b128 v[140:143], v236 offset:4096
    ds_read_b64_tr_b16 v[100:101], v240 offset:0
    ds_read_b64_tr_b16 v[102:103], v240 offset:256
    ds_read_b64_tr_b16 v[104:105], v241 offset:0
    ds_read_b64_tr_b16 v[106:107], v241 offset:256
    ds_read_b64_tr_b16 v[108:109], v240 offset:64
    ds_read_b64_tr_b16 v[110:111], v240 offset:320
    ds_read_b64_tr_b16 v[112:113], v241 offset:64
    ds_read_b64_tr_b16 v[114:115], v241 offset:320
    ds_read_b64_tr_b16 v[116:117], v240 offset:128
    ds_read_b64_tr_b16 v[118:119], v240 offset:384
    ds_read_b64_tr_b16 v[120:121], v241 offset:128
    ds_read_b64_tr_b16 v[122:123], v241 offset:384
    ds_read_b64_tr_b16 v[124:125], v240 offset:192
    ds_read_b64_tr_b16 v[126:127], v240 offset:448
    ds_read_b64_tr_b16 v[128:129], v241 offset:192
    ds_read_b64_tr_b16 v[130:131], v241 offset:448
    s_waitcnt lgkmcnt(0)
    s_barrier
    v_mfma_f32_16x16x32_bf16 v[4:7], v[100:103], v[132:135], 0
    ds_read_b128 v[180:183], v237 offset:0
    v_mfma_f32_16x16x32_bf16 v[36:39], v[100:103], v[136:139], 0
    ds_read_b128 v[184:187], v237 offset:2048
    v_mfma_f32_16x16x32_bf16 v[68:71], v[100:103], v[140:143], 0
    ds_read_b128 v[188:191], v237 offset:4096
    v_mfma_f32_16x16x32_bf16 v[8:11], v[104:107], v[132:135], 0
    ds_read_b64_tr_b16 v[148:149], v240 offset:17408
    v_mfma_f32_16x16x32_bf16 v[40:43], v[104:107], v[136:139], 0
    ds_read_b64_tr_b16 v[150:151], v240 offset:17664
    v_mfma_f32_16x16x32_bf16 v[72:75], v[104:107], v[140:143], 0
    ds_read_b64_tr_b16 v[152:153], v241 offset:17408
    v_mfma_f32_16x16x32_bf16 v[12:15], v[108:111], v[132:135], 0
    ds_read_b64_tr_b16 v[154:155], v241 offset:17664
    v_mfma_f32_16x16x32_bf16 v[44:47], v[108:111], v[136:139], 0
    ds_read_b64_tr_b16 v[156:157], v240 offset:17472
    v_mfma_f32_16x16x32_bf16 v[76:79], v[108:111], v[140:143], 0
    ds_read_b64_tr_b16 v[158:159], v240 offset:17728
    v_mfma_f32_16x16x32_bf16 v[16:19], v[112:115], v[132:135], 0
    ds_read_b64_tr_b16 v[160:161], v241 offset:17472
    v_mfma_f32_16x16x32_bf16 v[48:51], v[112:115], v[136:139], 0
    ds_read_b64_tr_b16 v[162:163], v241 offset:17728
    v_mfma_f32_16x16x32_bf16 v[80:83], v[112:115], v[140:143], 0
    ds_read_b64_tr_b16 v[164:165], v240 offset:17536
    v_mfma_f32_16x16x32_bf16 v[20:23], v[116:119], v[132:135], 0
    ds_read_b64_tr_b16 v[166:167], v240 offset:17792
    v_mfma_f32_16x16x32_bf16 v[52:55], v[116:119], v[136:139], 0
    ds_read_b64_tr_b16 v[168:169], v241 offset:17536
    v_mfma_f32_16x16x32_bf16 v[84:87], v[116:119], v[140:143], 0
    ds_read_b64_tr_b16 v[170:171], v241 offset:17792
    v_mfma_f32_16x16x32_bf16 v[24:27], v[120:123], v[132:135], 0
    ds_read_b64_tr_b16 v[172:173], v240 offset:17600
    v_mfma_f32_16x16x32_bf16 v[56:59], v[120:123], v[136:139], 0
    ds_read_b64_tr_b16 v[174:175], v240 offset:17856
    v_mfma_f32_16x16x32_bf16 v[88:91], v[120:123], v[140:143], 0
    ds_read_b64_tr_b16 v[176:177], v241 offset:17600
    v_mfma_f32_16x16x32_bf16 v[28:31], v[124:127], v[132:135], 0
    ds_read_b64_tr_b16 v[178:179], v241 offset:17856
    v_mfma_f32_16x16x32_bf16 v[60:63], v[124:127], v[136:139], 0
    v_mfma_f32_16x16x32_bf16 v[92:95], v[124:127], v[140:143], 0
    v_mfma_f32_16x16x32_bf16 v[32:35], v[128:131], v[132:135], 0
    v_mfma_f32_16x16x32_bf16 v[64:67], v[128:131], v[136:139], 0
    v_mfma_f32_16x16x32_bf16 v[96:99], v[128:131], v[140:143], 0
    s_waitcnt lgkmcnt(0)
    s_barrier
    v_mfma_f32_16x16x32_bf16 v[4:7], v[148:151], v[180:183], v[4:7]
    ds_read_b128 v[132:135], v238 offset:0
    v_mfma_f32_16x16x32_bf16 v[36:39], v[148:151], v[184:187], v[36:39]
    ds_read_b128 v[136:139], v238 offset:2048
    v_mfma_f32_16x16x32_bf16 v[68:71], v[148:151], v[188:191], v[68:71]
    ds_read_b128 v[140:143], v238 offset:4096
    v_mfma_f32_16x16x32_bf16 v[8:11], v[152:155], v[180:183], v[8:11]
    ds_read_b64_tr_b16 v[100:101], v240 offset:34816
    v_mfma_f32_16x16x32_bf16 v[40:43], v[152:155], v[184:187], v[40:43]
    ds_read_b64_tr_b16 v[102:103], v240 offset:35072
    v_mfma_f32_16x16x32_bf16 v[72:75], v[152:155], v[188:191], v[72:75]
    ds_read_b64_tr_b16 v[104:105], v241 offset:34816
    v_mfma_f32_16x16x32_bf16 v[12:15], v[156:159], v[180:183], v[12:15]
    ds_read_b64_tr_b16 v[106:107], v241 offset:35072
    v_mfma_f32_16x16x32_bf16 v[44:47], v[156:159], v[184:187], v[44:47]
    ds_read_b64_tr_b16 v[108:109], v240 offset:34880
    v_mfma_f32_16x16x32_bf16 v[76:79], v[156:159], v[188:191], v[76:79]
    ds_read_b64_tr_b16 v[110:111], v240 offset:35136
    v_mfma_f32_16x16x32_bf16 v[16:19], v[160:163], v[180:183], v[16:19]
    ds_read_b64_tr_b16 v[112:113], v241 offset:34880
    v_mfma_f32_16x16x32_bf16 v[48:51], v[160:163], v[184:187], v[48:51]
    ds_read_b64_tr_b16 v[114:115], v241 offset:35136
    v_mfma_f32_16x16x32_bf16 v[80:83], v[160:163], v[188:191], v[80:83]
    ds_read_b64_tr_b16 v[116:117], v240 offset:34944
    v_mfma_f32_16x16x32_bf16 v[20:23], v[164:167], v[180:183], v[20:23]
    ds_read_b64_tr_b16 v[118:119], v240 offset:35200
    v_mfma_f32_16x16x32_bf16 v[52:55], v[164:167], v[184:187], v[52:55]
    ds_read_b64_tr_b16 v[120:121], v241 offset:34944
    v_mfma_f32_16x16x32_bf16 v[84:87], v[164:167], v[188:191], v[84:87]
    ds_read_b64_tr_b16 v[122:123], v241 offset:35200
    v_mfma_f32_16x16x32_bf16 v[24:27], v[168:171], v[180:183], v[24:27]
    ds_read_b64_tr_b16 v[124:125], v240 offset:35008
    v_mfma_f32_16x16x32_bf16 v[56:59], v[168:171], v[184:187], v[56:59]
    ds_read_b64_tr_b16 v[126:127], v240 offset:35264
    v_mfma_f32_16x16x32_bf16 v[88:91], v[168:171], v[188:191], v[88:91]
    ds_read_b64_tr_b16 v[128:129], v241 offset:35008
    v_mfma_f32_16x16x32_bf16 v[28:31], v[172:175], v[180:183], v[28:31]
    ds_read_b64_tr_b16 v[130:131], v241 offset:35264
    v_mfma_f32_16x16x32_bf16 v[60:63], v[172:175], v[184:187], v[60:63]
    v_mfma_f32_16x16x32_bf16 v[92:95], v[172:175], v[188:191], v[92:95]
    v_mfma_f32_16x16x32_bf16 v[32:35], v[176:179], v[180:183], v[32:35]
    v_mfma_f32_16x16x32_bf16 v[64:67], v[176:179], v[184:187], v[64:67]
    v_mfma_f32_16x16x32_bf16 v[96:99], v[176:179], v[188:191], v[96:99]
    s_waitcnt lgkmcnt(0)
    s_barrier
    v_mfma_f32_16x16x32_bf16 v[4:7], v[100:103], v[132:135], v[4:7]
    ds_read_b128 v[180:183], v239 offset:0
    v_mfma_f32_16x16x32_bf16 v[36:39], v[100:103], v[136:139], v[36:39]
    ds_read_b128 v[184:187], v239 offset:2048
    v_mfma_f32_16x16x32_bf16 v[68:71], v[100:103], v[140:143], v[68:71]
    ds_read_b128 v[188:191], v239 offset:4096
    v_mfma_f32_16x16x32_bf16 v[8:11], v[104:107], v[132:135], v[8:11]
    ds_read_b64_tr_b16 v[148:149], v242 offset:0
    v_mfma_f32_16x16x32_bf16 v[40:43], v[104:107], v[136:139], v[40:43]
    ds_read_b64_tr_b16 v[150:151], v242 offset:256
    v_mfma_f32_16x16x32_bf16 v[72:75], v[104:107], v[140:143], v[72:75]
    ds_read_b64_tr_b16 v[152:153], v243 offset:0
    v_mfma_f32_16x16x32_bf16 v[12:15], v[108:111], v[132:135], v[12:15]
    ds_read_b64_tr_b16 v[154:155], v243 offset:256
    v_mfma_f32_16x16x32_bf16 v[44:47], v[108:111], v[136:139], v[44:47]
    ds_read_b64_tr_b16 v[156:157], v242 offset:64
    v_mfma_f32_16x16x32_bf16 v[76:79], v[108:111], v[140:143], v[76:79]
    ds_read_b64_tr_b16 v[158:159], v242 offset:320
    v_mfma_f32_16x16x32_bf16 v[16:19], v[112:115], v[132:135], v[16:19]
    ds_read_b64_tr_b16 v[160:161], v243 offset:64
    v_mfma_f32_16x16x32_bf16 v[48:51], v[112:115], v[136:139], v[48:51]
    ds_read_b64_tr_b16 v[162:163], v243 offset:320
    v_mfma_f32_16x16x32_bf16 v[80:83], v[112:115], v[140:143], v[80:83]
    ds_read_b64_tr_b16 v[164:165], v242 offset:128
    v_mfma_f32_16x16x32_bf16 v[20:23], v[116:119], v[132:135], v[20:23]
    ds_read_b64_tr_b16 v[166:167], v242 offset:384
    v_mfma_f32_16x16x32_bf16 v[52:55], v[116:119], v[136:139], v[52:55]
    ds_read_b64_tr_b16 v[168:169], v243 offset:128
    v_mfma_f32_16x16x32_bf16 v[84:87], v[116:119], v[140:143], v[84:87]
    ds_read_b64_tr_b16 v[170:171], v243 offset:384
    v_mfma_f32_16x16x32_bf16 v[24:27], v[120:123], v[132:135], v[24:27]
    ds_read_b64_tr_b16 v[172:173], v242 offset:192
    v_mfma_f32_16x16x32_bf16 v[56:59], v[120:123], v[136:139], v[56:59]
    ds_read_b64_tr_b16 v[174:175], v242 offset:448
    v_mfma_f32_16x16x32_bf16 v[88:91], v[120:123], v[140:143], v[88:91]
    ds_read_b64_tr_b16 v[176:177], v243 offset:192
    v_mfma_f32_16x16x32_bf16 v[28:31], v[124:127], v[132:135], v[28:31]
    ds_read_b64_tr_b16 v[178:179], v243 offset:448
    v_mfma_f32_16x16x32_bf16 v[60:63], v[124:127], v[136:139], v[60:63]
    v_mfma_f32_16x16x32_bf16 v[92:95], v[124:127], v[140:143], v[92:95]
    v_mfma_f32_16x16x32_bf16 v[32:35], v[128:131], v[132:135], v[32:35]
    v_mfma_f32_16x16x32_bf16 v[64:67], v[128:131], v[136:139], v[64:67]
    v_mfma_f32_16x16x32_bf16 v[96:99], v[128:131], v[140:143], v[96:99]
    s_waitcnt lgkmcnt(0)
    s_barrier
    v_mfma_f32_16x16x32_bf16 v[4:7], v[148:151], v[180:183], v[4:7]
    ds_read_b128 v[132:135], v236 offset:0
    v_mfma_f32_16x16x32_bf16 v[36:39], v[148:151], v[184:187], v[36:39]
    ds_read_b128 v[136:139], v236 offset:2048
    v_mfma_f32_16x16x32_bf16 v[68:71], v[148:151], v[188:191], v[68:71]
    ds_read_b128 v[140:143], v236 offset:4096
    v_mfma_f32_16x16x32_bf16 v[8:11], v[152:155], v[180:183], v[8:11]
    ds_read_b64_tr_b16 v[100:101], v240 offset:0
    v_mfma_f32_16x16x32_bf16 v[40:43], v[152:155], v[184:187], v[40:43]
    ds_read_b64_tr_b16 v[102:103], v240 offset:256
    v_mfma_f32_16x16x32_bf16 v[72:75], v[152:155], v[188:191], v[72:75]
    ds_read_b64_tr_b16 v[104:105], v241 offset:0
    v_mfma_f32_16x16x32_bf16 v[12:15], v[156:159], v[180:183], v[12:15]
    ds_read_b64_tr_b16 v[106:107], v241 offset:256
    v_mfma_f32_16x16x32_bf16 v[44:47], v[156:159], v[184:187], v[44:47]
    ds_read_b64_tr_b16 v[108:109], v240 offset:64
    v_mfma_f32_16x16x32_bf16 v[76:79], v[156:159], v[188:191], v[76:79]
    ds_read_b64_tr_b16 v[110:111], v240 offset:320
    v_mfma_f32_16x16x32_bf16 v[16:19], v[160:163], v[180:183], v[16:19]
    ds_read_b64_tr_b16 v[112:113], v241 offset:64
    v_mfma_f32_16x16x32_bf16 v[48:51], v[160:163], v[184:187], v[48:51]
    ds_read_b64_tr_b16 v[114:115], v241 offset:320
    v_mfma_f32_16x16x32_bf16 v[80:83], v[160:163], v[188:191], v[80:83]
    ds_read_b64_tr_b16 v[116:117], v240 offset:128
    v_mfma_f32_16x16x32_bf16 v[20:23], v[164:167], v[180:183], v[20:23]
    ds_read_b64_tr_b16 v[118:119], v240 offset:384
    v_mfma_f32_16x16x32_bf16 v[52:55], v[164:167], v[184:187], v[52:55]
    ds_read_b64_tr_b16 v[120:121], v241 offset:128
    v_mfma_f32_16x16x32_bf16 v[84:87], v[164:167], v[188:191], v[84:87]
    ds_read_b64_tr_b16 v[122:123], v241 offset:384
    v_mfma_f32_16x16x32_bf16 v[24:27], v[168:171], v[180:183], v[24:27]
    ds_read_b64_tr_b16 v[124:125], v240 offset:192
    v_mfma_f32_16x16x32_bf16 v[56:59], v[168:171], v[184:187], v[56:59]
    ds_read_b64_tr_b16 v[126:127], v240 offset:448
    v_mfma_f32_16x16x32_bf16 v[88:91], v[168:171], v[188:191], v[88:91]
    ds_read_b64_tr_b16 v[128:129], v241 offset:192
    v_mfma_f32_16x16x32_bf16 v[28:31], v[172:175], v[180:183], v[28:31]
    ds_read_b64_tr_b16 v[130:131], v241 offset:448
    v_mfma_f32_16x16x32_bf16 v[60:63], v[172:175], v[184:187], v[60:63]
    v_mfma_f32_16x16x32_bf16 v[92:95], v[172:175], v[188:191], v[92:95]
    v_mfma_f32_16x16x32_bf16 v[32:35], v[176:179], v[180:183], v[32:35]
    v_mfma_f32_16x16x32_bf16 v[64:67], v[176:179], v[184:187], v[64:67]
    v_mfma_f32_16x16x32_bf16 v[96:99], v[176:179], v[188:191], v[96:99]
    s_waitcnt lgkmcnt(0)
    s_barrier
    v_mfma_f32_16x16x32_bf16 v[4:7], v[100:103], v[132:135], v[4:7]
    ds_read_b128 v[180:183], v237 offset:0
    v_mfma_f32_16x16x32_bf16 v[36:39], v[100:103], v[136:139], v[36:39]
    ds_read_b128 v[184:187], v237 offset:2048
    v_mfma_f32_16x16x32_bf16 v[68:71], v[100:103], v[140:143], v[68:71]
    ds_read_b128 v[188:191], v237 offset:4096
    v_mfma_f32_16x16x32_bf16 v[8:11], v[104:107], v[132:135], v[8:11]
    ds_read_b64_tr_b16 v[148:149], v240 offset:17408
    v_mfma_f32_16x16x32_bf16 v[40:43], v[104:107], v[136:139], v[40:43]
    ds_read_b64_tr_b16 v[150:151], v240 offset:17664
    v_mfma_f32_16x16x32_bf16 v[72:75], v[104:107], v[140:143], v[72:75]
    ds_read_b64_tr_b16 v[152:153], v241 offset:17408
    v_mfma_f32_16x16x32_bf16 v[12:15], v[108:111], v[132:135], v[12:15]
    ds_read_b64_tr_b16 v[154:155], v241 offset:17664
    v_mfma_f32_16x16x32_bf16 v[44:47], v[108:111], v[136:139], v[44:47]
    ds_read_b64_tr_b16 v[156:157], v240 offset:17472
    v_mfma_f32_16x16x32_bf16 v[76:79], v[108:111], v[140:143], v[76:79]
    ds_read_b64_tr_b16 v[158:159], v240 offset:17728
    v_mfma_f32_16x16x32_bf16 v[16:19], v[112:115], v[132:135], v[16:19]
    ds_read_b64_tr_b16 v[160:161], v241 offset:17472
    v_mfma_f32_16x16x32_bf16 v[48:51], v[112:115], v[136:139], v[48:51]
    ds_read_b64_tr_b16 v[162:163], v241 offset:17728
    v_mfma_f32_16x16x32_bf16 v[80:83], v[112:115], v[140:143], v[80:83]
    ds_read_b64_tr_b16 v[164:165], v240 offset:17536
    v_mfma_f32_16x16x32_bf16 v[20:23], v[116:119], v[132:135], v[20:23]
    ds_read_b64_tr_b16 v[166:167], v240 offset:17792
    v_mfma_f32_16x16x32_bf16 v[52:55], v[116:119], v[136:139], v[52:55]
    ds_read_b64_tr_b16 v[168:169], v241 offset:17536
    v_mfma_f32_16x16x32_bf16 v[84:87], v[116:119], v[140:143], v[84:87]
    ds_read_b64_tr_b16 v[170:171], v241 offset:17792
    v_mfma_f32_16x16x32_bf16 v[24:27], v[120:123], v[132:135], v[24:27]
    ds_read_b64_tr_b16 v[172:173], v240 offset:17600
    v_mfma_f32_16x16x32_bf16 v[56:59], v[120:123], v[136:139], v[56:59]
    ds_read_b64_tr_b16 v[174:175], v240 offset:17856
    v_mfma_f32_16x16x32_bf16 v[88:91], v[120:123], v[140:143], v[88:91]
    ds_read_b64_tr_b16 v[176:177], v241 offset:17600
    v_mfma_f32_16x16x32_bf16 v[28:31], v[124:127], v[132:135], v[28:31]
    ds_read_b64_tr_b16 v[178:179], v241 offset:17856
    v_mfma_f32_16x16x32_bf16 v[60:63], v[124:127], v[136:139], v[60:63]
    v_mfma_f32_16x16x32_bf16 v[92:95], v[124:127], v[140:143], v[92:95]
    v_mfma_f32_16x16x32_bf16 v[32:35], v[128:131], v[132:135], v[32:35]
    v_mfma_f32_16x16x32_bf16 v[64:67], v[128:131], v[136:139], v[64:67]
    v_mfma_f32_16x16x32_bf16 v[96:99], v[128:131], v[140:143], v[96:99]
    s_waitcnt lgkmcnt(0)
    s_barrier
    v_mfma_f32_16x16x32_bf16 v[4:7], v[148:151], v[180:183], v[4:7]
    ds_read_b128 v[132:135], v238 offset:0
    v_mfma_f32_16x16x32_bf16 v[36:39], v[148:151], v[184:187], v[36:39]
    ds_read_b128 v[136:139], v238 offset:2048
    v_mfma_f32_16x16x32_bf16 v[68:71], v[148:151], v[188:191], v[68:71]
    ds_read_b128 v[140:143], v238 offset:4096
    v_mfma_f32_16x16x32_bf16 v[8:11], v[152:155], v[180:183], v[8:11]
    ds_read_b64_tr_b16 v[100:101], v240 offset:34816
    v_mfma_f32_16x16x32_bf16 v[40:43], v[152:155], v[184:187], v[40:43]
    ds_read_b64_tr_b16 v[102:103], v240 offset:35072
    v_mfma_f32_16x16x32_bf16 v[72:75], v[152:155], v[188:191], v[72:75]
    ds_read_b64_tr_b16 v[104:105], v241 offset:34816
    v_mfma_f32_16x16x32_bf16 v[12:15], v[156:159], v[180:183], v[12:15]
    ds_read_b64_tr_b16 v[106:107], v241 offset:35072
    v_mfma_f32_16x16x32_bf16 v[44:47], v[156:159], v[184:187], v[44:47]
    ds_read_b64_tr_b16 v[108:109], v240 offset:34880
    v_mfma_f32_16x16x32_bf16 v[76:79], v[156:159], v[188:191], v[76:79]
    ds_read_b64_tr_b16 v[110:111], v240 offset:35136
    v_mfma_f32_16x16x32_bf16 v[16:19], v[160:163], v[180:183], v[16:19]
    ds_read_b64_tr_b16 v[112:113], v241 offset:34880
    v_mfma_f32_16x16x32_bf16 v[48:51], v[160:163], v[184:187], v[48:51]
    ds_read_b64_tr_b16 v[114:115], v241 offset:35136
    v_mfma_f32_16x16x32_bf16 v[80:83], v[160:163], v[188:191], v[80:83]
    ds_read_b64_tr_b16 v[116:117], v240 offset:34944
    v_mfma_f32_16x16x32_bf16 v[20:23], v[164:167], v[180:183], v[20:23]
    ds_read_b64_tr_b16 v[118:119], v240 offset:35200
    v_mfma_f32_16x16x32_bf16 v[52:55], v[164:167], v[184:187], v[52:55]
    ds_read_b64_tr_b16 v[120:121], v241 offset:34944
    v_mfma_f32_16x16x32_bf16 v[84:87], v[164:167], v[188:191], v[84:87]
    ds_read_b64_tr_b16 v[122:123], v241 offset:35200
    v_mfma_f32_16x16x32_bf16 v[24:27], v[168:171], v[180:183], v[24:27]
    ds_read_b64_tr_b16 v[124:125], v240 offset:35008
    v_mfma_f32_16x16x32_bf16 v[56:59], v[168:171], v[184:187], v[56:59]
    ds_read_b64_tr_b16 v[126:127], v240 offset:35264
    v_mfma_f32_16x16x32_bf16 v[88:91], v[168:171], v[188:191], v[88:91]
    ds_read_b64_tr_b16 v[128:129], v241 offset:35008
    v_mfma_f32_16x16x32_bf16 v[28:31], v[172:175], v[180:183], v[28:31]
    ds_read_b64_tr_b16 v[130:131], v241 offset:35264
    v_mfma_f32_16x16x32_bf16 v[60:63], v[172:175], v[184:187], v[60:63]
    v_mfma_f32_16x16x32_bf16 v[92:95], v[172:175], v[188:191], v[92:95]
    v_mfma_f32_16x16x32_bf16 v[32:35], v[176:179], v[180:183], v[32:35]
    v_mfma_f32_16x16x32_bf16 v[64:67], v[176:179], v[184:187], v[64:67]
    v_mfma_f32_16x16x32_bf16 v[96:99], v[176:179], v[188:191], v[96:99]
    s_add_u32 m0, s70, 17408
    s_nop 0
    buffer_load_dwordx4 v244, s[4:7], s64 offen offset:0 nt lds
    s_waitcnt lgkmcnt(0)
    s_barrier
    v_mfma_f32_16x16x32_bf16 v[4:7], v[100:103], v[132:135], v[4:7]
    ds_read_b128 v[180:183], v239 offset:0
    v_mfma_f32_16x16x32_bf16 v[36:39], v[100:103], v[136:139], v[36:39]
    ds_read_b128 v[184:187], v239 offset:2048
    v_mfma_f32_16x16x32_bf16 v[68:71], v[100:103], v[140:143], v[68:71]
    ds_read_b128 v[188:191], v239 offset:4096
    v_mfma_f32_16x16x32_bf16 v[8:11], v[104:107], v[132:135], v[8:11]
    ds_read_b64_tr_b16 v[148:149], v242 offset:0
    v_mfma_f32_16x16x32_bf16 v[40:43], v[104:107], v[136:139], v[40:43]
    ds_read_b64_tr_b16 v[150:151], v242 offset:256
    v_mfma_f32_16x16x32_bf16 v[72:75], v[104:107], v[140:143], v[72:75]
    ds_read_b64_tr_b16 v[152:153], v243 offset:0
    v_mfma_f32_16x16x32_bf16 v[12:15], v[108:111], v[132:135], v[12:15]
    ds_read_b64_tr_b16 v[154:155], v243 offset:256
    v_mfma_f32_16x16x32_bf16 v[44:47], v[108:111], v[136:139], v[44:47]
    ds_read_b64_tr_b16 v[156:157], v242 offset:64
    v_mfma_f32_16x16x32_bf16 v[76:79], v[108:111], v[140:143], v[76:79]
    ds_read_b64_tr_b16 v[158:159], v242 offset:320
    v_mfma_f32_16x16x32_bf16 v[16:19], v[112:115], v[132:135], v[16:19]
    ds_read_b64_tr_b16 v[160:161], v243 offset:64
    v_mfma_f32_16x16x32_bf16 v[48:51], v[112:115], v[136:139], v[48:51]
    ds_read_b64_tr_b16 v[162:163], v243 offset:320
    v_mfma_f32_16x16x32_bf16 v[80:83], v[112:115], v[140:143], v[80:83]
    ds_read_b64_tr_b16 v[164:165], v242 offset:128
    v_mfma_f32_16x16x32_bf16 v[20:23], v[116:119], v[132:135], v[20:23]
    ds_read_b64_tr_b16 v[166:167], v242 offset:384
    v_mfma_f32_16x16x32_bf16 v[52:55], v[116:119], v[136:139], v[52:55]
    ds_read_b64_tr_b16 v[168:169], v243 offset:128
    v_mfma_f32_16x16x32_bf16 v[84:87], v[116:119], v[140:143], v[84:87]
    ds_read_b64_tr_b16 v[170:171], v243 offset:384
    v_mfma_f32_16x16x32_bf16 v[24:27], v[120:123], v[132:135], v[24:27]
    ds_read_b64_tr_b16 v[172:173], v242 offset:192
    v_mfma_f32_16x16x32_bf16 v[56:59], v[120:123], v[136:139], v[56:59]
    ds_read_b64_tr_b16 v[174:175], v242 offset:448
    v_mfma_f32_16x16x32_bf16 v[88:91], v[120:123], v[140:143], v[88:91]
    ds_read_b64_tr_b16 v[176:177], v243 offset:192
    v_mfma_f32_16x16x32_bf16 v[28:31], v[124:127], v[132:135], v[28:31]
    ds_read_b64_tr_b16 v[178:179], v243 offset:448
    v_mfma_f32_16x16x32_bf16 v[60:63], v[124:127], v[136:139], v[60:63]
    v_mfma_f32_16x16x32_bf16 v[92:95], v[124:127], v[140:143], v[92:95]
    v_mfma_f32_16x16x32_bf16 v[32:35], v[128:131], v[132:135], v[32:35]
    v_mfma_f32_16x16x32_bf16 v[64:67], v[128:131], v[136:139], v[64:67]
    v_mfma_f32_16x16x32_bf16 v[96:99], v[128:131], v[140:143], v[96:99]
    s_add_u32 m0, s70, 18208
    s_nop 0
    buffer_load_dwordx4 v244, s[4:7], s64 offen offset:256 nt lds
    s_waitcnt lgkmcnt(0)
    s_barrier
    v_mfma_f32_16x16x32_bf16 v[4:7], v[148:151], v[180:183], v[4:7]
    ds_read_b128 v[132:135], v236 offset:0
    v_mfma_f32_16x16x32_bf16 v[36:39], v[148:151], v[184:187], v[36:39]
    ds_read_b128 v[136:139], v236 offset:2048
    v_mfma_f32_16x16x32_bf16 v[68:71], v[148:151], v[188:191], v[68:71]
    ds_read_b128 v[140:143], v236 offset:4096
    v_mfma_f32_16x16x32_bf16 v[8:11], v[152:155], v[180:183], v[8:11]
    ds_read_b64_tr_b16 v[100:101], v240 offset:0
    v_mfma_f32_16x16x32_bf16 v[40:43], v[152:155], v[184:187], v[40:43]
    ds_read_b64_tr_b16 v[102:103], v240 offset:256
    v_mfma_f32_16x16x32_bf16 v[72:75], v[152:155], v[188:191], v[72:75]
    ds_read_b64_tr_b16 v[104:105], v241 offset:0
    v_mfma_f32_16x16x32_bf16 v[12:15], v[156:159], v[180:183], v[12:15]
    ds_read_b64_tr_b16 v[106:107], v241 offset:256
    v_mfma_f32_16x16x32_bf16 v[44:47], v[156:159], v[184:187], v[44:47]
    ds_read_b64_tr_b16 v[108:109], v240 offset:64
    v_mfma_f32_16x16x32_bf16 v[76:79], v[156:159], v[188:191], v[76:79]
    ds_read_b64_tr_b16 v[110:111], v240 offset:320
    v_mfma_f32_16x16x32_bf16 v[16:19], v[160:163], v[180:183], v[16:19]
    ds_read_b64_tr_b16 v[112:113], v241 offset:64
    v_mfma_f32_16x16x32_bf16 v[48:51], v[160:163], v[184:187], v[48:51]
    ds_read_b64_tr_b16 v[114:115], v241 offset:320
    v_mfma_f32_16x16x32_bf16 v[80:83], v[160:163], v[188:191], v[80:83]
    ds_read_b64_tr_b16 v[116:117], v240 offset:128
    v_mfma_f32_16x16x32_bf16 v[20:23], v[164:167], v[180:183], v[20:23]
    ds_read_b64_tr_b16 v[118:119], v240 offset:384
    v_mfma_f32_16x16x32_bf16 v[52:55], v[164:167], v[184:187], v[52:55]
    ds_read_b64_tr_b16 v[120:121], v241 offset:128
    v_mfma_f32_16x16x32_bf16 v[84:87], v[164:167], v[188:191], v[84:87]
    ds_read_b64_tr_b16 v[122:123], v241 offset:384
    v_mfma_f32_16x16x32_bf16 v[24:27], v[168:171], v[180:183], v[24:27]
    ds_read_b64_tr_b16 v[124:125], v240 offset:192
    v_mfma_f32_16x16x32_bf16 v[56:59], v[168:171], v[184:187], v[56:59]
    ds_read_b64_tr_b16 v[126:127], v240 offset:448
    v_mfma_f32_16x16x32_bf16 v[88:91], v[168:171], v[188:191], v[88:91]
    ds_read_b64_tr_b16 v[128:129], v241 offset:192
    v_mfma_f32_16x16x32_bf16 v[28:31], v[172:175], v[180:183], v[28:31]
    ds_read_b64_tr_b16 v[130:131], v241 offset:448
    v_mfma_f32_16x16x32_bf16 v[60:63], v[172:175], v[184:187], v[60:63]
    v_mfma_f32_16x16x32_bf16 v[92:95], v[172:175], v[188:191], v[92:95]
    v_mfma_f32_16x16x32_bf16 v[32:35], v[176:179], v[180:183], v[32:35]
    v_mfma_f32_16x16x32_bf16 v[64:67], v[176:179], v[184:187], v[64:67]
    v_mfma_f32_16x16x32_bf16 v[96:99], v[176:179], v[188:191], v[96:99]
    s_add_u32 m0, s70, 19008
    s_nop 0
    buffer_load_dwordx4 v244, s[4:7], s64 offen offset:512 nt lds
    s_waitcnt lgkmcnt(0)
    s_barrier
    v_mfma_f32_16x16x32_bf16 v[4:7], v[100:103], v[132:135], v[4:7]
    ds_read_b128 v[180:183], v237 offset:0
    v_mfma_f32_16x16x32_bf16 v[36:39], v[100:103], v[136:139], v[36:39]
    ds_read_b128 v[184:187], v237 offset:2048
    v_mfma_f32_16x16x32_bf16 v[68:71], v[100:103], v[140:143], v[68:71]
    ds_read_b128 v[188:191], v237 offset:4096
    v_mfma_f32_16x16x32_bf16 v[8:11], v[104:107], v[132:135], v[8:11]
    ds_read_b64_tr_b16 v[148:149], v240 offset:17408
    v_mfma_f32_16x16x32_bf16 v[40:43], v[104:107], v[136:139], v[40:43]
    ds_read_b64_tr_b16 v[150:151], v240 offset:17664
    v_mfma_f32_16x16x32_bf16 v[72:75], v[104:107], v[140:143], v[72:75]
    ds_read_b64_tr_b16 v[152:153], v241 offset:17408
    v_mfma_f32_16x16x32_bf16 v[12:15], v[108:111], v[132:135], v[12:15]
    ds_read_b64_tr_b16 v[154:155], v241 offset:17664
    v_mfma_f32_16x16x32_bf16 v[44:47], v[108:111], v[136:139], v[44:47]
    ds_read_b64_tr_b16 v[156:157], v240 offset:17472
    v_mfma_f32_16x16x32_bf16 v[76:79], v[108:111], v[140:143], v[76:79]
    ds_read_b64_tr_b16 v[158:159], v240 offset:17728
    v_mfma_f32_16x16x32_bf16 v[16:19], v[112:115], v[132:135], v[16:19]
    ds_read_b64_tr_b16 v[160:161], v241 offset:17472
    v_mfma_f32_16x16x32_bf16 v[48:51], v[112:115], v[136:139], v[48:51]
    ds_read_b64_tr_b16 v[162:163], v241 offset:17728
    v_mfma_f32_16x16x32_bf16 v[80:83], v[112:115], v[140:143], v[80:83]
    ds_read_b64_tr_b16 v[164:165], v240 offset:17536
    v_mfma_f32_16x16x32_bf16 v[20:23], v[116:119], v[132:135], v[20:23]
    ds_read_b64_tr_b16 v[166:167], v240 offset:17792
    v_mfma_f32_16x16x32_bf16 v[52:55], v[116:119], v[136:139], v[52:55]
    ds_read_b64_tr_b16 v[168:169], v241 offset:17536
    v_mfma_f32_16x16x32_bf16 v[84:87], v[116:119], v[140:143], v[84:87]
    ds_read_b64_tr_b16 v[170:171], v241 offset:17792
    v_mfma_f32_16x16x32_bf16 v[24:27], v[120:123], v[132:135], v[24:27]
    ds_read_b64_tr_b16 v[172:173], v240 offset:17600
    v_mfma_f32_16x16x32_bf16 v[56:59], v[120:123], v[136:139], v[56:59]
    ds_read_b64_tr_b16 v[174:175], v240 offset:17856
    v_mfma_f32_16x16x32_bf16 v[88:91], v[120:123], v[140:143], v[88:91]
    ds_read_b64_tr_b16 v[176:177], v241 offset:17600
    v_mfma_f32_16x16x32_bf16 v[28:31], v[124:127], v[132:135], v[28:31]
    ds_read_b64_tr_b16 v[178:179], v241 offset:17856
    v_mfma_f32_16x16x32_bf16 v[60:63], v[124:127], v[136:139], v[60:63]
    v_mfma_f32_16x16x32_bf16 v[92:95], v[124:127], v[140:143], v[92:95]
    v_mfma_f32_16x16x32_bf16 v[32:35], v[128:131], v[132:135], v[32:35]
    v_mfma_f32_16x16x32_bf16 v[64:67], v[128:131], v[136:139], v[64:67]
    v_mfma_f32_16x16x32_bf16 v[96:99], v[128:131], v[140:143], v[96:99]
    s_add_u32 m0, s70, 19808
    s_nop 0
    buffer_load_dwordx4 v244, s[4:7], s64 offen offset:768 nt lds
    s_waitcnt lgkmcnt(0)
    s_barrier
    v_mfma_f32_16x16x32_bf16 v[4:7], v[148:151], v[180:183], v[4:7]
    ds_read_b128 v[132:135], v238 offset:0
    v_mfma_f32_16x16x32_bf16 v[36:39], v[148:151], v[184:187], v[36:39]
    ds_read_b128 v[136:139], v238 offset:2048
    v_mfma_f32_16x16x32_bf16 v[68:71], v[148:151], v[188:191], v[68:71]
    ds_read_b128 v[140:143], v238 offset:4096
    v_mfma_f32_16x16x32_bf16 v[8:11], v[152:155], v[180:183], v[8:11]
    ds_read_b64_tr_b16 v[100:101], v240 offset:34816
    v_mfma_f32_16x16x32_bf16 v[40:43], v[152:155], v[184:187], v[40:43]
    ds_read_b64_tr_b16 v[102:103], v240 offset:35072
    v_mfma_f32_16x16x32_bf16 v[72:75], v[152:155], v[188:191], v[72:75]
    ds_read_b64_tr_b16 v[104:105], v241 offset:34816
    v_mfma_f32_16x16x32_bf16 v[12:15], v[156:159], v[180:183], v[12:15]
    ds_read_b64_tr_b16 v[106:107], v241 offset:35072
    v_mfma_f32_16x16x32_bf16 v[44:47], v[156:159], v[184:187], v[44:47]
    ds_read_b64_tr_b16 v[108:109], v240 offset:34880
    v_mfma_f32_16x16x32_bf16 v[76:79], v[156:159], v[188:191], v[76:79]
    ds_read_b64_tr_b16 v[110:111], v240 offset:35136
    v_mfma_f32_16x16x32_bf16 v[16:19], v[160:163], v[180:183], v[16:19]
    ds_read_b64_tr_b16 v[112:113], v241 offset:34880
    v_mfma_f32_16x16x32_bf16 v[48:51], v[160:163], v[184:187], v[48:51]
    ds_read_b64_tr_b16 v[114:115], v241 offset:35136
    v_mfma_f32_16x16x32_bf16 v[80:83], v[160:163], v[188:191], v[80:83]
    ds_read_b64_tr_b16 v[116:117], v240 offset:34944
    v_mfma_f32_16x16x32_bf16 v[20:23], v[164:167], v[180:183], v[20:23]
    ds_read_b64_tr_b16 v[118:119], v240 offset:35200
    v_mfma_f32_16x16x32_bf16 v[52:55], v[164:167], v[184:187], v[52:55]
    ds_read_b64_tr_b16 v[120:121], v241 offset:34944
    v_mfma_f32_16x16x32_bf16 v[84:87], v[164:167], v[188:191], v[84:87]
    ds_read_b64_tr_b16 v[122:123], v241 offset:35200
    v_mfma_f32_16x16x32_bf16 v[24:27], v[168:171], v[180:183], v[24:27]
    ds_read_b64_tr_b16 v[124:125], v240 offset:35008
    v_mfma_f32_16x16x32_bf16 v[56:59], v[168:171], v[184:187], v[56:59]
    ds_read_b64_tr_b16 v[126:127], v240 offset:35264
    v_mfma_f32_16x16x32_bf16 v[88:91], v[168:171], v[188:191], v[88:91]
    ds_read_b64_tr_b16 v[128:129], v241 offset:35008
    v_mfma_f32_16x16x32_bf16 v[28:31], v[172:175], v[180:183], v[28:31]
    ds_read_b64_tr_b16 v[130:131], v241 offset:35264
    v_mfma_f32_16x16x32_bf16 v[60:63], v[172:175], v[184:187], v[60:63]
    v_mfma_f32_16x16x32_bf16 v[92:95], v[172:175], v[188:191], v[92:95]
    v_mfma_f32_16x16x32_bf16 v[32:35], v[176:179], v[180:183], v[32:35]
    v_mfma_f32_16x16x32_bf16 v[64:67], v[176:179], v[184:187], v[64:67]
    v_mfma_f32_16x16x32_bf16 v[96:99], v[176:179], v[188:191], v[96:99]
    s_waitcnt lgkmcnt(0)
    s_barrier
    v_mfma_f32_16x16x32_bf16 v[4:7], v[100:103], v[132:135], v[4:7]
    ds_read_b128 v[180:183], v239 offset:0
    v_mfma_f32_16x16x32_bf16 v[36:39], v[100:103], v[136:139], v[36:39]
    ds_read_b128 v[184:187], v239 offset:2048
    v_mfma_f32_16x16x32_bf16 v[68:71], v[100:103], v[140:143], v[68:71]
    ds_read_b128 v[188:191], v239 offset:4096
    v_mfma_f32_16x16x32_bf16 v[8:11], v[104:107], v[132:135], v[8:11]
    ds_read_b64_tr_b16 v[148:149], v242 offset:0
    v_mfma_f32_16x16x32_bf16 v[40:43], v[104:107], v[136:139], v[40:43]
    ds_read_b64_tr_b16 v[150:151], v242 offset:256
    v_mfma_f32_16x16x32_bf16 v[72:75], v[104:107], v[140:143], v[72:75]
    ds_read_b64_tr_b16 v[152:153], v243 offset:0
    v_mfma_f32_16x16x32_bf16 v[12:15], v[108:111], v[132:135], v[12:15]
    ds_read_b64_tr_b16 v[154:155], v243 offset:256
    v_mfma_f32_16x16x32_bf16 v[44:47], v[108:111], v[136:139], v[44:47]
    ds_read_b64_tr_b16 v[156:157], v242 offset:64
    v_mfma_f32_16x16x32_bf16 v[76:79], v[108:111], v[140:143], v[76:79]
    ds_read_b64_tr_b16 v[158:159], v242 offset:320
    v_mfma_f32_16x16x32_bf16 v[16:19], v[112:115], v[132:135], v[16:19]
    ds_read_b64_tr_b16 v[160:161], v243 offset:64
    v_mfma_f32_16x16x32_bf16 v[48:51], v[112:115], v[136:139], v[48:51]
    ds_read_b64_tr_b16 v[162:163], v243 offset:320
    v_mfma_f32_16x16x32_bf16 v[80:83], v[112:115], v[140:143], v[80:83]
    ds_read_b64_tr_b16 v[164:165], v242 offset:128
    v_mfma_f32_16x16x32_bf16 v[20:23], v[116:119], v[132:135], v[20:23]
    ds_read_b64_tr_b16 v[166:167], v242 offset:384
    v_mfma_f32_16x16x32_bf16 v[52:55], v[116:119], v[136:139], v[52:55]
    ds_read_b64_tr_b16 v[168:169], v243 offset:128
    v_mfma_f32_16x16x32_bf16 v[84:87], v[116:119], v[140:143], v[84:87]
    ds_read_b64_tr_b16 v[170:171], v243 offset:384
    v_mfma_f32_16x16x32_bf16 v[24:27], v[120:123], v[132:135], v[24:27]
    ds_read_b64_tr_b16 v[172:173], v242 offset:192
    v_mfma_f32_16x16x32_bf16 v[56:59], v[120:123], v[136:139], v[56:59]
    ds_read_b64_tr_b16 v[174:175], v242 offset:448
    v_mfma_f32_16x16x32_bf16 v[88:91], v[120:123], v[140:143], v[88:91]
    ds_read_b64_tr_b16 v[176:177], v243 offset:192
    v_mfma_f32_16x16x32_bf16 v[28:31], v[124:127], v[132:135], v[28:31]
    ds_read_b64_tr_b16 v[178:179], v243 offset:448
    v_mfma_f32_16x16x32_bf16 v[60:63], v[124:127], v[136:139], v[60:63]
    v_mfma_f32_16x16x32_bf16 v[92:95], v[124:127], v[140:143], v[92:95]
    v_mfma_f32_16x16x32_bf16 v[32:35], v[128:131], v[132:135], v[32:35]
    v_mfma_f32_16x16x32_bf16 v[64:67], v[128:131], v[136:139], v[64:67]
    v_mfma_f32_16x16x32_bf16 v[96:99], v[128:131], v[140:143], v[96:99]
    s_waitcnt lgkmcnt(0)
    s_barrier
    v_mfma_f32_16x16x32_bf16 v[4:7], v[148:151], v[180:183], v[4:7]
    ds_read_b128 v[132:135], v236 offset:0
    v_mfma_f32_16x16x32_bf16 v[36:39], v[148:151], v[184:187], v[36:39]
    ds_read_b128 v[136:139], v236 offset:2048
    v_mfma_f32_16x16x32_bf16 v[68:71], v[148:151], v[188:191], v[68:71]
    ds_read_b128 v[140:143], v236 offset:4096
    v_mfma_f32_16x16x32_bf16 v[8:11], v[152:155], v[180:183], v[8:11]
    ds_read_b64_tr_b16 v[100:101], v240 offset:0
    v_mfma_f32_16x16x32_bf16 v[40:43], v[152:155], v[184:187], v[40:43]
    ds_read_b64_tr_b16 v[102:103], v240 offset:256
    v_mfma_f32_16x16x32_bf16 v[72:75], v[152:155], v[188:191], v[72:75]
    ds_read_b64_tr_b16 v[104:105], v241 offset:0
    v_mfma_f32_16x16x32_bf16 v[12:15], v[156:159], v[180:183], v[12:15]
    ds_read_b64_tr_b16 v[106:107], v241 offset:256
    v_mfma_f32_16x16x32_bf16 v[44:47], v[156:159], v[184:187], v[44:47]
    ds_read_b64_tr_b16 v[108:109], v240 offset:64
    v_mfma_f32_16x16x32_bf16 v[76:79], v[156:159], v[188:191], v[76:79]
    ds_read_b64_tr_b16 v[110:111], v240 offset:320
    v_mfma_f32_16x16x32_bf16 v[16:19], v[160:163], v[180:183], v[16:19]
    ds_read_b64_tr_b16 v[112:113], v241 offset:64
    v_mfma_f32_16x16x32_bf16 v[48:51], v[160:163], v[184:187], v[48:51]
    ds_read_b64_tr_b16 v[114:115], v241 offset:320
    v_mfma_f32_16x16x32_bf16 v[80:83], v[160:163], v[188:191], v[80:83]
    ds_read_b64_tr_b16 v[116:117], v240 offset:128
    v_mfma_f32_16x16x32_bf16 v[20:23], v[164:167], v[180:183], v[20:23]
    ds_read_b64_tr_b16 v[118:119], v240 offset:384
    v_mfma_f32_16x16x32_bf16 v[52:55], v[164:167], v[184:187], v[52:55]
    ds_read_b64_tr_b16 v[120:121], v241 offset:128
    v_mfma_f32_16x16x32_bf16 v[84:87], v[164:167], v[188:191], v[84:87]
    ds_read_b64_tr_b16 v[122:123], v241 offset:384
    v_mfma_f32_16x16x32_bf16 v[24:27], v[168:171], v[180:183], v[24:27]
    ds_read_b64_tr_b16 v[124:125], v240 offset:192
    v_mfma_f32_16x16x32_bf16 v[56:59], v[168:171], v[184:187], v[56:59]
    ds_read_b64_tr_b16 v[126:127], v240 offset:448
    v_mfma_f32_16x16x32_bf16 v[88:91], v[168:171], v[188:191], v[88:91]
    ds_read_b64_tr_b16 v[128:129], v241 offset:192
    v_mfma_f32_16x16x32_bf16 v[28:31], v[172:175], v[180:183], v[28:31]
    ds_read_b64_tr_b16 v[130:131], v241 offset:448
    v_mfma_f32_16x16x32_bf16 v[60:63], v[172:175], v[184:187], v[60:63]
    v_mfma_f32_16x16x32_bf16 v[92:95], v[172:175], v[188:191], v[92:95]
    v_mfma_f32_16x16x32_bf16 v[32:35], v[176:179], v[180:183], v[32:35]
    v_mfma_f32_16x16x32_bf16 v[64:67], v[176:179], v[184:187], v[64:67]
    v_mfma_f32_16x16x32_bf16 v[96:99], v[176:179], v[188:191], v[96:99]
    s_waitcnt lgkmcnt(0)
    s_barrier
    v_mfma_f32_16x16x32_bf16 v[4:7], v[100:103], v[132:135], v[4:7]
    ds_read_b128 v[180:183], v237 offset:0
    v_mfma_f32_16x16x32_bf16 v[36:39], v[100:103], v[136:139], v[36:39]
    ds_read_b128 v[184:187], v237 offset:2048
    v_mfma_f32_16x16x32_bf16 v[68:71], v[100:103], v[140:143], v[68:71]
    ds_read_b128 v[188:191], v237 offset:4096
    v_mfma_f32_16x16x32_bf16 v[8:11], v[104:107], v[132:135], v[8:11]
    ds_read_b64_tr_b16 v[148:149], v240 offset:17408
    v_mfma_f32_16x16x32_bf16 v[40:43], v[104:107], v[136:139], v[40:43]
    ds_read_b64_tr_b16 v[150:151], v240 offset:17664
    v_mfma_f32_16x16x32_bf16 v[72:75], v[104:107], v[140:143], v[72:75]
    ds_read_b64_tr_b16 v[152:153], v241 offset:17408
    v_mfma_f32_16x16x32_bf16 v[12:15], v[108:111], v[132:135], v[12:15]
    ds_read_b64_tr_b16 v[154:155], v241 offset:17664
    v_mfma_f32_16x16x32_bf16 v[44:47], v[108:111], v[136:139], v[44:47]
    ds_read_b64_tr_b16 v[156:157], v240 offset:17472
    v_mfma_f32_16x16x32_bf16 v[76:79], v[108:111], v[140:143], v[76:79]
    ds_read_b64_tr_b16 v[158:159], v240 offset:17728
    v_mfma_f32_16x16x32_bf16 v[16:19], v[112:115], v[132:135], v[16:19]
    ds_read_b64_tr_b16 v[160:161], v241 offset:17472
    v_mfma_f32_16x16x32_bf16 v[48:51], v[112:115], v[136:139], v[48:51]
    ds_read_b64_tr_b16 v[162:163], v241 offset:17728
    v_mfma_f32_16x16x32_bf16 v[80:83], v[112:115], v[140:143], v[80:83]
    ds_read_b64_tr_b16 v[164:165], v240 offset:17536
    v_mfma_f32_16x16x32_bf16 v[20:23], v[116:119], v[132:135], v[20:23]
    ds_read_b64_tr_b16 v[166:167], v240 offset:17792
    v_mfma_f32_16x16x32_bf16 v[52:55], v[116:119], v[136:139], v[52:55]
    ds_read_b64_tr_b16 v[168:169], v241 offset:17536
    v_mfma_f32_16x16x32_bf16 v[84:87], v[116:119], v[140:143], v[84:87]
    ds_read_b64_tr_b16 v[170:171], v241 offset:17792
    v_mfma_f32_16x16x32_bf16 v[24:27], v[120:123], v[132:135], v[24:27]
    ds_read_b64_tr_b16 v[172:173], v240 offset:17600
    v_mfma_f32_16x16x32_bf16 v[56:59], v[120:123], v[136:139], v[56:59]
    ds_read_b64_tr_b16 v[174:175], v240 offset:17856
    v_mfma_f32_16x16x32_bf16 v[88:91], v[120:123], v[140:143], v[88:91]
    ds_read_b64_tr_b16 v[176:177], v241 offset:17600
    v_mfma_f32_16x16x32_bf16 v[28:31], v[124:127], v[132:135], v[28:31]
    ds_read_b64_tr_b16 v[178:179], v241 offset:17856
    v_mfma_f32_16x16x32_bf16 v[60:63], v[124:127], v[136:139], v[60:63]
    v_mfma_f32_16x16x32_bf16 v[92:95], v[124:127], v[140:143], v[92:95]
    v_mfma_f32_16x16x32_bf16 v[32:35], v[128:131], v[132:135], v[32:35]
    v_mfma_f32_16x16x32_bf16 v[64:67], v[128:131], v[136:139], v[64:67]
    v_mfma_f32_16x16x32_bf16 v[96:99], v[128:131], v[140:143], v[96:99]
    s_cmp_lg_u32 s75, 0
    s_cbranch_scc1 L_noann
    s_waitcnt vmcnt(0)
    s_mov_b32 s28, s38
    s_mov_b32 s29, s39
    s_mov_b32 s30, 16
    s_mov_b32 s31, 0x20000
    v_mov_b32 v252, 1
    s_mov_b64 exec, 1
    buffer_store_dword v252, off, s[28:31], 0 sc1
    s_mov_b64 exec, -1
L_noann:
    s_waitcnt lgkmcnt(0)
    s_barrier
    v_mfma_f32_16x16x32_bf16 v[4:7], v[148:151], v[180:183], v[4:7]
    ds_read_b128 v[132:135], v238 offset:0
    v_mfma_f32_16x16x32_bf16 v[36:39], v[148:151], v[184:187], v[36:39]
    ds_read_b128 v[136:139], v238 offset:2048
    v_mfma_f32_16x16x32_bf16 v[68:71], v[148:151], v[188:191], v[68:71]
    ds_read_b128 v[140:143], v238 offset:4096
    v_mfma_f32_16x16x32_bf16 v[8:11], v[152:155], v[180:183], v[8:11]
    ds_read_b64_tr_b16 v[100:101], v240 offset:34816
    v_mfma_f32_16x16x32_bf16 v[40:43], v[152:155], v[184:187], v[40:43]
    ds_read_b64_tr_b16 v[102:103], v240 offset:35072
    v_mfma_f32_16x16x32_bf16 v[72:75], v[152:155], v[188:191], v[72:75]
    ds_read_b64_tr_b16 v[104:105], v241 offset:34816
    v_mfma_f32_16x16x32_bf16 v[12:15], v[156:159], v[180:183], v[12:15]
    ds_read_b64_tr_b16 v[106:107], v241 offset:35072
    v_mfma_f32_16x16x32_bf16 v[44:47], v[156:159], v[184:187], v[44:47]
    ds_read_b64_tr_b16 v[108:109], v240 offset:34880
    v_mfma_f32_16x16x32_bf16 v[76:79], v[156:159], v[188:191], v[76:79]
    ds_read_b64_tr_b16 v[110:111], v240 offset:35136
    v_mfma_f32_16x16x32_bf16 v[16:19], v[160:163], v[180:183], v[16:19]
    ds_read_b64_tr_b16 v[112:113], v241 offset:34880
    v_mfma_f32_16x16x32_bf16 v[48:51], v[160:163], v[184:187], v[48:51]
    ds_read_b64_tr_b16 v[114:115], v241 offset:35136
    v_mfma_f32_16x16x32_bf16 v[80:83], v[160:163], v[188:191], v[80:83]
    ds_read_b64_tr_b16 v[116:117], v240 offset:34944
    v_mfma_f32_16x16x32_bf16 v[20:23], v[164:167], v[180:183], v[20:23]
    ds_read_b64_tr_b16 v[118:119], v240 offset:35200
    v_mfma_f32_16x16x32_bf16 v[52:55], v[164:167], v[184:187], v[52:55]
    ds_read_b64_tr_b16 v[120:121], v241 offset:34944
    v_mfma_f32_16x16x32_bf16 v[84:87], v[164:167], v[188:191], v[84:87]
    ds_read_b64_tr_b16 v[122:123], v241 offset:35200
    v_mfma_f32_16x16x32_bf16 v[24:27], v[168:171], v[180:183], v[24:27]
    ds_read_b64_tr_b16 v[124:125], v240 offset:35008
    v_mfma_f32_16x16x32_bf16 v[56:59], v[168:171], v[184:187], v[56:59]
    ds_read_b64_tr_b16 v[126:127], v240 offset:35264
    v_mfma_f32_16x16x32_bf16 v[88:91], v[168:171], v[188:191], v[88:91]
    ds_read_b64_tr_b16 v[128:129], v241 offset:35008
    v_mfma_f32_16x16x32_bf16 v[28:31], v[172:175], v[180:183], v[28:31]
    ds_read_b64_tr_b16 v[130:131], v241 offset:35264
    v_mfma_f32_16x16x32_bf16 v[60:63], v[172:175], v[184:187], v[60:63]
    v_mfma_f32_16x16x32_bf16 v[92:95], v[172:175], v[188:191], v[92:95]
    v_mfma_f32_16x16x32_bf16 v[32:35], v[176:179], v[180:183], v[32:35]
    v_mfma_f32_16x16x32_bf16 v[64:67], v[176:179], v[184:187], v[64:67]
    v_mfma_f32_16x16x32_bf16 v[96:99], v[176:179], v[188:191], v[96:99]
    s_waitcnt lgkmcnt(0)
    s_barrier
    v_mfma_f32_16x16x32_bf16 v[4:7], v[100:103], v[132:135], v[4:7]
    ds_read_b128 v[180:183], v239 offset:0
    v_mfma_f32_16x16x32_bf16 v[36:39], v[100:103], v[136:139], v[36:39]
    ds_read_b128 v[184:187], v239 offset:2048
    v_mfma_f32_16x16x32_bf16 v[68:71], v[100:103], v[140:143], v[68:71]
    ds_read_b128 v[188:191], v239 offset:4096
    v_mfma_f32_16x16x32_bf16 v[8:11], v[104:107], v[132:135], v[8:11]
    ds_read_b64_tr_b16 v[148:149], v242 offset:0
    v_mfma_f32_16x16x32_bf16 v[40:43], v[104:107], v[136:139], v[40:43]
    ds_read_b64_tr_b16 v[150:151], v242 offset:256
    v_mfma_f32_16x16x32_bf16 v[72:75], v[104:107], v[140:143], v[72:75]
    ds_read_b64_tr_b16 v[152:153], v243 offset:0
    v_mfma_f32_16x16x32_bf16 v[12:15], v[108:111], v[132:135], v[12:15]
    ds_read_b64_tr_b16 v[154:155], v243 offset:256
    v_mfma_f32_16x16x32_bf16 v[44:47], v[108:111], v[136:139], v[44:47]
    ds_read_b64_tr_b16 v[156:157], v242 offset:64
    v_mfma_f32_16x16x32_bf16 v[76:79], v[108:111], v[140:143], v[76:79]
    ds_read_b64_tr_b16 v[158:159], v242 offset:320
    v_mfma_f32_16x16x32_bf16 v[16:19], v[112:115], v[132:135], v[16:19]
    ds_read_b64_tr_b16 v[160:161], v243 offset:64
    v_mfma_f32_16x16x32_bf16 v[48:51], v[112:115], v[136:139], v[48:51]
    ds_read_b64_tr_b16 v[162:163], v243 offset:320
    v_mfma_f32_16x16x32_bf16 v[80:83], v[112:115], v[140:143], v[80:83]
    ds_read_b64_tr_b16 v[164:165], v242 offset:128
    v_mfma_f32_16x16x32_bf16 v[20:23], v[116:119], v[132:135], v[20:23]
    ds_read_b64_tr_b16 v[166:167], v242 offset:384
    v_mfma_f32_16x16x32_bf16 v[52:55], v[116:119], v[136:139], v[52:55]
    ds_read_b64_tr_b16 v[168:169], v243 offset:128
    v_mfma_f32_16x16x32_bf16 v[84:87], v[116:119], v[140:143], v[84:87]
    ds_read_b64_tr_b16 v[170:171], v243 offset:384
    v_mfma_f32_16x16x32_bf16 v[24:27], v[120:123], v[132:135], v[24:27]
    ds_read_b64_tr_b16 v[172:173], v242 offset:192
    v_mfma_f32_16x16x32_bf16 v[56:59], v[120:123], v[136:139], v[56:59]
    ds_read_b64_tr_b16 v[174:175], v242 offset:448
    v_mfma_f32_16x16x32_bf16 v[88:91], v[120:123], v[140:143], v[88:91]
    ds_read_b64_tr_b16 v[176:177], v243 offset:192
    v_mfma_f32_16x16x32_bf16 v[28:31], v[124:127], v[132:135], v[28:31]
    ds_read_b64_tr_b16 v[178:179], v243 offset:448
    v_mfma_f32_16x16x32_bf16 v[60:63], v[124:127], v[136:139], v[60:63]
    v_mfma_f32_16x16x32_bf16 v[92:95], v[124:127], v[140:143], v[92:95]
    v_mfma_f32_16x16x32_bf16 v[32:35], v[128:131], v[132:135], v[32:35]
    v_mfma_f32_16x16x32_bf16 v[64:67], v[128:131], v[136:139], v[64:67]
    v_mfma_f32_16x16x32_bf16 v[96:99], v[128:131], v[140:143], v[96:99]
    s_waitcnt vmcnt(0)
    s_waitcnt lgkmcnt(0)
    s_barrier
    v_mfma_f32_16x16x32_bf16 v[4:7], v[148:151], v[180:183], v[4:7]
    v_add_u32 v232, 0, v228
    v_add_u32 v233, 0, v229
    ds_read_b128 v[196:199], v232 offset:0
    ds_read_b128 v[204:207], v232 offset:64
    ds_read_b128 v[212:215], v232 offset:128
    ds_read_b128 v[220:223], v232 offset:192
    ds_read_b128 v[200:203], v233 offset:0
    ds_read_b128 v[208:211], v233 offset:64
    ds_read_b128 v[216:219], v233 offset:128
    ds_read_b128 v[224:227], v233 offset:192
    v_mfma_f32_16x16x32_bf16 v[36:39], v[148:151], v[184:187], v[36:39]
    v_mfma_f32_16x16x32_bf16 v[68:71], v[148:151], v[188:191], v[68:71]
    v_mfma_f32_16x16x32_bf16 v[8:11], v[152:155], v[180:183], v[8:11]
    v_mfma_f32_16x16x32_bf16 v[40:43], v[152:155], v[184:187], v[40:43]
    v_mfma_f32_16x16x32_bf16 v[72:75], v[152:155], v[188:191], v[72:75]
    v_mfma_f32_16x16x32_bf16 v[12:15], v[156:159], v[180:183], v[12:15]
    v_mfma_f32_16x16x32_bf16 v[44:47], v[156:159], v[184:187], v[44:47]
    v_mfma_f32_16x16x32_bf16 v[76:79], v[156:159], v[188:191], v[76:79]
    v_mfma_f32_16x16x32_bf16 v[16:19], v[160:163], v[180:183], v[16:19]
    v_mfma_f32_16x16x32_bf16 v[48:51], v[160:163], v[184:187], v[48:51]
    v_mfma_f32_16x16x32_bf16 v[80:83], v[160:163], v[188:191], v[80:83]
    v_pk_mul_f32 v[4:5], v[4:5], s[62:63]
    v_pk_mul_f32 v[6:7], v[6:7], s[62:63]
    v_mfma_f32_16x16x32_bf16 v[20:23], v[164:167], v[180:183], v[20:23]
    v_pk_mul_f32 v[8:9], v[8:9], s[62:63]
    v_pk_mul_f32 v[10:11], v[10:11], s[62:63]
    v_mfma_f32_16x16x32_bf16 v[52:55], v[164:167], v[184:187], v[52:55]
    v_cvt_pk_bf16_f32 v100, v4, v5
    v_cvt_pk_bf16_f32 v101, v6, v7
    v_mfma_f32_16x16x32_bf16 v[84:87], v[164:167], v[188:191], v[84:87]
    v_cvt_pk_bf16_f32 v102, v8, v9
    v_cvt_pk_bf16_f32 v103, v10, v11
    v_mfma_f32_16x16x32_bf16 v[24:27], v[168:171], v[180:183], v[24:27]
    v_pk_mul_f32 v[36:37], v[36:37], s[62:63]
    v_pk_mul_f32 v[38:39], v[38:39], s[62:63]
    v_mfma_f32_16x16x32_bf16 v[56:59], v[168:171], v[184:187], v[56:59]
    v_pk_mul_f32 v[40:41], v[40:41], s[62:63]
    v_pk_mul_f32 v[42:43], v[42:43], s[62:63]
    v_mfma_f32_16x16x32_bf16 v[88:91], v[168:171], v[188:191], v[88:91]
    v_cvt_pk_bf16_f32 v116, v36, v37
    v_cvt_pk_bf16_f32 v117, v38, v39
    v_mfma_f32_16x16x32_bf16 v[28:31], v[172:175], v[180:183], v[28:31]
    v_cvt_pk_bf16_f32 v118, v40, v41
    v_cvt_pk_bf16_f32 v119, v42, v43
    v_mfma_f32_16x16x32_bf16 v[60:63], v[172:175], v[184:187], v[60:63]
    v_pk_mul_f32 v[68:69], v[68:69], s[62:63]
    v_pk_mul_f32 v[70:71], v[70:71], s[62:63]
    v_mfma_f32_16x16x32_bf16 v[92:95], v[172:175], v[188:191], v[92:95]
    v_pk_mul_f32 v[72:73], v[72:73], s[62:63]
    v_pk_mul_f32 v[74:75], v[74:75], s[62:63]
    v_mfma_f32_16x16x32_bf16 v[32:35], v[176:179], v[180:183], v[32:35]
    v_cvt_pk_bf16_f32 v132, v68, v69
    v_cvt_pk_bf16_f32 v133, v70, v71
    v_mfma_f32_16x16x32_bf16 v[64:67], v[176:179], v[184:187], v[64:67]
    v_cvt_pk_bf16_f32 v134, v72, v73
    v_cvt_pk_bf16_f32 v135, v74, v75
    v_mfma_f32_16x16x32_bf16 v[96:99], v[176:179], v[188:191], v[96:99]
    v_pk_mul_f32 v[12:13], v[12:13], s[62:63]
    v_pk_mul_f32 v[14:15], v[14:15], s[62:63]
    v_pk_mul_f32 v[16:17], v[16:17], s[62:63]
    v_pk_mul_f32 v[18:19], v[18:19], s[62:63]
    v_cvt_pk_bf16_f32 v104, v12, v13
    v_cvt_pk_bf16_f32 v105, v14, v15
    v_cvt_pk_bf16_f32 v106, v16, v17
    v_cvt_pk_bf16_f32 v107, v18, v19
    v_pk_mul_f32 v[44:45], v[44:45], s[62:63]
    v_pk_mul_f32 v[46:47], v[46:47], s[62:63]
    v_pk_mul_f32 v[48:49], v[48:49], s[62:63]
    v_pk_mul_f32 v[50:51], v[50:51], s[62:63]
    v_cvt_pk_bf16_f32 v120, v44, v45
    v_cvt_pk_bf16_f32 v121, v46, v47
    v_cvt_pk_bf16_f32 v122, v48, v49
    v_cvt_pk_bf16_f32 v123, v50, v51
    v_pk_mul_f32 v[76:77], v[76:77], s[62:63]
    v_pk_mul_f32 v[78:79], v[78:79], s[62:63]
    v_pk_mul_f32 v[80:81], v[80:81], s[62:63]
    v_pk_mul_f32 v[82:83], v[82:83], s[62:63]
    v_cvt_pk_bf16_f32 v136, v76, v77
    v_cvt_pk_bf16_f32 v137, v78, v79
    v_cvt_pk_bf16_f32 v138, v80, v81
    v_cvt_pk_bf16_f32 v139, v82, v83
    v_pk_mul_f32 v[20:21], v[20:21], s[62:63]
    v_pk_mul_f32 v[22:23], v[22:23], s[62:63]
    v_pk_mul_f32 v[24:25], v[24:25], s[62:63]
    v_pk_mul_f32 v[26:27], v[26:27], s[62:63]
    v_cvt_pk_bf16_f32 v108, v20, v21
    v_cvt_pk_bf16_f32 v109, v22, v23
    v_cvt_pk_bf16_f32 v110, v24, v25
    v_cvt_pk_bf16_f32 v111, v26, v27
    v_pk_mul_f32 v[52:53], v[52:53], s[62:63]
    v_pk_mul_f32 v[54:55], v[54:55], s[62:63]
    v_pk_mul_f32 v[56:57], v[56:57], s[62:63]
    v_pk_mul_f32 v[58:59], v[58:59], s[62:63]
    v_cvt_pk_bf16_f32 v124, v52, v53
    v_cvt_pk_bf16_f32 v125, v54, v55
    v_cvt_pk_bf16_f32 v126, v56, v57
    v_cvt_pk_bf16_f32 v127, v58, v59
    v_pk_mul_f32 v[84:85], v[84:85], s[62:63]
    v_pk_mul_f32 v[86:87], v[86:87], s[62:63]
    v_pk_mul_f32 v[88:89], v[88:89], s[62:63]
    v_pk_mul_f32 v[90:91], v[90:91], s[62:63]
    v_cvt_pk_bf16_f32 v140, v84, v85
    v_cvt_pk_bf16_f32 v141, v86, v87
    v_cvt_pk_bf16_f32 v142, v88, v89
    v_cvt_pk_bf16_f32 v143, v90, v91
    v_pk_mul_f32 v[28:29], v[28:29], s[62:63]
    v_pk_mul_f32 v[30:31], v[30:31], s[62:63]
    v_pk_mul_f32 v[32:33], v[32:33], s[62:63]
    v_pk_mul_f32 v[34:35], v[34:35], s[62:63]
    v_cvt_pk_bf16_f32 v112, v28, v29
    v_cvt_pk_bf16_f32 v113, v30, v31
    v_cvt_pk_bf16_f32 v114, v32, v33
    v_cvt_pk_bf16_f32 v115, v34, v35
    v_pk_mul_f32 v[60:61], v[60:61], s[62:63]
    v_pk_mul_f32 v[62:63], v[62:63], s[62:63]
    v_pk_mul_f32 v[64:65], v[64:65], s[62:63]
    v_pk_mul_f32 v[66:67], v[66:67], s[62:63]
    v_cvt_pk_bf16_f32 v128, v60, v61
    v_cvt_pk_bf16_f32 v129, v62, v63
    v_cvt_pk_bf16_f32 v130, v64, v65
    v_cvt_pk_bf16_f32 v131, v66, v67
    v_pk_mul_f32 v[92:93], v[92:93], s[62:63]
    v_pk_mul_f32 v[94:95], v[94:95], s[62:63]
    v_pk_mul_f32 v[96:97], v[96:97], s[62:63]
    v_pk_mul_f32 v[98:99], v[98:99], s[62:63]
    v_cvt_pk_bf16_f32 v144, v92, v93
    v_cvt_pk_bf16_f32 v145, v94, v95
    v_cvt_pk_bf16_f32 v146, v96, v97
    v_cvt_pk_bf16_f32 v147, v98, v99
    v_permlane32_swap_b32 v100, v102
    v_permlane32_swap_b32 v101, v103
    v_permlane32_swap_b32 v104, v106
    v_permlane32_swap_b32 v105, v107
    v_permlane32_swap_b32 v108, v110
    v_permlane32_swap_b32 v109, v111
    v_permlane32_swap_b32 v112, v114
    v_permlane32_swap_b32 v113, v115
    v_permlane32_swap_b32 v116, v118
    v_permlane32_swap_b32 v117, v119
    v_permlane32_swap_b32 v120, v122
    v_permlane32_swap_b32 v121, v123
    v_permlane32_swap_b32 v124, v126
    v_permlane32_swap_b32 v125, v127
    v_permlane32_swap_b32 v128, v130
    v_permlane32_swap_b32 v129, v131
    v_permlane32_swap_b32 v132, v134
    v_permlane32_swap_b32 v133, v135
    v_permlane32_swap_b32 v136, v138
    v_permlane32_swap_b32 v137, v139
    v_permlane32_swap_b32 v140, v142
    v_permlane32_swap_b32 v141, v143
    v_permlane32_swap_b32 v144, v146
    v_permlane32_swap_b32 v145, v147
    v_permlane16_swap_b32 v100, v102
    v_permlane16_swap_b32 v101, v103
    v_permlane16_swap_b32 v104, v106
    v_permlane16_swap_b32 v105, v107
    v_permlane16_swap_b32 v108, v110
    v_permlane16_swap_b32 v109, v111
    v_permlane16_swap_b32 v112, v114
    v_permlane16_swap_b32 v113, v115
    v_permlane16_swap_b32 v116, v118
    v_permlane16_swap_b32 v117, v119
    v_permlane16_swap_b32 v120, v122
    v_permlane16_swap_b32 v121, v123
    v_permlane16_swap_b32 v124, v126
    v_permlane16_swap_b32 v125, v127
    v_permlane16_swap_b32 v128, v130
    v_permlane16_swap_b32 v129, v131
    v_permlane16_swap_b32 v132, v134
    v_permlane16_swap_b32 v133, v135
    v_permlane16_swap_b32 v136, v138
    v_permlane16_swap_b32 v137, v139
    v_permlane16_swap_b32 v140, v142
    v_permlane16_swap_b32 v141, v143
    v_permlane16_swap_b32 v144, v146
    v_permlane16_swap_b32 v145, v147
    v_mov_b32 v248, 0x3f803f80
    v_mov_b32 v249, 0x3f803f80
    v_mov_b32 v250, 0x3f803f80
    v_mov_b32 v251, 0x3f803f80
    s_barrier
    s_waitcnt lgkmcnt(4)
    v_mfma_f32_16x16x32_bf16 v[148:151], v[196:199], v[100:103], 0
    v_add_u32 v234, s55, v230
    v_add_u32 v235, s55, v231
    v_mfma_f32_16x16x32_bf16 v[148:151], v[204:207], v[104:107], v[148:151]
    v_add_u32 v232, s50, v228
    v_add_u32 v233, s50, v229
    v_mfma_f32_16x16x32_bf16 v[148:151], v[212:215], v[108:111], v[148:151]
    s_mov_b32 s59, s50
    s_mov_b32 s50, s51
    v_mfma_f32_16x16x32_bf16 v[148:151], v[220:223], v[112:115], v[148:151]
    s_mov_b32 s51, s52
    s_mov_b32 s52, s53
    s_waitcnt lgkmcnt(0)
    v_mfma_f32_16x16x32_bf16 v[152:155], v[200:203], v[100:103], 0
    s_mov_b32 s53, s54
    s_mov_b32 s54, s59
    v_mfma_f32_16x16x32_bf16 v[152:155], v[208:211], v[104:107], v[152:155]
    s_mov_b32 s59, s55
    s_mov_b32 s55, s56
    v_mfma_f32_16x16x32_bf16 v[152:155], v[216:219], v[108:111], v[152:155]
    s_mov_b32 s56, s57
    s_mov_b32 s57, s58
    v_mfma_f32_16x16x32_bf16 v[152:155], v[224:227], v[112:115], v[152:155]
    s_mov_b32 s58, s59
    v_mfma_f32_16x16x32_bf16 v[156:159], v[196:199], v[116:119], 0
    v_mfma_f32_16x16x32_bf16 v[156:159], v[204:207], v[120:123], v[156:159]
    v_mfma_f32_16x16x32_bf16 v[156:159], v[212:215], v[124:127], v[156:159]
    v_mfma_f32_16x16x32_bf16 v[156:159], v[220:223], v[128:131], v[156:159]
    v_mfma_f32_16x16x32_bf16 v[160:163], v[200:203], v[116:119], 0
    v_mfma_f32_16x16x32_bf16 v[160:163], v[208:211], v[120:123], v[160:163]
    v_mfma_f32_16x16x32_bf16 v[160:163], v[216:219], v[124:127], v[160:163]
    v_max3_f32 v252, v148, v149, v150
    v_max3_f32 v252, v252, v151, v152
    v_max3_f32 v252, v252, v153, v154
    v_max_f32 v252, v252, v155
    v_mfma_f32_16x16x32_bf16 v[160:163], v[224:227], v[128:131], v[160:163]
    v_mov_b32 v253, v252
    s_nop 1
    v_permlane32_swap_b32 v252, v253
    v_max_f32 v252, v252, v253
    v_mfma_f32_16x16x32_bf16 v[164:167], v[196:199], v[132:135], 0
    ds_read_b64_tr_b16 v[196:197], v234 offset:0
    ds_read_b64_tr_b16 v[198:199], v234 offset:4352
    v_mov_b32 v253, v252
    s_nop 1
    v_permlane16_swap_b32 v252, v253
    v_max_f32 v252, v252, v253
    v_mfma_f32_16x16x32_bf16 v[164:167], v[204:207], v[136:139], v[164:167]
    ds_read_b64_tr_b16 v[204:205], v234 offset:64
    ds_read_b64_tr_b16 v[206:207], v234 offset:4416
    v_sub_f32 v148, v148, v252
    v_sub_f32 v149, v149, v252
    v_sub_f32 v150, v150, v252
    v_sub_f32 v151, v151, v252
    v_mfma_f32_16x16x32_bf16 v[164:167], v[212:215], v[140:143], v[164:167]
    ds_read_b64_tr_b16 v[212:213], v234 offset:128
    ds_read_b64_tr_b16 v[214:215], v234 offset:4480
    v_sub_f32 v152, v152, v252
    v_sub_f32 v153, v153, v252
    v_sub_f32 v154, v154, v252
    v_sub_f32 v155, v155, v252
    v_mfma_f32_16x16x32_bf16 v[164:167], v[220:223], v[144:147], v[164:167]
    ds_read_b64_tr_b16 v[220:221], v234 offset:192
    ds_read_b64_tr_b16 v[222:223], v234 offset:4544
    v_sub_f32 v172, 0, v252
    v_sub_f32 v173, 0, v252
    v_sub_f32 v174, 0, v252
    v_sub_f32 v175, 0, v252
    v_mfma_f32_16x16x32_bf16 v[168:171], v[200:203], v[132:135], 0
    ds_read_b64_tr_b16 v[200:201], v235 offset:0
    ds_read_b64_tr_b16 v[202:203], v235 offset:4352
    v_exp_f32 v148, v148
    v_exp_f32 v149, v149
    v_mfma_f32_16x16x32_bf16 v[168:171], v[208:211], v[136:139], v[168:171]
    ds_read_b64_tr_b16 v[208:209], v235 offset:64
    ds_read_b64_tr_b16 v[210:211], v235 offset:4416
    v_exp_f32 v150, v150
    v_exp_f32 v151, v151
    v_mfma_f32_16x16x32_bf16 v[168:171], v[216:219], v[140:143], v[168:171]
    ds_read_b64_tr_b16 v[216:217], v235 offset:128
    ds_read_b64_tr_b16 v[218:219], v235 offset:4480
    v_cvt_pk_bf16_f32 v148, v148, v149
    v_cvt_pk_bf16_f32 v149, v150, v151
    v_exp_f32 v152, v152
    v_mfma_f32_16x16x32_bf16 v[168:171], v[224:227], v[144:147], v[168:171]
    ds_read_b64_tr_b16 v[224:225], v235 offset:192
    ds_read_b64_tr_b16 v[226:227], v235 offset:4544
    v_exp_f32 v153, v153
    v_exp_f32 v154, v154
    v_exp_f32 v155, v155
    v_cvt_pk_bf16_f32 v150, v152, v153
    v_cvt_pk_bf16_f32 v151, v154, v155
    s_waitcnt lgkmcnt(8)
    s_nop 0
    v_mfma_f32_16x16x32_bf16 v[4:7], v[196:199], v[148:151], 0
    v_max3_f32 v252, v156, v157, v158
    v_max3_f32 v252, v252, v159, v160
    v_mfma_f32_16x16x32_bf16 v[12:15], v[204:207], v[148:151], 0
    v_max3_f32 v252, v252, v161, v162
    v_max_f32 v252, v252, v163
    v_mfma_f32_16x16x32_bf16 v[20:23], v[212:215], v[148:151], 0
    v_mov_b32 v253, v252
    s_nop 1
    v_mfma_f32_16x16x32_bf16 v[28:31], v[220:223], v[148:151], 0
    v_permlane32_swap_b32 v252, v253
    v_max_f32 v252, v252, v253
    s_waitcnt lgkmcnt(0)
    v_mfma_f32_16x16x32_bf16 v[8:11], v[200:203], v[148:151], 0
    v_mov_b32 v253, v252
    s_nop 1
    v_mfma_f32_16x16x32_bf16 v[16:19], v[208:211], v[148:151], 0
    v_permlane16_swap_b32 v252, v253
    v_max_f32 v252, v252, v253
    v_mfma_f32_16x16x32_bf16 v[24:27], v[216:219], v[148:151], 0
    v_sub_f32 v156, v156, v252
    v_sub_f32 v157, v157, v252
    v_mfma_f32_16x16x32_bf16 v[32:35], v[224:227], v[148:151], 0
    v_mfma_f32_16x16x32_bf16 v[236:239], v[248:251], v[148:151], 0
    v_sub_f32 v158, v158, v252
    v_sub_f32 v159, v159, v252
    v_sub_f32 v160, v160, v252
    v_sub_f32 v161, v161, v252
    v_sub_f32 v162, v162, v252
    v_sub_f32 v163, v163, v252
    v_sub_f32 v176, 0, v252
    v_sub_f32 v177, 0, v252
    v_sub_f32 v178, 0, v252
    v_sub_f32 v179, 0, v252
    v_exp_f32 v156, v156
    v_exp_f32 v157, v157
    v_exp_f32 v158, v158
    v_exp_f32 v159, v159
    v_cvt_pk_bf16_f32 v156, v156, v157
    v_cvt_pk_bf16_f32 v157, v158, v159
    v_exp_f32 v160, v160
    v_exp_f32 v161, v161
    v_exp_f32 v162, v162
    v_exp_f32 v163, v163
    v_cvt_pk_bf16_f32 v158, v160, v161
    v_cvt_pk_bf16_f32 v159, v162, v163
    s_nop 1
    v_mfma_f32_16x16x32_bf16 v[36:39], v[196:199], v[156:159], 0
    v_max3_f32 v252, v164, v165, v166
    v_max3_f32 v252, v252, v167, v168
    v_mfma_f32_16x16x32_bf16 v[44:47], v[204:207], v[156:159], 0
    v_max3_f32 v252, v252, v169, v170
    v_max_f32 v252, v252, v171
    v_mfma_f32_16x16x32_bf16 v[52:55], v[212:215], v[156:159], 0
    v_mov_b32 v253, v252
    s_nop 1
    v_mfma_f32_16x16x32_bf16 v[60:63], v[220:223], v[156:159], 0
    v_permlane32_swap_b32 v252, v253
    v_max_f32 v252, v252, v253
    v_mfma_f32_16x16x32_bf16 v[40:43], v[200:203], v[156:159], 0
    v_mov_b32 v253, v252
    s_nop 1
    v_mfma_f32_16x16x32_bf16 v[48:51], v[208:211], v[156:159], 0
    v_permlane16_swap_b32 v252, v253
    v_max_f32 v252, v252, v253
    v_mfma_f32_16x16x32_bf16 v[56:59], v[216:219], v[156:159], 0
    v_sub_f32 v164, v164, v252
    v_sub_f32 v165, v165, v252
    v_mfma_f32_16x16x32_bf16 v[64:67], v[224:227], v[156:159], 0
    v_mfma_f32_16x16x32_bf16 v[240:243], v[248:251], v[156:159], 0
    v_sub_f32 v166, v166, v252
    v_sub_f32 v167, v167, v252
    v_sub_f32 v168, v168, v252
    v_sub_f32 v169, v169, v252
    v_sub_f32 v170, v170, v252
    v_sub_f32 v171, v171, v252
    v_sub_f32 v180, 0, v252
    v_sub_f32 v181, 0, v252
    v_sub_f32 v182, 0, v252
    v_sub_f32 v183, 0, v252
    v_exp_f32 v164, v164
    v_exp_f32 v165, v165
    v_exp_f32 v166, v166
    v_exp_f32 v167, v167
    v_cvt_pk_bf16_f32 v164, v164, v165
    v_cvt_pk_bf16_f32 v165, v166, v167
    v_exp_f32 v168, v168
    v_exp_f32 v169, v169
    v_exp_f32 v170, v170
    v_exp_f32 v171, v171
    v_cvt_pk_bf16_f32 v166, v168, v169
    v_cvt_pk_bf16_f32 v167, v170, v171
    s_nop 1
    v_mfma_f32_16x16x32_bf16 v[68:71], v[196:199], v[164:167], 0
    ds_read_b128 v[196:199], v232 offset:0
    v_mfma_f32_16x16x32_bf16 v[76:79], v[204:207], v[164:167], 0
    ds_read_b128 v[204:207], v232 offset:64
    v_mfma_f32_16x16x32_bf16 v[84:87], v[212:215], v[164:167], 0
    ds_read_b128 v[212:215], v232 offset:128
    v_mfma_f32_16x16x32_bf16 v[92:95], v[220:223], v[164:167], 0
    ds_read_b128 v[220:223], v232 offset:192
    v_mfma_f32_16x16x32_bf16 v[72:75], v[200:203], v[164:167], 0
    ds_read_b128 v[200:203], v233 offset:0
    v_mfma_f32_16x16x32_bf16 v[80:83], v[208:211], v[164:167], 0
    ds_read_b128 v[208:211], v233 offset:64
    v_mfma_f32_16x16x32_bf16 v[88:91], v[216:219], v[164:167], 0
    ds_read_b128 v[216:219], v233 offset:128
    v_mfma_f32_16x16x32_bf16 v[96:99], v[224:227], v[164:167], 0
    v_mfma_f32_16x16x32_bf16 v[244:247], v[248:251], v[164:167], 0
    ds_read_b128 v[224:227], v233 offset:192
    s_mov_b32 s60, 1
L_att_F:
    s_barrier
    s_waitcnt lgkmcnt(4)
    v_mfma_f32_16x16x32_bf16 v[148:151], v[196:199], v[100:103], v[172:175]
    v_add_u32 v234, s55, v230
    v_add_u32 v235, s55, v231
    v_mfma_f32_16x16x32_bf16 v[148:151], v[204:207], v[104:107], v[148:151]
    v_add_u32 v232, s50, v228
    v_add_u32 v233, s50, v229
    v_mfma_f32_16x16x32_bf16 v[148:151], v[212:215], v[108:111], v[148:151]
    s_mov_b32 s59, s50
    s_mov_b32 s50, s51
    v_mfma_f32_16x16x32_bf16 v[148:151], v[220:223], v[112:115], v[148:151]
    s_mov_b32 s51, s52
    s_mov_b32 s52, s53
    s_waitcnt lgkmcnt(0)
    v_mfma_f32_16x16x32_bf16 v[152:155], v[200:203], v[100:103], v[172:175]
    s_mov_b32 s53, s54
    s_mov_b32 s54, s59
    v_mfma_f32_16x16x32_bf16 v[152:155], v[208:211], v[104:107], v[152:155]
    s_mov_b32 s59, s55
    s_mov_b32 s55, s56
    v_exp_f32 v148, v148
    v_mfma_f32_16x16x32_bf16 v[152:155], v[216:219], v[108:111], v[152:155]
    s_mov_b32 s56, s57
    s_mov_b32 s57, s58
    v_exp_f32 v149, v149
    v_mfma_f32_16x16x32_bf16 v[152:155], v[224:227], v[112:115], v[152:155]
    s_mov_b32 s58, s59
    v_exp_f32 v150, v150
    v_mfma_f32_16x16x32_bf16 v[156:159], v[196:199], v[116:119], v[176:179]
    v_exp_f32 v151, v151
    v_mfma_f32_16x16x32_bf16 v[156:159], v[204:207], v[120:123], v[156:159]
    v_cvt_pk_bf16_f32 v148, v148, v149
    v_cvt_pk_bf16_f32 v149, v150, v151
    v_mfma_f32_16x16x32_bf16 v[156:159], v[212:215], v[124:127], v[156:159]
    v_exp_f32 v152, v152
    v_mfma_f32_16x16x32_bf16 v[156:159], v[220:223], v[128:131], v[156:159]
    v_exp_f32 v153, v153
    v_mfma_f32_16x16x32_bf16 v[160:163], v[200:203], v[116:119], v[176:179]
    v_exp_f32 v154, v154
    v_mfma_f32_16x16x32_bf16 v[160:163], v[208:211], v[120:123], v[160:163]
    v_exp_f32 v155, v155
    v_mfma_f32_16x16x32_bf16 v[160:163], v[216:219], v[124:127], v[160:163]
    v_cvt_pk_bf16_f32 v150, v152, v153
    v_cvt_pk_bf16_f32 v151, v154, v155
    v_mfma_f32_16x16x32_bf16 v[160:163], v[224:227], v[128:131], v[160:163]
    v_exp_f32 v156, v156
    v_mfma_f32_16x16x32_bf16 v[164:167], v[196:199], v[132:135], v[180:183]
    ds_read_b64_tr_b16 v[196:197], v234 offset:0
    ds_read_b64_tr_b16 v[198:199], v234 offset:4352
    v_exp_f32 v157, v157
    v_mfma_f32_16x16x32_bf16 v[164:167], v[204:207], v[136:139], v[164:167]
    ds_read_b64_tr_b16 v[204:205], v234 offset:64
    ds_read_b64_tr_b16 v[206:207], v234 offset:4416
    v_exp_f32 v158, v158
    v_mfma_f32_16x16x32_bf16 v[164:167], v[212:215], v[140:143], v[164:167]
    ds_read_b64_tr_b16 v[212:213], v234 offset:128
    ds_read_b64_tr_b16 v[214:215], v234 offset:4480
    v_exp_f32 v159, v159
    v_mfma_f32_16x16x32_bf16 v[164:167], v[220:223], v[144:147], v[164:167]
    ds_read_b64_tr_b16 v[220:221], v234 offset:192
    ds_read_b64_tr_b16 v[222:223], v234 offset:4544
    v_cvt_pk_bf16_f32 v156, v156, v157
    v_cvt_pk_bf16_f32 v157, v158, v159
    v_mfma_f32_16x16x32_bf16 v[168:171], v[200:203], v[132:135], v[180:183]
    ds_read_b64_tr_b16 v[200:201], v235 offset:0
    ds_read_b64_tr_b16 v[202:203], v235 offset:4352
    v_exp_f32 v160, v160
    v_mfma_f32_16x16x32_bf16 v[168:171], v[208:211], v[136:139], v[168:171]
    ds_read_b64_tr_b16 v[208:209], v235 offset:64
    ds_read_b64_tr_b16 v[210:211], v235 offset:4416
    v_exp_f32 v161, v161
    v_mfma_f32_16x16x32_bf16 v[168:171], v[216:219], v[140:143], v[168:171]
    ds_read_b64_tr_b16 v[216:217], v235 offset:128
    ds_read_b64_tr_b16 v[218:219], v235 offset:4480
    v_exp_f32 v162, v162
    v_mfma_f32_16x16x32_bf16 v[168:171], v[224:227], v[144:147], v[168:171]
    ds_read_b64_tr_b16 v[224:225], v235 offset:192
    ds_read_b64_tr_b16 v[226:227], v235 offset:4544
    v_exp_f32 v163, v163
    s_waitcnt lgkmcnt(8)
    v_mfma_f32_16x16x32_bf16 v[4:7], v[196:199], v[148:151], v[4:7]
    v_cvt_pk_bf16_f32 v158, v160, v161
    v_cvt_pk_bf16_f32 v159, v162, v163
    v_mfma_f32_16x16x32_bf16 v[12:15], v[204:207], v[148:151], v[12:15]
    v_exp_f32 v164, v164
    v_mfma_f32_16x16x32_bf16 v[20:23], v[212:215], v[148:151], v[20:23]
    v_exp_f32 v165, v165
    v_mfma_f32_16x16x32_bf16 v[28:31], v[220:223], v[148:151], v[28:31]
    v_exp_f32 v166, v166
    s_waitcnt lgkmcnt(0)
    v_mfma_f32_16x16x32_bf16 v[8:11], v[200:203], v[148:151], v[8:11]
    v_exp_f32 v167, v167
    v_mfma_f32_16x16x32_bf16 v[16:19], v[208:211], v[148:151], v[16:19]
    v_cvt_pk_bf16_f32 v164, v164, v165
    v_cvt_pk_bf16_f32 v165, v166, v167
    v_mfma_f32_16x16x32_bf16 v[24:27], v[216:219], v[148:151], v[24:27]
    v_exp_f32 v168, v168
    v_mfma_f32_16x16x32_bf16 v[32:35], v[224:227], v[148:151], v[32:35]
    v_mfma_f32_16x16x32_bf16 v[236:239], v[248:251], v[148:151], v[236:239]
    v_exp_f32 v169, v169
    v_mfma_f32_16x16x32_bf16 v[36:39], v[196:199], v[156:159], v[36:39]
    v_exp_f32 v170, v170
    v_mfma_f32_16x16x32_bf16 v[44:47], v[204:207], v[156:159], v[44:47]
    v_exp_f32 v171, v171
    v_mfma_f32_16x16x32_bf16 v[52:55], v[212:215], v[156:159], v[52:55]
    v_cvt_pk_bf16_f32 v166, v168, v169
    v_cvt_pk_bf16_f32 v167, v170, v171
    v_mfma_f32_16x16x32_bf16 v[60:63], v[220:223], v[156:159], v[60:63]
    v_mfma_f32_16x16x32_bf16 v[40:43], v[200:203], v[156:159], v[40:43]
    v_mfma_f32_16x16x32_bf16 v[48:51], v[208:211], v[156:159], v[48:51]
    v_mfma_f32_16x16x32_bf16 v[56:59], v[216:219], v[156:159], v[56:59]
    v_mfma_f32_16x16x32_bf16 v[64:67], v[224:227], v[156:159], v[64:67]
    v_mfma_f32_16x16x32_bf16 v[240:243], v[248:251], v[156:159], v[240:243]
    v_mfma_f32_16x16x32_bf16 v[68:71], v[196:199], v[164:167], v[68:71]
    ds_read_b128 v[196:199], v232 offset:0
    v_mfma_f32_16x16x32_bf16 v[76:79], v[204:207], v[164:167], v[76:79]
    ds_read_b128 v[204:207], v232 offset:64
    v_mfma_f32_16x16x32_bf16 v[84:87], v[212:215], v[164:167], v[84:87]
    ds_read_b128 v[212:215], v232 offset:128
    v_mfma_f32_16x16x32_bf16 v[92:95], v[220:223], v[164:167], v[92:95]
    ds_read_b128 v[220:223], v232 offset:192
    v_mfma_f32_16x16x32_bf16 v[72:75], v[200:203], v[164:167], v[72:75]
    ds_read_b128 v[200:203], v233 offset:0
    v_mfma_f32_16x16x32_bf16 v[80:83], v[208:211], v[164:167], v[80:83]
    ds_read_b128 v[208:211], v233 offset:64
    v_mfma_f32_16x16x32_bf16 v[88:91], v[216:219], v[164:167], v[88:91]
    ds_read_b128 v[216:219], v233 offset:128
    v_mfma_f32_16x16x32_bf16 v[96:99], v[224:227], v[164:167], v[96:99]
    v_mfma_f32_16x16x32_bf16 v[244:247], v[248:251], v[164:167], v[244:247]
    ds_read_b128 v[224:227], v233 offset:192
    s_add_u32 s60, s60, 1
    s_cmp_lt_u32 s60, 16
    s_cbranch_scc1 L_att_F
    v_mov_b32 v252, 0x4b800000
    v_mov_b32 v253, 163824
    v_cmp_nle_f32 vcc, v236, v252
    s_nop 0
    s_cbranch_vccnz L_voteF
    v_cmp_nle_f32 vcc, v240, v252
    s_nop 0
    s_cbranch_vccnz L_voteF
    v_cmp_nle_f32 vcc, v244, v252
    s_nop 0
    s_cbranch_vccnz L_voteF
    s_branch L_epi_F
L_voteF:
    ds_write_b32 v253, v253
L_epi_F:
    v_rcp_f32 v236, v236
    v_rcp_f32 v240, v240
    v_rcp_f32 v244, v244
    v_lshlrev_b32 v248, 4, v0
    v_add_u32 v249, 4096, v248
    v_add_u32 v250, 8192, v248
    s_mul_i32 s17, s45, 81920
    v_pk_mul_f32 v[4:5], v[4:5], v[236:237] op_sel_hi:[1,0]
    v_pk_mul_f32 v[6:7], v[6:7], v[236:237] op_sel_hi:[1,0]
    v_pk_mul_f32 v[8:9], v[8:9], v[236:237] op_sel_hi:[1,0]
    v_pk_mul_f32 v[10:11], v[10:11], v[236:237] op_sel_hi:[1,0]
    v_cvt_pk_bf16_f32 v148, v4, v5
    v_cvt_pk_bf16_f32 v149, v6, v7
    v_cvt_pk_bf16_f32 v150, v8, v9
    v_cvt_pk_bf16_f32 v151, v10, v11
    v_pk_mul_f32 v[36:37], v[36:37], v[240:241] op_sel_hi:[1,0]
    v_pk_mul_f32 v[38:39], v[38:39], v[240:241] op_sel_hi:[1,0]
    v_pk_mul_f32 v[40:41], v[40:41], v[240:241] op_sel_hi:[1,0]
    v_pk_mul_f32 v[42:43], v[42:43], v[240:241] op_sel_hi:[1,0]
    v_cvt_pk_bf16_f32 v152, v36, v37
    v_cvt_pk_bf16_f32 v153, v38, v39
    v_cvt_pk_bf16_f32 v154, v40, v41
    v_cvt_pk_bf16_f32 v155, v42, v43
    v_pk_mul_f32 v[68:69], v[68:69], v[244:245] op_sel_hi:[1,0]
    v_pk_mul_f32 v[70:71], v[70:71], v[244:245] op_sel_hi:[1,0]
    v_pk_mul_f32 v[72:73], v[72:73], v[244:245] op_sel_hi:[1,0]
    v_pk_mul_f32 v[74:75], v[74:75], v[244:245] op_sel_hi:[1,0]
    v_cvt_pk_bf16_f32 v156, v68, v69
    v_cvt_pk_bf16_f32 v157, v70, v71
    v_cvt_pk_bf16_f32 v158, v72, v73
    v_cvt_pk_bf16_f32 v159, v74, v75
    v_pk_mul_f32 v[12:13], v[12:13], v[236:237] op_sel_hi:[1,0]
    v_pk_mul_f32 v[14:15], v[14:15], v[236:237] op_sel_hi:[1,0]
    v_pk_mul_f32 v[16:17], v[16:17], v[236:237] op_sel_hi:[1,0]
    v_pk_mul_f32 v[18:19], v[18:19], v[236:237] op_sel_hi:[1,0]
    v_cvt_pk_bf16_f32 v160, v12, v13
    v_cvt_pk_bf16_f32 v161, v14, v15
    v_cvt_pk_bf16_f32 v162, v16, v17
    v_cvt_pk_bf16_f32 v163, v18, v19
    v_pk_mul_f32 v[44:45], v[44:45], v[240:241] op_sel_hi:[1,0]
    v_pk_mul_f32 v[46:47], v[46:47], v[240:241] op_sel_hi:[1,0]
    v_pk_mul_f32 v[48:49], v[48:49], v[240:241] op_sel_hi:[1,0]
    v_pk_mul_f32 v[50:51], v[50:51], v[240:241] op_sel_hi:[1,0]
    v_cvt_pk_bf16_f32 v164, v44, v45
    v_cvt_pk_bf16_f32 v165, v46, v47
    v_cvt_pk_bf16_f32 v166, v48, v49
    v_cvt_pk_bf16_f32 v167, v50, v51
    v_pk_mul_f32 v[76:77], v[76:77], v[244:245] op_sel_hi:[1,0]
    v_pk_mul_f32 v[78:79], v[78:79], v[244:245] op_sel_hi:[1,0]
    v_pk_mul_f32 v[80:81], v[80:81], v[244:245] op_sel_hi:[1,0]
    v_pk_mul_f32 v[82:83], v[82:83], v[244:245] op_sel_hi:[1,0]
    v_cvt_pk_bf16_f32 v168, v76, v77
    v_cvt_pk_bf16_f32 v169, v78, v79
    v_cvt_pk_bf16_f32 v170, v80, v81
    v_cvt_pk_bf16_f32 v171, v82, v83
    v_pk_mul_f32 v[20:21], v[20:21], v[236:237] op_sel_hi:[1,0]
    v_pk_mul_f32 v[22:23], v[22:23], v[236:237] op_sel_hi:[1,0]
    v_pk_mul_f32 v[24:25], v[24:25], v[236:237] op_sel_hi:[1,0]
    v_pk_mul_f32 v[26:27], v[26:27], v[236:237] op_sel_hi:[1,0]
    v_cvt_pk_bf16_f32 v172, v20, v21
    v_cvt_pk_bf16_f32 v173, v22, v23
    v_cvt_pk_bf16_f32 v174, v24, v25
    v_cvt_pk_bf16_f32 v175, v26, v27
    v_pk_mul_f32 v[52:53], v[52:53], v[240:241] op_sel_hi:[1,0]
    v_pk_mul_f32 v[54:55], v[54:55], v[240:241] op_sel_hi:[1,0]
    v_pk_mul_f32 v[56:57], v[56:57], v[240:241] op_sel_hi:[1,0]
    v_pk_mul_f32 v[58:59], v[58:59], v[240:241] op_sel_hi:[1,0]
    v_cvt_pk_bf16_f32 v176, v52, v53
    v_cvt_pk_bf16_f32 v177, v54, v55
    v_cvt_pk_bf16_f32 v178, v56, v57
    v_cvt_pk_bf16_f32 v179, v58, v59
    v_pk_mul_f32 v[84:85], v[84:85], v[244:245] op_sel_hi:[1,0]
    v_pk_mul_f32 v[86:87], v[86:87], v[244:245] op_sel_hi:[1,0]
    v_pk_mul_f32 v[88:89], v[88:89], v[244:245] op_sel_hi:[1,0]
    v_pk_mul_f32 v[90:91], v[90:91], v[244:245] op_sel_hi:[1,0]
    v_cvt_pk_bf16_f32 v180, v84, v85
    v_cvt_pk_bf16_f32 v181, v86, v87
    v_cvt_pk_bf16_f32 v182, v88, v89
    v_cvt_pk_bf16_f32 v183, v90, v91
    v_pk_mul_f32 v[28:29], v[28:29], v[236:237] op_sel_hi:[1,0]
    v_pk_mul_f32 v[30:31], v[30:31], v[236:237] op_sel_hi:[1,0]
    v_pk_mul_f32 v[32:33], v[32:33], v[236:237] op_sel_hi:[1,0]
    v_pk_mul_f32 v[34:35], v[34:35], v[236:237] op_sel_hi:[1,0]
    v_cvt_pk_bf16_f32 v184, v28, v29
    v_cvt_pk_bf16_f32 v185, v30, v31
    v_cvt_pk_bf16_f32 v186, v32, v33
    v_cvt_pk_bf16_f32 v187, v34, v35
    v_pk_mul_f32 v[60:61], v[60:61], v[240:241] op_sel_hi:[1,0]
    v_pk_mul_f32 v[62:63], v[62:63], v[240:241] op_sel_hi:[1,0]
    v_pk_mul_f32 v[64:65], v[64:65], v[240:241] op_sel_hi:[1,0]
    v_pk_mul_f32 v[66:67], v[66:67], v[240:241] op_sel_hi:[1,0]
    v_cvt_pk_bf16_f32 v188, v60, v61
    v_cvt_pk_bf16_f32 v189, v62, v63
    v_cvt_pk_bf16_f32 v190, v64, v65
    v_cvt_pk_bf16_f32 v191, v66, v67
    v_pk_mul_f32 v[92:93], v[92:93], v[244:245] op_sel_hi:[1,0]
    v_pk_mul_f32 v[94:95], v[94:95], v[244:245] op_sel_hi:[1,0]
    v_pk_mul_f32 v[96:97], v[96:97], v[244:245] op_sel_hi:[1,0]
    v_pk_mul_f32 v[98:99], v[98:99], v[244:245] op_sel_hi:[1,0]
    v_cvt_pk_bf16_f32 v192, v92, v93
    v_cvt_pk_bf16_f32 v193, v94, v95
    v_cvt_pk_bf16_f32 v194, v96, v97
    v_cvt_pk_bf16_f32 v195, v98, v99
    s_lshl_b32 s79, s49, 7
    s_add_u32 s59, s79, 34816
    s_xor_b32 s78, s59, 128
    v_add_u32 v232, s59, v230
    v_add_u32 v233, s59, v231
    v_add_u32 v234, s78, v230
    v_add_u32 v235, s78, v231
    v_mov_b32 v2, 163824
    s_waitcnt lgkmcnt(0)
    s_barrier
    ds_read_b32 v2, v2
    ds_read_b64_tr_b16 v[196:197], v232 offset:0
    ds_read_b64_tr_b16 v[198:199], v232 offset:4352
    ds_read_b64_tr_b16 v[200:201], v233 offset:0
    ds_read_b64_tr_b16 v[202:203], v233 offset:4352
    ds_read_b64_tr_b16 v[204:205], v232 offset:64
    ds_read_b64_tr_b16 v[206:207], v232 offset:4416
    ds_read_b64_tr_b16 v[208:209], v233 offset:64
    ds_read_b64_tr_b16 v[210:211], v233 offset:4416
    ds_read_b64_tr_b16 v[212:213], v234 offset:0
    ds_read_b64_tr_b16 v[214:215], v234 offset:4352
    ds_read_b64_tr_b16 v[216:217], v235 offset:0
    ds_read_b64_tr_b16 v[218:219], v235 offset:4352
    ds_read_b64_tr_b16 v[220:221], v234 offset:64
    ds_read_b64_tr_b16 v[222:223], v234 offset:4416
    ds_read_b64_tr_b16 v[224:225], v235 offset:64
    ds_read_b64_tr_b16 v[226:227], v235 offset:4416
    s_waitcnt lgkmcnt(15)
    v_readfirstlane_b32 s59, v2
    s_nop 0
    s_cmp_lg_u32 s59, 0
    s_cbranch_scc1 L_redo_F
    buffer_store_dwordx4 v[148:151], v248, s[12:15], s17 offen offset:0 sc1
    buffer_store_dwordx4 v[152:155], v249, s[12:15], s17 offen offset:0 sc1
    buffer_store_dwordx4 v[156:159], v250, s[12:15], s17 offen offset:0 sc1
    buffer_store_dwordx4 v[160:163], v248, s[12:15], s17 offen offset:1024 sc1
    s_add_u32 s59, s45, 0
    s_and_b32 s59, s59, 3
    s_mul_i32 s17, s59, 81920
    s_add_u32 s59, s45, 1
    s_and_b32 s59, s59, 3
    s_mul_i32 s18, s59, 81920
    s_add_u32 s59, s45, 2
    s_and_b32 s59, s59, 3
    s_mul_i32 s19, s59, 81920
    s_add_u32 s59, s45, 3
    s_and_b32 s59, s59, 3
    s_mul_i32 s0, s59, 81920
    v_add_u32 v2, s100, v248
    s_add_u32 s59, s79, 52224
    s_xor_b32 s78, s59, 128
    v_add_u32 v232, s59, v230
    v_add_u32 v233, s59, v231
    v_add_u32 v234, s78, v230
    v_add_u32 v235, s78, v231
    s_waitcnt lgkmcnt(14)
    v_mfma_f32_16x16x32_bf16 v[4:7], v[196:199], v[148:151], 0
    v_mfma_f32_16x16x32_bf16 v[36:39], v[196:199], v[152:155], 0
    v_mfma_f32_16x16x32_bf16 v[68:71], v[196:199], v[156:159], 0
    ds_read_b64_tr_b16 v[100:101], v232 offset:0
    ds_read_b64_tr_b16 v[102:103], v232 offset:4352
    buffer_store_dwordx4 v[164:167], v249, s[12:15], s17 offen offset:1024 sc1
    s_waitcnt lgkmcnt(14)
    v_mfma_f32_16x16x32_bf16 v[8:11], v[200:203], v[148:151], 0
    v_mfma_f32_16x16x32_bf16 v[40:43], v[200:203], v[152:155], 0
    v_mfma_f32_16x16x32_bf16 v[72:75], v[200:203], v[156:159], 0
    ds_read_b64_tr_b16 v[104:105], v233 offset:0
    ds_read_b64_tr_b16 v[106:107], v233 offset:4352
    buffer_store_dwordx4 v[168:171], v250, s[12:15], s17 offen offset:1024 sc1
    s_waitcnt lgkmcnt(14)
    v_mfma_f32_16x16x32_bf16 v[12:15], v[204:207], v[148:151], 0
    v_mfma_f32_16x16x32_bf16 v[44:47], v[204:207], v[152:155], 0
    v_mfma_f32_16x16x32_bf16 v[76:79], v[204:207], v[156:159], 0
    ds_read_b64_tr_b16 v[108:109], v232 offset:64
    ds_read_b64_tr_b16 v[110:111], v232 offset:4416
    buffer_store_dwordx4 v[172:175], v248, s[12:15], s17 offen offset:2048 sc1
    s_waitcnt lgkmcnt(14)
    v_mfma_f32_16x16x32_bf16 v[16:19], v[208:211], v[148:151], 0
    v_mfma_f32_16x16x32_bf16 v[48:51], v[208:211], v[152:155], 0
    v_mfma_f32_16x16x32_bf16 v[80:83], v[208:211], v[156:159], 0
    ds_read_b64_tr_b16 v[112:113], v233 offset:64
    ds_read_b64_tr_b16 v[114:115], v233 offset:4416
    buffer_store_dwordx4 v[176:179], v249, s[12:15], s17 offen offset:2048 sc1
    s_waitcnt lgkmcnt(14)
    v_mfma_f32_16x16x32_bf16 v[20:23], v[212:215], v[148:151], 0
    v_mfma_f32_16x16x32_bf16 v[52:55], v[212:215], v[152:155], 0
    v_mfma_f32_16x16x32_bf16 v[84:87], v[212:215], v[156:159], 0
    ds_read_b64_tr_b16 v[116:117], v234 offset:0
    ds_read_b64_tr_b16 v[118:119], v234 offset:4352
    buffer_store_dwordx4 v[180:183], v250, s[12:15], s17 offen offset:2048 sc1
    s_waitcnt lgkmcnt(14)
    v_mfma_f32_16x16x32_bf16 v[24:27], v[216:219], v[148:151], 0
    v_mfma_f32_16x16x32_bf16 v[56:59], v[216:219], v[152:155], 0
    v_mfma_f32_16x16x32_bf16 v[88:91], v[216:219], v[156:159], 0
    ds_read_b64_tr_b16 v[120:121], v235 offset:0
    ds_read_b64_tr_b16 v[122:123], v235 offset:4352
    buffer_store_dwordx4 v[184:187], v248, s[12:15], s17 offen offset:3072 sc1
    s_waitcnt lgkmcnt(14)
    v_mfma_f32_16x16x32_bf16 v[28:31], v[220:223], v[148:151], 0
    v_mfma_f32_16x16x32_bf16 v[60:63], v[220:223], v[152:155], 0
    v_mfma_f32_16x16x32_bf16 v[92:95], v[220:223], v[156:159], 0
    ds_read_b64_tr_b16 v[124:125], v234 offset:64
    ds_read_b64_tr_b16 v[126:127], v234 offset:4416
    buffer_store_dwordx4 v[188:191], v249, s[12:15], s17 offen offset:3072 sc1
    s_waitcnt lgkmcnt(14)
    v_mfma_f32_16x16x32_bf16 v[32:35], v[224:227], v[148:151], 0
    v_mfma_f32_16x16x32_bf16 v[64:67], v[224:227], v[152:155], 0
    v_mfma_f32_16x16x32_bf16 v[96:99], v[224:227], v[156:159], 0
    ds_read_b64_tr_b16 v[128:129], v235 offset:64
    ds_read_b64_tr_b16 v[130:131], v235 offset:4416
    buffer_store_dwordx4 v[192:195], v250, s[12:15], s17 offen offset:3072 sc1
    s_add_u32 s59, s79, 87040
    s_xor_b32 s78, s59, 128
    v_add_u32 v232, s59, v230
    v_add_u32 v233, s59, v231
    v_add_u32 v234, s78, v230
    v_add_u32 v235, s78, v231
    s_barrier
    s_waitcnt lgkmcnt(4)
    v_mfma_f32_16x16x32_bf16 v[4:7], v[100:103], v[160:163], v[4:7]
    v_mfma_f32_16x16x32_bf16 v[36:39], v[100:103], v[164:167], v[36:39]
    v_mfma_f32_16x16x32_bf16 v[68:71], v[100:103], v[168:171], v[68:71]
    ds_read_b64_tr_b16 v[196:197], v232 offset:0
    ds_read_b64_tr_b16 v[198:199], v232 offset:4352
    v_mfma_f32_16x16x32_bf16 v[8:11], v[104:107], v[160:163], v[8:11]
    v_mfma_f32_16x16x32_bf16 v[40:43], v[104:107], v[164:167], v[40:43]
    v_mfma_f32_16x16x32_bf16 v[72:75], v[104:107], v[168:171], v[72:75]
    ds_read_b64_tr_b16 v[200:201], v233 offset:0
    ds_read_b64_tr_b16 v[202:203], v233 offset:4352
    v_mfma_f32_16x16x32_bf16 v[12:15], v[108:111], v[160:163], v[12:15]
    v_mfma_f32_16x16x32_bf16 v[44:47], v[108:111], v[164:167], v[44:47]
    v_mfma_f32_16x16x32_bf16 v[76:79], v[108:111], v[168:171], v[76:79]
    ds_read_b64_tr_b16 v[204:205], v232 offset:64
    ds_read_b64_tr_b16 v[206:207], v232 offset:4416
    v_mfma_f32_16x16x32_bf16 v[16:19], v[112:115], v[160:163], v[16:19]
    v_mfma_f32_16x16x32_bf16 v[48:51], v[112:115], v[164:167], v[48:51]
    v_mfma_f32_16x16x32_bf16 v[80:83], v[112:115], v[168:171], v[80:83]
    ds_read_b64_tr_b16 v[208:209], v233 offset:64
    ds_read_b64_tr_b16 v[210:211], v233 offset:4416
    v_mfma_f32_16x16x32_bf16 v[20:23], v[116:119], v[160:163], v[20:23]
    v_mfma_f32_16x16x32_bf16 v[52:55], v[116:119], v[164:167], v[52:55]
    v_mfma_f32_16x16x32_bf16 v[84:87], v[116:119], v[168:171], v[84:87]
    ds_read_b64_tr_b16 v[212:213], v234 offset:0
    ds_read_b64_tr_b16 v[214:215], v234 offset:4352
    v_mfma_f32_16x16x32_bf16 v[24:27], v[120:123], v[160:163], v[24:27]
    v_mfma_f32_16x16x32_bf16 v[56:59], v[120:123], v[164:167], v[56:59]
    v_mfma_f32_16x16x32_bf16 v[88:91], v[120:123], v[168:171], v[88:91]
    ds_read_b64_tr_b16 v[216:217], v235 offset:0
    ds_read_b64_tr_b16 v[218:219], v235 offset:4352
    s_waitcnt lgkmcnt(14)
    v_mfma_f32_16x16x32_bf16 v[28:31], v[124:127], v[160:163], v[28:31]
    v_mfma_f32_16x16x32_bf16 v[60:63], v[124:127], v[164:167], v[60:63]
    v_mfma_f32_16x16x32_bf16 v[92:95], v[124:127], v[168:171], v[92:95]
    ds_read_b64_tr_b16 v[220:221], v234 offset:64
    ds_read_b64_tr_b16 v[222:223], v234 offset:4416
    s_waitcnt lgkmcnt(14)
    v_mfma_f32_16x16x32_bf16 v[32:35], v[128:131], v[160:163], v[32:35]
    v_mfma_f32_16x16x32_bf16 v[64:67], v[128:131], v[164:167], v[64:67]
    v_mfma_f32_16x16x32_bf16 v[96:99], v[128:131], v[168:171], v[96:99]
    ds_read_b64_tr_b16 v[224:225], v235 offset:64
    ds_read_b64_tr_b16 v[226:227], v235 offset:4416
    s_add_u32 s59, s79, 139264
    s_xor_b32 s78, s59, 128
    v_add_u32 v232, s59, v230
    v_add_u32 v233, s59, v231
    v_add_u32 v234, s78, v230
    v_add_u32 v235, s78, v231
    s_barrier
    s_waitcnt lgkmcnt(4)
    v_mfma_f32_16x16x32_bf16 v[4:7], v[196:199], v[172:175], v[4:7]
    v_mfma_f32_16x16x32_bf16 v[36:39], v[196:199], v[176:179], v[36:39]
    v_mfma_f32_16x16x32_bf16 v[68:71], v[196:199], v[180:183], v[68:71]
    ds_read_b64_tr_b16 v[100:101], v232 offset:0
    ds_read_b64_tr_b16 v[102:103], v232 offset:4352
    v_mfma_f32_16x16x32_bf16 v[8:11], v[200:203], v[172:175], v[8:11]
    v_mfma_f32_16x16x32_bf16 v[40:43], v[200:203], v[176:179], v[40:43]
    v_mfma_f32_16x16x32_bf16 v[72:75], v[200:203], v[180:183], v[72:75]
    ds_read_b64_tr_b16 v[104:105], v233 offset:0
    ds_read_b64_tr_b16 v[106:107], v233 offset:4352
    v_mfma_f32_16x16x32_bf16 v[12:15], v[204:207], v[172:175], v[12:15]
    v_mfma_f32_16x16x32_bf16 v[44:47], v[204:207], v[176:179], v[44:47]
    v_mfma_f32_16x16x32_bf16 v[76:79], v[204:207], v[180:183], v[76:79]
    ds_read_b64_tr_b16 v[108:109], v232 offset:64
    ds_read_b64_tr_b16 v[110:111], v232 offset:4416
    v_mfma_f32_16x16x32_bf16 v[16:19], v[208:211], v[172:175], v[16:19]
    v_mfma_f32_16x16x32_bf16 v[48:51], v[208:211], v[176:179], v[48:51]
    v_mfma_f32_16x16x32_bf16 v[80:83], v[208:211], v[180:183], v[80:83]
    ds_read_b64_tr_b16 v[112:113], v233 offset:64
    ds_read_b64_tr_b16 v[114:115], v233 offset:4416
    v_mfma_f32_16x16x32_bf16 v[20:23], v[212:215], v[172:175], v[20:23]
    v_mfma_f32_16x16x32_bf16 v[52:55], v[212:215], v[176:179], v[52:55]
    v_mfma_f32_16x16x32_bf16 v[84:87], v[212:215], v[180:183], v[84:87]
    ds_read_b64_tr_b16 v[116:117], v234 offset:0
    ds_read_b64_tr_b16 v[118:119], v234 offset:4352
    v_mfma_f32_16x16x32_bf16 v[24:27], v[216:219], v[172:175], v[24:27]
    v_mfma_f32_16x16x32_bf16 v[56:59], v[216:219], v[176:179], v[56:59]
    v_mfma_f32_16x16x32_bf16 v[88:91], v[216:219], v[180:183], v[88:91]
    ds_read_b64_tr_b16 v[120:121], v235 offset:0
    ds_read_b64_tr_b16 v[122:123], v235 offset:4352
    s_waitcnt lgkmcnt(14)
    v_mfma_f32_16x16x32_bf16 v[28:31], v[220:223], v[172:175], v[28:31]
    v_mfma_f32_16x16x32_bf16 v[60:63], v[220:223], v[176:179], v[60:63]
    v_mfma_f32_16x16x32_bf16 v[92:95], v[220:223], v[180:183], v[92:95]
    ds_read_b64_tr_b16 v[124:125], v234 offset:64
    ds_read_b64_tr_b16 v[126:127], v234 offset:4416
    s_waitcnt lgkmcnt(14)
    v_mfma_f32_16x16x32_bf16 v[32:35], v[224:227], v[172:175], v[32:35]
    v_mfma_f32_16x16x32_bf16 v[64:67], v[224:227], v[176:179], v[64:67]
    v_mfma_f32_16x16x32_bf16 v[96:99], v[224:227], v[180:183], v[96:99]
    ds_read_b64_tr_b16 v[128:129], v235 offset:64
    ds_read_b64_tr_b16 v[130:131], v235 offset:4416
    s_add_u32 s59, s79, 0
    s_xor_b32 s78, s59, 128
    v_add_u32 v232, s59, v230
    v_add_u32 v233, s59, v231
    v_add_u32 v234, s78, v230
    v_add_u32 v235, s78, v231
    s_waitcnt vmcnt(0)
    s_barrier
    s_barrier
    buffer_load_dwordx4 v[148:151], v248, s[12:15], s18 offen offset:0 sc1
    buffer_load_dwordx4 v[152:155], v249, s[12:15], s18 offen offset:0 sc1
    buffer_load_dwordx4 v[156:159], v250, s[12:15], s18 offen offset:0 sc1
    buffer_load_dwordx4 v[160:163], v248, s[12:15], s18 offen offset:1024 sc1
    buffer_load_dwordx4 v[164:167], v249, s[12:15], s18 offen offset:1024 sc1
    buffer_load_dwordx4 v[168:171], v250, s[12:15], s18 offen offset:1024 sc1
    s_waitcnt lgkmcnt(4)
    v_mfma_f32_16x16x32_bf16 v[4:7], v[100:103], v[184:187], v[4:7]
    v_mfma_f32_16x16x32_bf16 v[36:39], v[100:103], v[188:191], v[36:39]
    v_mfma_f32_16x16x32_bf16 v[68:71], v[100:103], v[192:195], v[68:71]
    ds_read_b64_tr_b16 v[196:197], v232 offset:0
    ds_read_b64_tr_b16 v[198:199], v232 offset:4352
    v_mfma_f32_16x16x32_bf16 v[8:11], v[104:107], v[184:187], v[8:11]
    v_mfma_f32_16x16x32_bf16 v[40:43], v[104:107], v[188:191], v[40:43]
    v_mfma_f32_16x16x32_bf16 v[72:75], v[104:107], v[192:195], v[72:75]
    ds_read_b64_tr_b16 v[200:201], v233 offset:0
    ds_read_b64_tr_b16 v[202:203], v233 offset:4352
    v_mfma_f32_16x16x32_bf16 v[12:15], v[108:111], v[184:187], v[12:15]
    v_mfma_f32_16x16x32_bf16 v[44:47], v[108:111], v[188:191], v[44:47]
    v_mfma_f32_16x16x32_bf16 v[76:79], v[108:111], v[192:195], v[76:79]
    ds_read_b64_tr_b16 v[204:205], v232 offset:64
    ds_read_b64_tr_b16 v[206:207], v232 offset:4416
    v_mfma_f32_16x16x32_bf16 v[16:19], v[112:115], v[184:187], v[16:19]
    v_mfma_f32_16x16x32_bf16 v[48:51], v[112:115], v[188:191], v[48:51]
    v_mfma_f32_16x16x32_bf16 v[80:83], v[112:115], v[192:195], v[80:83]
    ds_read_b64_tr_b16 v[208:209], v233 offset:64
    ds_read_b64_tr_b16 v[210:211], v233 offset:4416
    v_mfma_f32_16x16x32_bf16 v[20:23], v[116:119], v[184:187], v[20:23]
    v_mfma_f32_16x16x32_bf16 v[52:55], v[116:119], v[188:191], v[52:55]
    v_mfma_f32_16x16x32_bf16 v[84:87], v[116:119], v[192:195], v[84:87]
    ds_read_b64_tr_b16 v[212:213], v234 offset:0
    ds_read_b64_tr_b16 v[214:215], v234 offset:4352
    v_mfma_f32_16x16x32_bf16 v[24:27], v[120:123], v[184:187], v[24:27]
    v_mfma_f32_16x16x32_bf16 v[56:59], v[120:123], v[188:191], v[56:59]
    v_mfma_f32_16x16x32_bf16 v[88:91], v[120:123], v[192:195], v[88:91]
    ds_read_b64_tr_b16 v[216:217], v235 offset:0
    ds_read_b64_tr_b16 v[218:219], v235 offset:4352
    s_waitcnt lgkmcnt(14)
    v_mfma_f32_16x16x32_bf16 v[28:31], v[124:127], v[184:187], v[28:31]
    v_mfma_f32_16x16x32_bf16 v[60:63], v[124:127], v[188:191], v[60:63]
    v_mfma_f32_16x16x32_bf16 v[92:95], v[124:127], v[192:195], v[92:95]
    ds_read_b64_tr_b16 v[220:221], v234 offset:64
    ds_read_b64_tr_b16 v[222:223], v234 offset:4416
    s_waitcnt lgkmcnt(14)
    v_mfma_f32_16x16x32_bf16 v[32:35], v[128:131], v[184:187], v[32:35]
    v_mfma_f32_16x16x32_bf16 v[64:67], v[128:131], v[188:191], v[64:67]
    v_mfma_f32_16x16x32_bf16 v[96:99], v[128:131], v[192:195], v[96:99]
    ds_read_b64_tr_b16 v[224:225], v235 offset:64
    ds_read_b64_tr_b16 v[226:227], v235 offset:4416
    s_add_u32 s59, s79, 17408
    s_xor_b32 s78, s59, 128
    v_add_u32 v232, s59, v230
    v_add_u32 v233, s59, v231
    v_add_u32 v234, s78, v230
    v_add_u32 v235, s78, v231
    s_barrier
    s_waitcnt vmcnt(3)
    s_waitcnt lgkmcnt(4)
    v_mfma_f32_16x16x32_bf16 v[4:7], v[196:199], v[148:151], v[4:7]
    v_mfma_f32_16x16x32_bf16 v[36:39], v[196:199], v[152:155], v[36:39]
    v_mfma_f32_16x16x32_bf16 v[68:71], v[196:199], v[156:159], v[68:71]
    ds_read_b64_tr_b16 v[100:101], v232 offset:0
    ds_read_b64_tr_b16 v[102:103], v232 offset:4352
    v_mfma_f32_16x16x32_bf16 v[8:11], v[200:203], v[148:151], v[8:11]
    v_mfma_f32_16x16x32_bf16 v[40:43], v[200:203], v[152:155], v[40:43]
    v_mfma_f32_16x16x32_bf16 v[72:75], v[200:203], v[156:159], v[72:75]
    ds_read_b64_tr_b16 v[104:105], v233 offset:0
    ds_read_b64_tr_b16 v[106:107], v233 offset:4352
    v_mfma_f32_16x16x32_bf16 v[12:15], v[204:207], v[148:151], v[12:15]
    v_mfma_f32_16x16x32_bf16 v[44:47], v[204:207], v[152:155], v[44:47]
    v_mfma_f32_16x16x32_bf16 v[76:79], v[204:207], v[156:159], v[76:79]
    ds_read_b64_tr_b16 v[108:109], v232 offset:64
    ds_read_b64_tr_b16 v[110:111], v232 offset:4416
    v_mfma_f32_16x16x32_bf16 v[16:19], v[208:211], v[148:151], v[16:19]
    v_mfma_f32_16x16x32_bf16 v[48:51], v[208:211], v[152:155], v[48:51]
    v_mfma_f32_16x16x32_bf16 v[80:83], v[208:211], v[156:159], v[80:83]
    ds_read_b64_tr_b16 v[112:113], v233 offset:64
    ds_read_b64_tr_b16 v[114:115], v233 offset:4416
    v_mfma_f32_16x16x32_bf16 v[20:23], v[212:215], v[148:151], v[20:23]
    v_mfma_f32_16x16x32_bf16 v[52:55], v[212:215], v[152:155], v[52:55]
    v_mfma_f32_16x16x32_bf16 v[84:87], v[212:215], v[156:159], v[84:87]
    ds_read_b64_tr_b16 v[116:117], v234 offset:0
    ds_read_b64_tr_b16 v[118:119], v234 offset:4352
    v_mfma_f32_16x16x32_bf16 v[24:27], v[216:219], v[148:151], v[24:27]
    v_mfma_f32_16x16x32_bf16 v[56:59], v[216:219], v[152:155], v[56:59]
    v_mfma_f32_16x16x32_bf16 v[88:91], v[216:219], v[156:159], v[88:91]
    ds_read_b64_tr_b16 v[120:121], v235 offset:0
    ds_read_b64_tr_b16 v[122:123], v235 offset:4352
    s_waitcnt lgkmcnt(14)
    v_mfma_f32_16x16x32_bf16 v[28:31], v[220:223], v[148:151], v[28:31]
    v_mfma_f32_16x16x32_bf16 v[60:63], v[220:223], v[152:155], v[60:63]
    v_mfma_f32_16x16x32_bf16 v[92:95], v[220:223], v[156:159], v[92:95]
    ds_read_b64_tr_b16 v[124:125], v234 offset:64
    ds_read_b64_tr_b16 v[126:127], v234 offset:4416
    s_waitcnt lgkmcnt(14)
    v_mfma_f32_16x16x32_bf16 v[32:35], v[224:227], v[148:151], v[32:35]
    v_mfma_f32_16x16x32_bf16 v[64:67], v[224:227], v[152:155], v[64:67]
    v_mfma_f32_16x16x32_bf16 v[96:99], v[224:227], v[156:159], v[96:99]
    ds_read_b64_tr_b16 v[128:129], v235 offset:64
    ds_read_b64_tr_b16 v[130:131], v235 offset:4416
    s_add_u32 s59, s79, 69632
    s_xor_b32 s78, s59, 128
    v_add_u32 v232, s59, v230
    v_add_u32 v233, s59, v231
    v_add_u32 v234, s78, v230
    v_add_u32 v235, s78, v231
    s_barrier
    buffer_load_dwordx4 v[172:175], v248, s[12:15], s18 offen offset:2048 sc1
    buffer_load_dwordx4 v[176:179], v249, s[12:15], s18 offen offset:2048 sc1
    buffer_load_dwordx4 v[180:183], v250, s[12:15], s18 offen offset:2048 sc1
    s_waitcnt vmcnt(3)
    s_waitcnt lgkmcnt(4)
    v_mfma_f32_16x16x32_bf16 v[4:7], v[100:103], v[160:163], v[4:7]
    v_mfma_f32_16x16x32_bf16 v[36:39], v[100:103], v[164:167], v[36:39]
    v_mfma_f32_16x16x32_bf16 v[68:71], v[100:103], v[168:171], v[68:71]
    ds_read_b64_tr_b16 v[196:197], v232 offset:0
    ds_read_b64_tr_b16 v[198:199], v232 offset:4352
    v_mfma_f32_16x16x32_bf16 v[8:11], v[104:107], v[160:163], v[8:11]
    v_mfma_f32_16x16x32_bf16 v[40:43], v[104:107], v[164:167], v[40:43]
    v_mfma_f32_16x16x32_bf16 v[72:75], v[104:107], v[168:171], v[72:75]
    ds_read_b64_tr_b16 v[200:201], v233 offset:0
    ds_read_b64_tr_b16 v[202:203], v233 offset:4352
    v_mfma_f32_16x16x32_bf16 v[12:15], v[108:111], v[160:163], v[12:15]
    v_mfma_f32_16x16x32_bf16 v[44:47], v[108:111], v[164:167], v[44:47]
    v_mfma_f32_16x16x32_bf16 v[76:79], v[108:111], v[168:171], v[76:79]
    ds_read_b64_tr_b16 v[204:205], v232 offset:64
    ds_read_b64_tr_b16 v[206:207], v232 offset:4416
    v_mfma_f32_16x16x32_bf16 v[16:19], v[112:115], v[160:163], v[16:19]
    v_mfma_f32_16x16x32_bf16 v[48:51], v[112:115], v[164:167], v[48:51]
    v_mfma_f32_16x16x32_bf16 v[80:83], v[112:115], v[168:171], v[80:83]
    ds_read_b64_tr_b16 v[208:209], v233 offset:64
    ds_read_b64_tr_b16 v[210:211], v233 offset:4416
    v_mfma_f32_16x16x32_bf16 v[20:23], v[116:119], v[160:163], v[20:23]
    v_mfma_f32_16x16x32_bf16 v[52:55], v[116:119], v[164:167], v[52:55]
    v_mfma_f32_16x16x32_bf16 v[84:87], v[116:119], v[168:171], v[84:87]
    ds_read_b64_tr_b16 v[212:213], v234 offset:0
    ds_read_b64_tr_b16 v[214:215], v234 offset:4352
    v_mfma_f32_16x16x32_bf16 v[24:27], v[120:123], v[160:163], v[24:27]
    v_mfma_f32_16x16x32_bf16 v[56:59], v[120:123], v[164:167], v[56:59]
    v_mfma_f32_16x16x32_bf16 v[88:91], v[120:123], v[168:171], v[88:91]
    ds_read_b64_tr_b16 v[216:217], v235 offset:0
    ds_read_b64_tr_b16 v[218:219], v235 offset:4352
    s_waitcnt lgkmcnt(14)
    v_mfma_f32_16x16x32_bf16 v[28:31], v[124:127], v[160:163], v[28:31]
    v_mfma_f32_16x16x32_bf16 v[60:63], v[124:127], v[164:167], v[60:63]
    v_mfma_f32_16x16x32_bf16 v[92:95], v[124:127], v[168:171], v[92:95]
    ds_read_b64_tr_b16 v[220:221], v234 offset:64
    ds_read_b64_tr_b16 v[222:223], v234 offset:4416
    s_waitcnt lgkmcnt(14)
    v_mfma_f32_16x16x32_bf16 v[32:35], v[128:131], v[160:163], v[32:35]
    v_mfma_f32_16x16x32_bf16 v[64:67], v[128:131], v[164:167], v[64:67]
    v_mfma_f32_16x16x32_bf16 v[96:99], v[128:131], v[168:171], v[96:99]
    ds_read_b64_tr_b16 v[224:225], v235 offset:64
    ds_read_b64_tr_b16 v[226:227], v235 offset:4416
    s_add_u32 s59, s79, 104448
    s_xor_b32 s78, s59, 128
    v_add_u32 v232, s59, v230
    v_add_u32 v233, s59, v231
    v_add_u32 v234, s78, v230
    v_add_u32 v235, s78, v231
    s_barrier
    buffer_load_dwordx4 v[184:187], v248, s[12:15], s18 offen offset:3072 sc1
    buffer_load_dwordx4 v[188:191], v249, s[12:15], s18 offen offset:3072 sc1
    buffer_load_dwordx4 v[192:195], v250, s[12:15], s18 offen offset:3072 sc1
    s_waitcnt vmcnt(3)
    s_waitcnt lgkmcnt(4)
    v_mfma_f32_16x16x32_bf16 v[4:7], v[196:199], v[172:175], v[4:7]
    v_mfma_f32_16x16x32_bf16 v[36:39], v[196:199], v[176:179], v[36:39]
    v_mfma_f32_16x16x32_bf16 v[68:71], v[196:199], v[180:183], v[68:71]
    ds_read_b64_tr_b16 v[100:101], v232 offset:0
    ds_read_b64_tr_b16 v[102:103], v232 offset:4352
    v_mfma_f32_16x16x32_bf16 v[8:11], v[200:203], v[172:175], v[8:11]
    v_mfma_f32_16x16x32_bf16 v[40:43], v[200:203], v[176:179], v[40:43]
    v_mfma_f32_16x16x32_bf16 v[72:75], v[200:203], v[180:183], v[72:75]
    ds_read_b64_tr_b16 v[104:105], v233 offset:0
    ds_read_b64_tr_b16 v[106:107], v233 offset:4352
    v_mfma_f32_16x16x32_bf16 v[12:15], v[204:207], v[172:175], v[12:15]
    v_mfma_f32_16x16x32_bf16 v[44:47], v[204:207], v[176:179], v[44:47]
    v_mfma_f32_16x16x32_bf16 v[76:79], v[204:207], v[180:183], v[76:79]
    ds_read_b64_tr_b16 v[108:109], v232 offset:64
    ds_read_b64_tr_b16 v[110:111], v232 offset:4416
    v_mfma_f32_16x16x32_bf16 v[16:19], v[208:211], v[172:175], v[16:19]
    v_mfma_f32_16x16x32_bf16 v[48:51], v[208:211], v[176:179], v[48:51]
    v_mfma_f32_16x16x32_bf16 v[80:83], v[208:211], v[180:183], v[80:83]
    ds_read_b64_tr_b16 v[112:113], v233 offset:64
    ds_read_b64_tr_b16 v[114:115], v233 offset:4416
    v_mfma_f32_16x16x32_bf16 v[20:23], v[212:215], v[172:175], v[20:23]
    v_mfma_f32_16x16x32_bf16 v[52:55], v[212:215], v[176:179], v[52:55]
    v_mfma_f32_16x16x32_bf16 v[84:87], v[212:215], v[180:183], v[84:87]
    ds_read_b64_tr_b16 v[116:117], v234 offset:0
    ds_read_b64_tr_b16 v[118:119], v234 offset:4352
    v_mfma_f32_16x16x32_bf16 v[24:27], v[216:219], v[172:175], v[24:27]
    v_mfma_f32_16x16x32_bf16 v[56:59], v[216:219], v[176:179], v[56:59]
    v_mfma_f32_16x16x32_bf16 v[88:91], v[216:219], v[180:183], v[88:91]
    ds_read_b64_tr_b16 v[120:121], v235 offset:0
    ds_read_b64_tr_b16 v[122:123], v235 offset:4352
    s_waitcnt lgkmcnt(14)
    v_mfma_f32_16x16x32_bf16 v[28:31], v[220:223], v[172:175], v[28:31]
    v_mfma_f32_16x16x32_bf16 v[60:63], v[220:223], v[176:179], v[60:63]
    v_mfma_f32_16x16x32_bf16 v[92:95], v[220:223], v[180:183], v[92:95]
    ds_read_b64_tr_b16 v[124:125], v234 offset:64
    ds_read_b64_tr_b16 v[126:127], v234 offset:4416
    s_waitcnt lgkmcnt(14)
    v_mfma_f32_16x16x32_bf16 v[32:35], v[224:227], v[172:175], v[32:35]
    v_mfma_f32_16x16x32_bf16 v[64:67], v[224:227], v[176:179], v[64:67]
    v_mfma_f32_16x16x32_bf16 v[96:99], v[224:227], v[180:183], v[96:99]
    ds_read_b64_tr_b16 v[128:129], v235 offset:64
    ds_read_b64_tr_b16 v[130:131], v235 offset:4416
    s_add_u32 s59, s79, 121856
    s_xor_b32 s78, s59, 128
    v_add_u32 v232, s59, v230
    v_add_u32 v233, s59, v231
    v_add_u32 v234, s78, v230
    v_add_u32 v235, s78, v231
    s_barrier
    buffer_load_dwordx4 v[148:151], v248, s[12:15], s19 offen offset:0 sc1
    buffer_load_dwordx4 v[152:155], v249, s[12:15], s19 offen offset:0 sc1
    buffer_load_dwordx4 v[156:159], v250, s[12:15], s19 offen offset:0 sc1
    s_waitcnt vmcnt(3)
    s_waitcnt lgkmcnt(4)
    v_mfma_f32_16x16x32_bf16 v[4:7], v[100:103], v[184:187], v[4:7]
    v_mfma_f32_16x16x32_bf16 v[36:39], v[100:103], v[188:191], v[36:39]
    v_mfma_f32_16x16x32_bf16 v[68:71], v[100:103], v[192:195], v[68:71]
    ds_read_b64_tr_b16 v[196:197], v232 offset:0
    ds_read_b64_tr_b16 v[198:199], v232 offset:4352
    v_mfma_f32_16x16x32_bf16 v[8:11], v[104:107], v[184:187], v[8:11]
    v_mfma_f32_16x16x32_bf16 v[40:43], v[104:107], v[188:191], v[40:43]
    v_mfma_f32_16x16x32_bf16 v[72:75], v[104:107], v[192:195], v[72:75]
    ds_read_b64_tr_b16 v[200:201], v233 offset:0
    ds_read_b64_tr_b16 v[202:203], v233 offset:4352
    v_mfma_f32_16x16x32_bf16 v[12:15], v[108:111], v[184:187], v[12:15]
    v_mfma_f32_16x16x32_bf16 v[44:47], v[108:111], v[188:191], v[44:47]
    v_mfma_f32_16x16x32_bf16 v[76:79], v[108:111], v[192:195], v[76:79]
    ds_read_b64_tr_b16 v[204:205], v232 offset:64
    ds_read_b64_tr_b16 v[206:207], v232 offset:4416
    v_mfma_f32_16x16x32_bf16 v[16:19], v[112:115], v[184:187], v[16:19]
    v_mfma_f32_16x16x32_bf16 v[48:51], v[112:115], v[188:191], v[48:51]
    v_mfma_f32_16x16x32_bf16 v[80:83], v[112:115], v[192:195], v[80:83]
    ds_read_b64_tr_b16 v[208:209], v233 offset:64
    ds_read_b64_tr_b16 v[210:211], v233 offset:4416
    v_mfma_f32_16x16x32_bf16 v[20:23], v[116:119], v[184:187], v[20:23]
    v_mfma_f32_16x16x32_bf16 v[52:55], v[116:119], v[188:191], v[52:55]
    v_mfma_f32_16x16x32_bf16 v[84:87], v[116:119], v[192:195], v[84:87]
    ds_read_b64_tr_b16 v[212:213], v234 offset:0
    ds_read_b64_tr_b16 v[214:215], v234 offset:4352
    v_mfma_f32_16x16x32_bf16 v[24:27], v[120:123], v[184:187], v[24:27]
    v_mfma_f32_16x16x32_bf16 v[56:59], v[120:123], v[188:191], v[56:59]
    v_mfma_f32_16x16x32_bf16 v[88:91], v[120:123], v[192:195], v[88:91]
    ds_read_b64_tr_b16 v[216:217], v235 offset:0
    ds_read_b64_tr_b16 v[218:219], v235 offset:4352
    s_waitcnt lgkmcnt(14)
    v_mfma_f32_16x16x32_bf16 v[28:31], v[124:127], v[184:187], v[28:31]
    v_mfma_f32_16x16x32_bf16 v[60:63], v[124:127], v[188:191], v[60:63]
    v_mfma_f32_16x16x32_bf16 v[92:95], v[124:127], v[192:195], v[92:95]
    ds_read_b64_tr_b16 v[220:221], v234 offset:64
    ds_read_b64_tr_b16 v[222:223], v234 offset:4416
    s_waitcnt lgkmcnt(14)
    v_mfma_f32_16x16x32_bf16 v[32:35], v[128:131], v[184:187], v[32:35]
    v_mfma_f32_16x16x32_bf16 v[64:67], v[128:131], v[188:191], v[64:67]
    v_mfma_f32_16x16x32_bf16 v[96:99], v[128:131], v[192:195], v[96:99]
    ds_read_b64_tr_b16 v[224:225], v235 offset:64
    ds_read_b64_tr_b16 v[226:227], v235 offset:4416
    s_add_u32 s59, s79, 34816
    s_xor_b32 s78, s59, 128
    v_add_u32 v232, s59, v230
    v_add_u32 v233, s59, v231
    v_add_u32 v234, s78, v230
    v_add_u32 v235, s78, v231
    s_barrier
    buffer_load_dwordx4 v[160:163], v248, s[12:15], s19 offen offset:1024 sc1
    buffer_load_dwordx4 v[164:167], v249, s[12:15], s19 offen offset:1024 sc1
    buffer_load_dwordx4 v[168:171], v250, s[12:15], s19 offen offset:1024 sc1
    s_waitcnt vmcnt(3)
    s_waitcnt lgkmcnt(4)
    v_mfma_f32_16x16x32_bf16 v[4:7], v[196:199], v[148:151], v[4:7]
    v_mfma_f32_16x16x32_bf16 v[36:39], v[196:199], v[152:155], v[36:39]
    v_mfma_f32_16x16x32_bf16 v[68:71], v[196:199], v[156:159], v[68:71]
    ds_read_b64_tr_b16 v[100:101], v232 offset:0
    ds_read_b64_tr_b16 v[102:103], v232 offset:4352
    v_mfma_f32_16x16x32_bf16 v[8:11], v[200:203], v[148:151], v[8:11]
    v_mfma_f32_16x16x32_bf16 v[40:43], v[200:203], v[152:155], v[40:43]
    v_mfma_f32_16x16x32_bf16 v[72:75], v[200:203], v[156:159], v[72:75]
    ds_read_b64_tr_b16 v[104:105], v233 offset:0
    ds_read_b64_tr_b16 v[106:107], v233 offset:4352
    v_mfma_f32_16x16x32_bf16 v[12:15], v[204:207], v[148:151], v[12:15]
    v_mfma_f32_16x16x32_bf16 v[44:47], v[204:207], v[152:155], v[44:47]
    v_mfma_f32_16x16x32_bf16 v[76:79], v[204:207], v[156:159], v[76:79]
    ds_read_b64_tr_b16 v[108:109], v232 offset:64
    ds_read_b64_tr_b16 v[110:111], v232 offset:4416
    v_mfma_f32_16x16x32_bf16 v[16:19], v[208:211], v[148:151], v[16:19]
    v_mfma_f32_16x16x32_bf16 v[48:51], v[208:211], v[152:155], v[48:51]
    v_mfma_f32_16x16x32_bf16 v[80:83], v[208:211], v[156:159], v[80:83]
    ds_read_b64_tr_b16 v[112:113], v233 offset:64
    ds_read_b64_tr_b16 v[114:115], v233 offset:4416
    v_mfma_f32_16x16x32_bf16 v[20:23], v[212:215], v[148:151], v[20:23]
    v_mfma_f32_16x16x32_bf16 v[52:55], v[212:215], v[152:155], v[52:55]
    v_mfma_f32_16x16x32_bf16 v[84:87], v[212:215], v[156:159], v[84:87]
    ds_read_b64_tr_b16 v[116:117], v234 offset:0
    ds_read_b64_tr_b16 v[118:119], v234 offset:4352
    v_mfma_f32_16x16x32_bf16 v[24:27], v[216:219], v[148:151], v[24:27]
    v_mfma_f32_16x16x32_bf16 v[56:59], v[216:219], v[152:155], v[56:59]
    v_mfma_f32_16x16x32_bf16 v[88:91], v[216:219], v[156:159], v[88:91]
    ds_read_b64_tr_b16 v[120:121], v235 offset:0
    ds_read_b64_tr_b16 v[122:123], v235 offset:4352
    s_waitcnt lgkmcnt(14)
    v_mfma_f32_16x16x32_bf16 v[28:31], v[220:223], v[148:151], v[28:31]
    v_mfma_f32_16x16x32_bf16 v[60:63], v[220:223], v[152:155], v[60:63]
    v_mfma_f32_16x16x32_bf16 v[92:95], v[220:223], v[156:159], v[92:95]
    ds_read_b64_tr_b16 v[124:125], v234 offset:64
    ds_read_b64_tr_b16 v[126:127], v234 offset:4416
    s_waitcnt lgkmcnt(14)
    v_mfma_f32_16x16x32_bf16 v[32:35], v[224:227], v[148:151], v[32:35]
    v_mfma_f32_16x16x32_bf16 v[64:67], v[224:227], v[152:155], v[64:67]
    v_mfma_f32_16x16x32_bf16 v[96:99], v[224:227], v[156:159], v[96:99]
    ds_read_b64_tr_b16 v[128:129], v235 offset:64
    ds_read_b64_tr_b16 v[130:131], v235 offset:4416
    s_add_u32 s59, s79, 52224
    s_xor_b32 s78, s59, 128
    v_add_u32 v232, s59, v230
    v_add_u32 v233, s59, v231
    v_add_u32 v234, s78, v230
    v_add_u32 v235, s78, v231
    s_barrier
    buffer_load_dwordx4 v[172:175], v248, s[12:15], s19 offen offset:2048 sc1
    buffer_load_dwordx4 v[176:179], v249, s[12:15], s19 offen offset:2048 sc1
    buffer_load_dwordx4 v[180:183], v250, s[12:15], s19 offen offset:2048 sc1
    s_waitcnt vmcnt(3)
    s_waitcnt lgkmcnt(4)
    v_mfma_f32_16x16x32_bf16 v[4:7], v[100:103], v[160:163], v[4:7]
    v_mfma_f32_16x16x32_bf16 v[36:39], v[100:103], v[164:167], v[36:39]
    v_mfma_f32_16x16x32_bf16 v[68:71], v[100:103], v[168:171], v[68:71]
    ds_read_b64_tr_b16 v[196:197], v232 offset:0
    ds_read_b64_tr_b16 v[198:199], v232 offset:4352
    v_mfma_f32_16x16x32_bf16 v[8:11], v[104:107], v[160:163], v[8:11]
    v_mfma_f32_16x16x32_bf16 v[40:43], v[104:107], v[164:167], v[40:43]
    v_mfma_f32_16x16x32_bf16 v[72:75], v[104:107], v[168:171], v[72:75]
    ds_read_b64_tr_b16 v[200:201], v233 offset:0
    ds_read_b64_tr_b16 v[202:203], v233 offset:4352
    v_mfma_f32_16x16x32_bf16 v[12:15], v[108:111], v[160:163], v[12:15]
    v_mfma_f32_16x16x32_bf16 v[44:47], v[108:111], v[164:167], v[44:47]
    v_mfma_f32_16x16x32_bf16 v[76:79], v[108:111], v[168:171], v[76:79]
    ds_read_b64_tr_b16 v[204:205], v232 offset:64
    ds_read_b64_tr_b16 v[206:207], v232 offset:4416
    v_mfma_f32_16x16x32_bf16 v[16:19], v[112:115], v[160:163], v[16:19]
    v_mfma_f32_16x16x32_bf16 v[48:51], v[112:115], v[164:167], v[48:51]
    v_mfma_f32_16x16x32_bf16 v[80:83], v[112:115], v[168:171], v[80:83]
    ds_read_b64_tr_b16 v[208:209], v233 offset:64
    ds_read_b64_tr_b16 v[210:211], v233 offset:4416
    v_mfma_f32_16x16x32_bf16 v[20:23], v[116:119], v[160:163], v[20:23]
    v_mfma_f32_16x16x32_bf16 v[52:55], v[116:119], v[164:167], v[52:55]
    v_mfma_f32_16x16x32_bf16 v[84:87], v[116:119], v[168:171], v[84:87]
    ds_read_b64_tr_b16 v[212:213], v234 offset:0
    ds_read_b64_tr_b16 v[214:215], v234 offset:4352
    v_mfma_f32_16x16x32_bf16 v[24:27], v[120:123], v[160:163], v[24:27]
    v_mfma_f32_16x16x32_bf16 v[56:59], v[120:123], v[164:167], v[56:59]
    v_mfma_f32_16x16x32_bf16 v[88:91], v[120:123], v[168:171], v[88:91]
    ds_read_b64_tr_b16 v[216:217], v235 offset:0
    ds_read_b64_tr_b16 v[218:219], v235 offset:4352
    s_waitcnt lgkmcnt(14)
    v_mfma_f32_16x16x32_bf16 v[28:31], v[124:127], v[160:163], v[28:31]
    v_mfma_f32_16x16x32_bf16 v[60:63], v[124:127], v[164:167], v[60:63]
    v_mfma_f32_16x16x32_bf16 v[92:95], v[124:127], v[168:171], v[92:95]
    ds_read_b64_tr_b16 v[220:221], v234 offset:64
    ds_read_b64_tr_b16 v[222:223], v234 offset:4416
    s_waitcnt lgkmcnt(14)
    v_mfma_f32_16x16x32_bf16 v[32:35], v[128:131], v[160:163], v[32:35]
    v_mfma_f32_16x16x32_bf16 v[64:67], v[128:131], v[164:167], v[64:67]
    v_mfma_f32_16x16x32_bf16 v[96:99], v[128:131], v[168:171], v[96:99]
    ds_read_b64_tr_b16 v[224:225], v235 offset:64
    ds_read_b64_tr_b16 v[226:227], v235 offset:4416
    s_add_u32 s59, s79, 87040
    s_xor_b32 s78, s59, 128
    v_add_u32 v232, s59, v230
    v_add_u32 v233, s59, v231
    v_add_u32 v234, s78, v230
    v_add_u32 v235, s78, v231
    s_barrier
    buffer_load_dwordx4 v[184:187], v248, s[12:15], s19 offen offset:3072 sc1
    buffer_load_dwordx4 v[188:191], v249, s[12:15], s19 offen offset:3072 sc1
    buffer_load_dwordx4 v[192:195], v250, s[12:15], s19 offen offset:3072 sc1
    s_waitcnt vmcnt(3)
    s_waitcnt lgkmcnt(4)
    v_mfma_f32_16x16x32_bf16 v[4:7], v[196:199], v[172:175], v[4:7]
    v_mfma_f32_16x16x32_bf16 v[36:39], v[196:199], v[176:179], v[36:39]
    v_mfma_f32_16x16x32_bf16 v[68:71], v[196:199], v[180:183], v[68:71]
    ds_read_b64_tr_b16 v[100:101], v232 offset:0
    ds_read_b64_tr_b16 v[102:103], v232 offset:4352
    v_mfma_f32_16x16x32_bf16 v[8:11], v[200:203], v[172:175], v[8:11]
    v_mfma_f32_16x16x32_bf16 v[40:43], v[200:203], v[176:179], v[40:43]
    v_mfma_f32_16x16x32_bf16 v[72:75], v[200:203], v[180:183], v[72:75]
    ds_read_b64_tr_b16 v[104:105], v233 offset:0
    ds_read_b64_tr_b16 v[106:107], v233 offset:4352
    v_mfma_f32_16x16x32_bf16 v[12:15], v[204:207], v[172:175], v[12:15]
    v_mfma_f32_16x16x32_bf16 v[44:47], v[204:207], v[176:179], v[44:47]
    v_mfma_f32_16x16x32_bf16 v[76:79], v[204:207], v[180:183], v[76:79]
    ds_read_b64_tr_b16 v[108:109], v232 offset:64
    ds_read_b64_tr_b16 v[110:111], v232 offset:4416
    v_mfma_f32_16x16x32_bf16 v[16:19], v[208:211], v[172:175], v[16:19]
    v_mfma_f32_16x16x32_bf16 v[48:51], v[208:211], v[176:179], v[48:51]
    v_mfma_f32_16x16x32_bf16 v[80:83], v[208:211], v[180:183], v[80:83]
    ds_read_b64_tr_b16 v[112:113], v233 offset:64
    ds_read_b64_tr_b16 v[114:115], v233 offset:4416
    v_mfma_f32_16x16x32_bf16 v[20:23], v[212:215], v[172:175], v[20:23]
    v_mfma_f32_16x16x32_bf16 v[52:55], v[212:215], v[176:179], v[52:55]
    v_mfma_f32_16x16x32_bf16 v[84:87], v[212:215], v[180:183], v[84:87]
    ds_read_b64_tr_b16 v[116:117], v234 offset:0
    ds_read_b64_tr_b16 v[118:119], v234 offset:4352
    v_mfma_f32_16x16x32_bf16 v[24:27], v[216:219], v[172:175], v[24:27]
    v_mfma_f32_16x16x32_bf16 v[56:59], v[216:219], v[176:179], v[56:59]
    v_mfma_f32_16x16x32_bf16 v[88:91], v[216:219], v[180:183], v[88:91]
    ds_read_b64_tr_b16 v[120:121], v235 offset:0
    ds_read_b64_tr_b16 v[122:123], v235 offset:4352
    s_waitcnt lgkmcnt(14)
    v_mfma_f32_16x16x32_bf16 v[28:31], v[220:223], v[172:175], v[28:31]
    v_mfma_f32_16x16x32_bf16 v[60:63], v[220:223], v[176:179], v[60:63]
    v_mfma_f32_16x16x32_bf16 v[92:95], v[220:223], v[180:183], v[92:95]
    ds_read_b64_tr_b16 v[124:125], v234 offset:64
    ds_read_b64_tr_b16 v[126:127], v234 offset:4416
    s_waitcnt lgkmcnt(14)
    v_mfma_f32_16x16x32_bf16 v[32:35], v[224:227], v[172:175], v[32:35]
    v_mfma_f32_16x16x32_bf16 v[64:67], v[224:227], v[176:179], v[64:67]
    v_mfma_f32_16x16x32_bf16 v[96:99], v[224:227], v[180:183], v[96:99]
    ds_read_b64_tr_b16 v[128:129], v235 offset:64
    ds_read_b64_tr_b16 v[130:131], v235 offset:4416
    s_add_u32 s59, s79, 139264
    s_xor_b32 s78, s59, 128
    v_add_u32 v232, s59, v230
    v_add_u32 v233, s59, v231
    v_add_u32 v234, s78, v230
    v_add_u32 v235, s78, v231
    s_barrier
    buffer_load_dwordx4 v[148:151], v248, s[12:15], s0 offen offset:0 sc1
    buffer_load_dwordx4 v[152:155], v249, s[12:15], s0 offen offset:0 sc1
    buffer_load_dwordx4 v[156:159], v250, s[12:15], s0 offen offset:0 sc1
    s_waitcnt vmcnt(3)
    s_waitcnt lgkmcnt(4)
    v_mfma_f32_16x16x32_bf16 v[4:7], v[100:103], v[184:187], v[4:7]
    v_mfma_f32_16x16x32_bf16 v[36:39], v[100:103], v[188:191], v[36:39]
    v_mfma_f32_16x16x32_bf16 v[68:71], v[100:103], v[192:195], v[68:71]
    ds_read_b64_tr_b16 v[196:197], v232 offset:0
    ds_read_b64_tr_b16 v[198:199], v232 offset:4352
    v_mfma_f32_16x16x32_bf16 v[8:11], v[104:107], v[184:187], v[8:11]
    v_mfma_f32_16x16x32_bf16 v[40:43], v[104:107], v[188:191], v[40:43]
    v_mfma_f32_16x16x32_bf16 v[72:75], v[104:107], v[192:195], v[72:75]
    ds_read_b64_tr_b16 v[200:201], v233 offset:0
    ds_read_b64_tr_b16 v[202:203], v233 offset:4352
    v_mfma_f32_16x16x32_bf16 v[12:15], v[108:111], v[184:187], v[12:15]
    v_mfma_f32_16x16x32_bf16 v[44:47], v[108:111], v[188:191], v[44:47]
    v_mfma_f32_16x16x32_bf16 v[76:79], v[108:111], v[192:195], v[76:79]
    ds_read_b64_tr_b16 v[204:205], v232 offset:64
    ds_read_b64_tr_b16 v[206:207], v232 offset:4416
    v_mfma_f32_16x16x32_bf16 v[16:19], v[112:115], v[184:187], v[16:19]
    v_mfma_f32_16x16x32_bf16 v[48:51], v[112:115], v[188:191], v[48:51]
    v_mfma_f32_16x16x32_bf16 v[80:83], v[112:115], v[192:195], v[80:83]
    ds_read_b64_tr_b16 v[208:209], v233 offset:64
    ds_read_b64_tr_b16 v[210:211], v233 offset:4416
    v_mfma_f32_16x16x32_bf16 v[20:23], v[116:119], v[184:187], v[20:23]
    v_mfma_f32_16x16x32_bf16 v[52:55], v[116:119], v[188:191], v[52:55]
    v_mfma_f32_16x16x32_bf16 v[84:87], v[116:119], v[192:195], v[84:87]
    ds_read_b64_tr_b16 v[212:213], v234 offset:0
    ds_read_b64_tr_b16 v[214:215], v234 offset:4352
    v_mfma_f32_16x16x32_bf16 v[24:27], v[120:123], v[184:187], v[24:27]
    v_mfma_f32_16x16x32_bf16 v[56:59], v[120:123], v[188:191], v[56:59]
    v_mfma_f32_16x16x32_bf16 v[88:91], v[120:123], v[192:195], v[88:91]
    ds_read_b64_tr_b16 v[216:217], v235 offset:0
    ds_read_b64_tr_b16 v[218:219], v235 offset:4352
    s_waitcnt lgkmcnt(14)
    v_mfma_f32_16x16x32_bf16 v[28:31], v[124:127], v[184:187], v[28:31]
    v_mfma_f32_16x16x32_bf16 v[60:63], v[124:127], v[188:191], v[60:63]
    v_mfma_f32_16x16x32_bf16 v[92:95], v[124:127], v[192:195], v[92:95]
    ds_read_b64_tr_b16 v[220:221], v234 offset:64
    ds_read_b64_tr_b16 v[222:223], v234 offset:4416
    s_waitcnt lgkmcnt(14)
    v_mfma_f32_16x16x32_bf16 v[32:35], v[128:131], v[184:187], v[32:35]
    v_mfma_f32_16x16x32_bf16 v[64:67], v[128:131], v[188:191], v[64:67]
    v_mfma_f32_16x16x32_bf16 v[96:99], v[128:131], v[192:195], v[96:99]
    ds_read_b64_tr_b16 v[224:225], v235 offset:64
    ds_read_b64_tr_b16 v[226:227], v235 offset:4416
    s_add_u32 s59, s79, 0
    s_xor_b32 s78, s59, 128
    v_add_u32 v232, s59, v230
    v_add_u32 v233, s59, v231
    v_add_u32 v234, s78, v230
    v_add_u32 v235, s78, v231
    s_barrier
    buffer_load_dwordx4 v[160:163], v248, s[12:15], s0 offen offset:1024 sc1
    buffer_load_dwordx4 v[164:167], v249, s[12:15], s0 offen offset:1024 sc1
    buffer_load_dwordx4 v[168:171], v250, s[12:15], s0 offen offset:1024 sc1
    s_waitcnt vmcnt(3)
    s_waitcnt lgkmcnt(4)
    v_mfma_f32_16x16x32_bf16 v[4:7], v[196:199], v[148:151], v[4:7]
    v_mfma_f32_16x16x32_bf16 v[36:39], v[196:199], v[152:155], v[36:39]
    v_mfma_f32_16x16x32_bf16 v[68:71], v[196:199], v[156:159], v[68:71]
    ds_read_b64_tr_b16 v[100:101], v232 offset:0
    ds_read_b64_tr_b16 v[102:103], v232 offset:4352
    v_mfma_f32_16x16x32_bf16 v[8:11], v[200:203], v[148:151], v[8:11]
    v_mfma_f32_16x16x32_bf16 v[40:43], v[200:203], v[152:155], v[40:43]
    v_mfma_f32_16x16x32_bf16 v[72:75], v[200:203], v[156:159], v[72:75]
    ds_read_b64_tr_b16 v[104:105], v233 offset:0
    ds_read_b64_tr_b16 v[106:107], v233 offset:4352
    v_mfma_f32_16x16x32_bf16 v[12:15], v[204:207], v[148:151], v[12:15]
    v_mfma_f32_16x16x32_bf16 v[44:47], v[204:207], v[152:155], v[44:47]
    v_mfma_f32_16x16x32_bf16 v[76:79], v[204:207], v[156:159], v[76:79]
    ds_read_b64_tr_b16 v[108:109], v232 offset:64
    ds_read_b64_tr_b16 v[110:111], v232 offset:4416
    v_mfma_f32_16x16x32_bf16 v[16:19], v[208:211], v[148:151], v[16:19]
    v_mfma_f32_16x16x32_bf16 v[48:51], v[208:211], v[152:155], v[48:51]
    v_mfma_f32_16x16x32_bf16 v[80:83], v[208:211], v[156:159], v[80:83]
    ds_read_b64_tr_b16 v[112:113], v233 offset:64
    ds_read_b64_tr_b16 v[114:115], v233 offset:4416
    v_mfma_f32_16x16x32_bf16 v[20:23], v[212:215], v[148:151], v[20:23]
    v_mfma_f32_16x16x32_bf16 v[52:55], v[212:215], v[152:155], v[52:55]
    v_mfma_f32_16x16x32_bf16 v[84:87], v[212:215], v[156:159], v[84:87]
    ds_read_b64_tr_b16 v[116:117], v234 offset:0
    ds_read_b64_tr_b16 v[118:119], v234 offset:4352
    v_mfma_f32_16x16x32_bf16 v[24:27], v[216:219], v[148:151], v[24:27]
    v_mfma_f32_16x16x32_bf16 v[56:59], v[216:219], v[152:155], v[56:59]
    v_mfma_f32_16x16x32_bf16 v[88:91], v[216:219], v[156:159], v[88:91]
    ds_read_b64_tr_b16 v[120:121], v235 offset:0
    ds_read_b64_tr_b16 v[122:123], v235 offset:4352
    s_waitcnt lgkmcnt(14)
    v_mfma_f32_16x16x32_bf16 v[28:31], v[220:223], v[148:151], v[28:31]
    v_mfma_f32_16x16x32_bf16 v[60:63], v[220:223], v[152:155], v[60:63]
    v_mfma_f32_16x16x32_bf16 v[92:95], v[220:223], v[156:159], v[92:95]
    ds_read_b64_tr_b16 v[124:125], v234 offset:64
    ds_read_b64_tr_b16 v[126:127], v234 offset:4416
    s_waitcnt lgkmcnt(14)
    v_mfma_f32_16x16x32_bf16 v[32:35], v[224:227], v[148:151], v[32:35]
    v_mfma_f32_16x16x32_bf16 v[64:67], v[224:227], v[152:155], v[64:67]
    v_mfma_f32_16x16x32_bf16 v[96:99], v[224:227], v[156:159], v[96:99]
    ds_read_b64_tr_b16 v[128:129], v235 offset:64
    ds_read_b64_tr_b16 v[130:131], v235 offset:4416
    s_add_u32 s59, s79, 17408
    s_xor_b32 s78, s59, 128
    v_add_u32 v232, s59, v230
    v_add_u32 v233, s59, v231
    v_add_u32 v234, s78, v230
    v_add_u32 v235, s78, v231
    s_barrier
    buffer_load_dwordx4 v[172:175], v248, s[12:15], s0 offen offset:2048 sc1
    buffer_load_dwordx4 v[176:179], v249, s[12:15], s0 offen offset:2048 sc1
    buffer_load_dwordx4 v[180:183], v250, s[12:15], s0 offen offset:2048 sc1
    s_waitcnt vmcnt(3)
    s_waitcnt lgkmcnt(4)
    v_mfma_f32_16x16x32_bf16 v[4:7], v[100:103], v[160:163], v[4:7]
    v_mfma_f32_16x16x32_bf16 v[36:39], v[100:103], v[164:167], v[36:39]
    v_mfma_f32_16x16x32_bf16 v[68:71], v[100:103], v[168:171], v[68:71]
    ds_read_b64_tr_b16 v[196:197], v232 offset:0
    ds_read_b64_tr_b16 v[198:199], v232 offset:4352
    v_mfma_f32_16x16x32_bf16 v[8:11], v[104:107], v[160:163], v[8:11]
    v_mfma_f32_16x16x32_bf16 v[40:43], v[104:107], v[164:167], v[40:43]
    v_mfma_f32_16x16x32_bf16 v[72:75], v[104:107], v[168:171], v[72:75]
    ds_read_b64_tr_b16 v[200:201], v233 offset:0
    ds_read_b64_tr_b16 v[202:203], v233 offset:4352
    v_mfma_f32_16x16x32_bf16 v[12:15], v[108:111], v[160:163], v[12:15]
    v_mfma_f32_16x16x32_bf16 v[44:47], v[108:111], v[164:167], v[44:47]
    v_mfma_f32_16x16x32_bf16 v[76:79], v[108:111], v[168:171], v[76:79]
    ds_read_b64_tr_b16 v[204:205], v232 offset:64
    ds_read_b64_tr_b16 v[206:207], v232 offset:4416
    v_mfma_f32_16x16x32_bf16 v[16:19], v[112:115], v[160:163], v[16:19]
    v_mfma_f32_16x16x32_bf16 v[48:51], v[112:115], v[164:167], v[48:51]
    v_mfma_f32_16x16x32_bf16 v[80:83], v[112:115], v[168:171], v[80:83]
    ds_read_b64_tr_b16 v[208:209], v233 offset:64
    ds_read_b64_tr_b16 v[210:211], v233 offset:4416
    v_mfma_f32_16x16x32_bf16 v[20:23], v[116:119], v[160:163], v[20:23]
    v_mfma_f32_16x16x32_bf16 v[52:55], v[116:119], v[164:167], v[52:55]
    v_mfma_f32_16x16x32_bf16 v[84:87], v[116:119], v[168:171], v[84:87]
    ds_read_b64_tr_b16 v[212:213], v234 offset:0
    ds_read_b64_tr_b16 v[214:215], v234 offset:4352
    v_mfma_f32_16x16x32_bf16 v[24:27], v[120:123], v[160:163], v[24:27]
    v_mfma_f32_16x16x32_bf16 v[56:59], v[120:123], v[164:167], v[56:59]
    v_mfma_f32_16x16x32_bf16 v[88:91], v[120:123], v[168:171], v[88:91]
    ds_read_b64_tr_b16 v[216:217], v235 offset:0
    ds_read_b64_tr_b16 v[218:219], v235 offset:4352
    s_waitcnt lgkmcnt(14)
    v_mfma_f32_16x16x32_bf16 v[28:31], v[124:127], v[160:163], v[28:31]
    v_mfma_f32_16x16x32_bf16 v[60:63], v[124:127], v[164:167], v[60:63]
    v_mfma_f32_16x16x32_bf16 v[92:95], v[124:127], v[168:171], v[92:95]
    ds_read_b64_tr_b16 v[220:221], v234 offset:64
    ds_read_b64_tr_b16 v[222:223], v234 offset:4416
    s_waitcnt lgkmcnt(14)
    v_mfma_f32_16x16x32_bf16 v[32:35], v[128:131], v[160:163], v[32:35]
    v_mfma_f32_16x16x32_bf16 v[64:67], v[128:131], v[164:167], v[64:67]
    v_mfma_f32_16x16x32_bf16 v[96:99], v[128:131], v[168:171], v[96:99]
    ds_read_b64_tr_b16 v[224:225], v235 offset:64
    ds_read_b64_tr_b16 v[226:227], v235 offset:4416
    s_add_u32 s59, s79, 69632
    s_xor_b32 s78, s59, 128
    v_add_u32 v232, s59, v230
    v_add_u32 v233, s59, v231
    v_add_u32 v234, s78, v230
    v_add_u32 v235, s78, v231
    s_barrier
    buffer_load_dwordx4 v[184:187], v248, s[12:15], s0 offen offset:3072 sc1
    buffer_load_dwordx4 v[188:191], v249, s[12:15], s0 offen offset:3072 sc1
    buffer_load_dwordx4 v[192:195], v250, s[12:15], s0 offen offset:3072 sc1
    s_waitcnt vmcnt(3)
    s_waitcnt lgkmcnt(4)
    v_mfma_f32_16x16x32_bf16 v[4:7], v[196:199], v[172:175], v[4:7]
    v_mfma_f32_16x16x32_bf16 v[36:39], v[196:199], v[176:179], v[36:39]
    v_mfma_f32_16x16x32_bf16 v[68:71], v[196:199], v[180:183], v[68:71]
    ds_read_b64_tr_b16 v[100:101], v232 offset:0
    ds_read_b64_tr_b16 v[102:103], v232 offset:4352
    v_mfma_f32_16x16x32_bf16 v[8:11], v[200:203], v[172:175], v[8:11]
    v_mfma_f32_16x16x32_bf16 v[40:43], v[200:203], v[176:179], v[40:43]
    v_mfma_f32_16x16x32_bf16 v[72:75], v[200:203], v[180:183], v[72:75]
    ds_read_b64_tr_b16 v[104:105], v233 offset:0
    ds_read_b64_tr_b16 v[106:107], v233 offset:4352
    v_mfma_f32_16x16x32_bf16 v[12:15], v[204:207], v[172:175], v[12:15]
    v_mfma_f32_16x16x32_bf16 v[44:47], v[204:207], v[176:179], v[44:47]
    v_mfma_f32_16x16x32_bf16 v[76:79], v[204:207], v[180:183], v[76:79]
    ds_read_b64_tr_b16 v[108:109], v232 offset:64
    ds_read_b64_tr_b16 v[110:111], v232 offset:4416
    v_mfma_f32_16x16x32_bf16 v[16:19], v[208:211], v[172:175], v[16:19]
    v_mfma_f32_16x16x32_bf16 v[48:51], v[208:211], v[176:179], v[48:51]
    v_mfma_f32_16x16x32_bf16 v[80:83], v[208:211], v[180:183], v[80:83]
    ds_read_b64_tr_b16 v[112:113], v233 offset:64
    ds_read_b64_tr_b16 v[114:115], v233 offset:4416
    v_mfma_f32_16x16x32_bf16 v[20:23], v[212:215], v[172:175], v[20:23]
    v_mfma_f32_16x16x32_bf16 v[52:55], v[212:215], v[176:179], v[52:55]
    v_mfma_f32_16x16x32_bf16 v[84:87], v[212:215], v[180:183], v[84:87]
    ds_read_b64_tr_b16 v[116:117], v234 offset:0
    ds_read_b64_tr_b16 v[118:119], v234 offset:4352
    v_mfma_f32_16x16x32_bf16 v[24:27], v[216:219], v[172:175], v[24:27]
    v_mfma_f32_16x16x32_bf16 v[56:59], v[216:219], v[176:179], v[56:59]
    v_mfma_f32_16x16x32_bf16 v[88:91], v[216:219], v[180:183], v[88:91]
    ds_read_b64_tr_b16 v[120:121], v235 offset:0
    ds_read_b64_tr_b16 v[122:123], v235 offset:4352
    s_waitcnt lgkmcnt(14)
    v_mfma_f32_16x16x32_bf16 v[28:31], v[220:223], v[172:175], v[28:31]
    v_mfma_f32_16x16x32_bf16 v[60:63], v[220:223], v[176:179], v[60:63]
    v_mfma_f32_16x16x32_bf16 v[92:95], v[220:223], v[180:183], v[92:95]
    ds_read_b64_tr_b16 v[124:125], v234 offset:64
    ds_read_b64_tr_b16 v[126:127], v234 offset:4416
    s_waitcnt lgkmcnt(14)
    v_mfma_f32_16x16x32_bf16 v[32:35], v[224:227], v[172:175], v[32:35]
    v_mfma_f32_16x16x32_bf16 v[64:67], v[224:227], v[176:179], v[64:67]
    v_mfma_f32_16x16x32_bf16 v[96:99], v[224:227], v[180:183], v[96:99]
    ds_read_b64_tr_b16 v[128:129], v235 offset:64
    ds_read_b64_tr_b16 v[130:131], v235 offset:4416
    s_waitcnt vmcnt(0)
    s_waitcnt lgkmcnt(6)
    v_mfma_f32_16x16x32_bf16 v[20:23], v[116:119], v[184:187], v[20:23]
    v_mfma_f32_16x16x32_bf16 v[52:55], v[116:119], v[188:191], v[52:55]
    v_mfma_f32_16x16x32_bf16 v[84:87], v[116:119], v[192:195], v[84:87]
    s_waitcnt lgkmcnt(4)
    v_mfma_f32_16x16x32_bf16 v[24:27], v[120:123], v[184:187], v[24:27]
    v_mfma_f32_16x16x32_bf16 v[56:59], v[120:123], v[188:191], v[56:59]
    v_mfma_f32_16x16x32_bf16 v[88:91], v[120:123], v[192:195], v[88:91]
    s_waitcnt lgkmcnt(2)
    v_mfma_f32_16x16x32_bf16 v[28:31], v[124:127], v[184:187], v[28:31]
    v_mfma_f32_16x16x32_bf16 v[60:63], v[124:127], v[188:191], v[60:63]
    v_mfma_f32_16x16x32_bf16 v[92:95], v[124:127], v[192:195], v[92:95]
    s_waitcnt lgkmcnt(0)
    v_mfma_f32_16x16x32_bf16 v[32:35], v[128:131], v[184:187], v[32:35]
    v_mfma_f32_16x16x32_bf16 v[64:67], v[128:131], v[188:191], v[64:67]
    v_mfma_f32_16x16x32_bf16 v[96:99], v[128:131], v[192:195], v[96:99]
    v_mfma_f32_16x16x32_bf16 v[4:7], v[100:103], v[184:187], v[4:7]
    v_mfma_f32_16x16x32_bf16 v[36:39], v[100:103], v[188:191], v[36:39]
    v_mfma_f32_16x16x32_bf16 v[68:71], v[100:103], v[192:195], v[68:71]
    s_barrier
    ds_write_b128 v2, v[20:23] offset:0
    ds_write_b128 v2, v[52:55] offset:4096
    ds_write_b128 v2, v[84:87] offset:8192
    ds_write_b128 v2, v[24:27] offset:1024
    v_mfma_f32_16x16x32_bf16 v[8:11], v[104:107], v[184:187], v[8:11]
    v_mfma_f32_16x16x32_bf16 v[40:43], v[104:107], v[188:191], v[40:43]
    v_mfma_f32_16x16x32_bf16 v[72:75], v[104:107], v[192:195], v[72:75]
    ds_write_b128 v2, v[56:59] offset:5120
    ds_write_b128 v2, v[88:91] offset:9216
    ds_write_b128 v2, v[28:31] offset:2048
    ds_write_b128 v2, v[60:63] offset:6144
    v_mfma_f32_16x16x32_bf16 v[12:15], v[108:111], v[184:187], v[12:15]
    v_mfma_f32_16x16x32_bf16 v[44:47], v[108:111], v[188:191], v[44:47]
    v_mfma_f32_16x16x32_bf16 v[76:79], v[108:111], v[192:195], v[76:79]
    ds_write_b128 v2, v[92:95] offset:10240
    ds_write_b128 v2, v[32:35] offset:3072
    ds_write_b128 v2, v[64:67] offset:7168
    ds_write_b128 v2, v[96:99] offset:11264
    v_mfma_f32_16x16x32_bf16 v[16:19], v[112:115], v[184:187], v[16:19]
    v_mfma_f32_16x16x32_bf16 v[48:51], v[112:115], v[188:191], v[48:51]
    v_mfma_f32_16x16x32_bf16 v[80:83], v[112:115], v[192:195], v[80:83]
    s_mul_i32 s78, s49, -81920
    s_add_u32 s78, s78, 40960
    s_add_u32 s78, s78, s100
    v_add_u32 v3, s78, v248
    v_bfe_u32 v232, v0, 2, 2
    v_lshlrev_b32 v232, 11, v232
    v_lshrrev_b32 v252, 4, v0
    v_lshl_add_u32 v232, v252, 6, v232
    v_and_b32 v252, 3, v0
    v_lshl_add_u32 v232, v252, 4, v232
    v_bfe_u32 v233, v0, 1, 2
    v_lshlrev_b32 v233, 11, v233
    v_lshrrev_b32 v252, 3, v0
    v_lshl_add_u32 v233, v252, 4, v233
    v_and_b32 v252, 1, v0
    v_lshl_add_u32 v233, v252, 3, v233
    s_mul_i32 s59, s44, 40
    s_lshl_b32 s78, s77, 2
    s_add_u32 s59, s59, s78
    s_add_u32 s59, s59, s43
    s_lshl_b32 s59, s59, 2
    s_lshl_b32 s59, s59, 11
    s_lshl_b32 s78, s42, 10
    s_add_u32 s59, s59, s78
    s_lshl_b32 s78, s45, 8
    s_add_u32 s59, s59, s78
    s_lshl_b32 s78, s49, 7
    s_add_u32 s59, s59, s78
    s_add_u32 s8, s36, s59
    s_addc_u32 s9, s37, 0
    s_mov_b32 s10, 71808
    s_mov_b32 s11, 0x20000
    s_lshl_b32 s64, s43, 9
    s_lshl_b32 s65, s43, 11
    s_mov_b32 s62, 0x3f80
    s_mov_b32 s63, 0x3f800000
    s_waitcnt lgkmcnt(0)
    s_barrier
    ds_read_b128 v[100:103], v3 offset:0
    ds_read_b128 v[104:107], v3 offset:1024
    ds_read_b128 v[108:111], v3 offset:2048
    ds_read_b128 v[112:115], v3 offset:3072
    ds_read_b128 v[116:119], v3 offset:4096
    ds_read_b128 v[120:123], v3 offset:5120
    ds_read_b128 v[124:127], v3 offset:6144
    ds_read_b128 v[128:131], v3 offset:7168
    ds_read_b128 v[132:135], v3 offset:8192
    ds_read_b128 v[136:139], v3 offset:9216
    ds_read_b128 v[140:143], v3 offset:10240
    ds_read_b128 v[144:147], v3 offset:11264
    s_waitcnt lgkmcnt(11)
    v_add_f32 v4, v4, v100
    v_add_f32 v5, v5, v101
    v_add_f32 v6, v6, v102
    v_add_f32 v7, v7, v103
    s_waitcnt lgkmcnt(10)
    v_add_f32 v8, v8, v104
    v_add_f32 v9, v9, v105
    v_add_f32 v10, v10, v106
    v_add_f32 v11, v11, v107
    s_waitcnt lgkmcnt(9)
    v_add_f32 v12, v12, v108
    v_add_f32 v13, v13, v109
    v_add_f32 v14, v14, v110
    v_add_f32 v15, v15, v111
    s_waitcnt lgkmcnt(8)
    v_add_f32 v16, v16, v112
    v_add_f32 v17, v17, v113
    v_add_f32 v18, v18, v114
    v_add_f32 v19, v19, v115
    v_cvt_pk_bf16_f32 v4, v4, v5
    v_cvt_pk_bf16_f32 v5, v6, v7
    v_cvt_pk_bf16_f32 v6, v8, v9
    v_cvt_pk_bf16_f32 v7, v10, v11
    v_cvt_pk_bf16_f32 v12, v12, v13
    v_cvt_pk_bf16_f32 v13, v14, v15
    v_cvt_pk_bf16_f32 v14, v16, v17
    v_cvt_pk_bf16_f32 v15, v18, v19
    v_permlane32_swap_b32 v4, v6
    v_permlane32_swap_b32 v5, v7
    v_permlane32_swap_b32 v12, v14
    v_permlane32_swap_b32 v13, v15
    v_permlane16_swap_b32 v4, v6
    v_permlane16_swap_b32 v5, v7
    v_permlane16_swap_b32 v12, v14
    v_permlane16_swap_b32 v13, v15
    buffer_store_dwordx4 v[4:7], v232, s[24:27], s64 offen offset:0 sc1
    buffer_store_dwordx4 v[12:15], v232, s[24:27], s64 offen offset:256 sc1
    s_waitcnt lgkmcnt(7)
    v_add_f32 v36, v36, v116
    v_add_f32 v37, v37, v117
    v_add_f32 v38, v38, v118
    v_add_f32 v39, v39, v119
    s_waitcnt lgkmcnt(6)
    v_add_f32 v40, v40, v120
    v_add_f32 v41, v41, v121
    v_add_f32 v42, v42, v122
    v_add_f32 v43, v43, v123
    s_waitcnt lgkmcnt(5)
    v_add_f32 v44, v44, v124
    v_add_f32 v45, v45, v125
    v_add_f32 v46, v46, v126
    v_add_f32 v47, v47, v127
    s_waitcnt lgkmcnt(4)
    v_add_f32 v48, v48, v128
    v_add_f32 v49, v49, v129
    v_add_f32 v50, v50, v130
    v_add_f32 v51, v51, v131
    v_cvt_pk_bf16_f32 v36, v36, v37
    v_cvt_pk_bf16_f32 v37, v38, v39
    v_cvt_pk_bf16_f32 v38, v40, v41
    v_cvt_pk_bf16_f32 v39, v42, v43
    v_cvt_pk_bf16_f32 v44, v44, v45
    v_cvt_pk_bf16_f32 v45, v46, v47
    v_cvt_pk_bf16_f32 v46, v48, v49
    v_cvt_pk_bf16_f32 v47, v50, v51
    v_permlane32_swap_b32 v36, v38
    v_permlane32_swap_b32 v37, v39
    v_permlane32_swap_b32 v44, v46
    v_permlane32_swap_b32 v45, v47
    v_permlane16_swap_b32 v36, v38
    v_permlane16_swap_b32 v37, v39
    v_permlane16_swap_b32 v44, v46
    v_permlane16_swap_b32 v45, v47
    s_add_u32 s64, s64, 8192
    buffer_store_dwordx4 v[36:39], v232, s[24:27], s64 offen offset:0 sc1
    buffer_store_dwordx4 v[44:47], v232, s[24:27], s64 offen offset:256 sc1
    s_waitcnt lgkmcnt(3)
    v_add_f32 v68, v68, v132
    v_add_f32 v69, v69, v133
    v_add_f32 v70, v70, v134
    v_add_f32 v71, v71, v135
    s_waitcnt lgkmcnt(2)
    v_add_f32 v72, v72, v136
    v_add_f32 v73, v73, v137
    v_add_f32 v74, v74, v138
    v_add_f32 v75, v75, v139
    s_waitcnt lgkmcnt(1)
    v_add_f32 v76, v76, v140
    v_add_f32 v77, v77, v141
    v_add_f32 v78, v78, v142
    v_add_f32 v79, v79, v143
    s_waitcnt lgkmcnt(0)
    v_add_f32 v80, v80, v144
    v_add_f32 v81, v81, v145
    v_add_f32 v82, v82, v146
    v_add_f32 v83, v83, v147
    v_cvt_pk_bf16_f32 v68, v68, v69
    v_cvt_pk_bf16_f32 v69, v70, v71
    v_cvt_pk_bf16_f32 v70, v72, v73
    v_cvt_pk_bf16_f32 v71, v74, v75
    v_cvt_pk_bf16_f32 v76, v76, v77
    v_cvt_pk_bf16_f32 v77, v78, v79
    v_cvt_pk_bf16_f32 v78, v80, v81
    v_cvt_pk_bf16_f32 v79, v82, v83
    v_permlane32_swap_b32 v68, v70
    v_permlane32_swap_b32 v69, v71
    v_permlane32_swap_b32 v76, v78
    v_permlane32_swap_b32 v77, v79
    v_permlane16_swap_b32 v68, v70
    v_permlane16_swap_b32 v69, v71
    v_permlane16_swap_b32 v76, v78
    v_permlane16_swap_b32 v77, v79
    s_add_u32 s64, s64, 8192
    buffer_store_dwordx4 v[68:71], v232, s[24:27], s64 offen offset:0 sc1
    buffer_store_dwordx4 v[76:79], v232, s[24:27], s64 offen offset:256 sc1
    v_lshlrev_b32 v232, 3, v0
    s_waitcnt vmcnt(0)
    s_barrier
    s_barrier
    buffer_load_dwordx2 v[100:101], v232, s[24:27], s65 offen offset:0 sc1
    buffer_load_dwordx2 v[102:103], v232, s[24:27], s65 offen offset:512 sc1
    buffer_load_dwordx2 v[104:105], v232, s[24:27], s65 offen offset:1024 sc1
    buffer_load_dwordx2 v[106:107], v232, s[24:27], s65 offen offset:1536 sc1
    s_add_u32 s65, s65, 8192
    buffer_load_dwordx2 v[108:109], v232, s[24:27], s65 offen offset:0 sc1
    buffer_load_dwordx2 v[110:111], v232, s[24:27], s65 offen offset:512 sc1
    buffer_load_dwordx2 v[112:113], v232, s[24:27], s65 offen offset:1024 sc1
    buffer_load_dwordx2 v[114:115], v232, s[24:27], s65 offen offset:1536 sc1
    s_add_u32 s65, s65, 8192
    buffer_load_dwordx2 v[116:117], v232, s[24:27], s65 offen offset:0 sc1
    buffer_load_dwordx2 v[118:119], v232, s[24:27], s65 offen offset:512 sc1
    buffer_load_dwordx2 v[120:121], v232, s[24:27], s65 offen offset:1024 sc1
    buffer_load_dwordx2 v[122:123], v232, s[24:27], s65 offen offset:1536 sc1
    s_waitcnt vmcnt(11)
    v_lshlrev_b32 v4, 16, v100
    v_and_b32 v5, 0xffff0000, v100
    v_lshlrev_b32 v6, 16, v101
    v_and_b32 v7, 0xffff0000, v101
    s_waitcnt vmcnt(10)
    v_dot2c_f32_bf16 v4, s62, v102
    v_dot2c_f32_bf16 v5, s63, v102
    v_dot2c_f32_bf16 v6, s62, v103
    v_dot2c_f32_bf16 v7, s63, v103
    s_waitcnt vmcnt(9)
    v_dot2c_f32_bf16 v4, s62, v104
    v_dot2c_f32_bf16 v5, s63, v104
    v_dot2c_f32_bf16 v6, s62, v105
    v_dot2c_f32_bf16 v7, s63, v105
    s_waitcnt vmcnt(8)
    v_dot2c_f32_bf16 v4, s62, v106
    v_dot2c_f32_bf16 v5, s63, v106
    v_dot2c_f32_bf16 v6, s62, v107
    v_dot2c_f32_bf16 v7, s63, v107
    s_nop 0
    v_cvt_pk_bf16_f32 v4, v4, v5
    s_nop 0
    v_cvt_pk_bf16_f32 v5, v6, v7
    s_mov_b32 s64, 0
    buffer_store_dwordx2 v[4:5], v233, s[8:11], s64 offen
    s_waitcnt vmcnt(8)
    v_lshlrev_b32 v36, 16, v108
    v_and_b32 v37, 0xffff0000, v108
    v_lshlrev_b32 v38, 16, v109
    v_and_b32 v39, 0xffff0000, v109
    s_waitcnt vmcnt(7)
    v_dot2c_f32_bf16 v36, s62, v110
    v_dot2c_f32_bf16 v37, s63, v110
    v_dot2c_f32_bf16 v38, s62, v111
    v_dot2c_f32_bf16 v39, s63, v111
    s_waitcnt vmcnt(6)
    v_dot2c_f32_bf16 v36, s62, v112
    v_dot2c_f32_bf16 v37, s63, v112
    v_dot2c_f32_bf16 v38, s62, v113
    v_dot2c_f32_bf16 v39, s63, v113
    s_waitcnt vmcnt(5)
    v_dot2c_f32_bf16 v36, s62, v114
    v_dot2c_f32_bf16 v37, s63, v114
    v_dot2c_f32_bf16 v38, s62, v115
    v_dot2c_f32_bf16 v39, s63, v115
    s_nop 0
    v_cvt_pk_bf16_f32 v36, v36, v37
    s_nop 0
    v_cvt_pk_bf16_f32 v37, v38, v39
    s_mov_b32 s64, 32768
    buffer_store_dwordx2 v[36:37], v233, s[8:11], s64 offen
    s_waitcnt vmcnt(5)
    v_lshlrev_b32 v68, 16, v116
    v_and_b32 v69, 0xffff0000, v116
    v_lshlrev_b32 v70, 16, v117
    v_and_b32 v71, 0xffff0000, v117
    s_waitcnt vmcnt(4)
    v_dot2c_f32_bf16 v68, s62, v118
    v_dot2c_f32_bf16 v69, s63, v118
    v_dot2c_f32_bf16 v70, s62, v119
    v_dot2c_f32_bf16 v71, s63, v119
    s_waitcnt vmcnt(3)
    v_dot2c_f32_bf16 v68, s62, v120
    v_dot2c_f32_bf16 v69, s63, v120
    v_dot2c_f32_bf16 v70, s62, v121
    v_dot2c_f32_bf16 v71, s63, v121
    s_waitcnt vmcnt(2)
    v_dot2c_f32_bf16 v68, s62, v122
    v_dot2c_f32_bf16 v69, s63, v122
    v_dot2c_f32_bf16 v70, s62, v123
    v_dot2c_f32_bf16 v71, s63, v123
    s_nop 0
    v_cvt_pk_bf16_f32 v68, v68, v69
    s_nop 0
    v_cvt_pk_bf16_f32 v69, v70, v71
    s_mov_b32 s64, 65536
    buffer_store_dwordx2 v[68:69], v233, s[8:11], s64 offen
    s_endpgm
L_redo_F:
    s_waitcnt vmcnt(0) lgkmcnt(0)
    s_barrier
    s_mov_b32 s50, 17408
    s_mov_b32 s51, 69632
    s_mov_b32 s52, 104448
    s_mov_b32 s53, 121856
    s_mov_b32 s54, 0
    s_mov_b32 s55, 34816
    s_mov_b32 s56, 52224
    s_mov_b32 s57, 87040
    s_mov_b32 s58, 139264
    s_mov_b32 s60, 0
    s_barrier
    v_add_u32 v232, 0, v228
    v_add_u32 v233, 0, v229
    ds_read_b128 v[196:199], v232 offset:0
    ds_read_b128 v[204:207], v232 offset:64
    ds_read_b128 v[212:215], v232 offset:128
    ds_read_b128 v[220:223], v232 offset:192
    ds_read_b128 v[200:203], v233 offset:0
    ds_read_b128 v[208:211], v233 offset:64
    ds_read_b128 v[216:219], v233 offset:128
    ds_read_b128 v[224:227], v233 offset:192
    v_mov_b32 v4, 0
    v_mov_b32 v5, 0
    v_mov_b32 v6, 0
    v_mov_b32 v7, 0
    v_mov_b32 v8, 0
    v_mov_b32 v9, 0
    v_mov_b32 v10, 0
    v_mov_b32 v11, 0
    v_mov_b32 v12, 0
    v_mov_b32 v13, 0
    v_mov_b32 v14, 0
    v_mov_b32 v15, 0
    v_mov_b32 v16, 0
    v_mov_b32 v17, 0
    v_mov_b32 v18, 0
    v_mov_b32 v19, 0
    v_mov_b32 v20, 0
    v_mov_b32 v21, 0
    v_mov_b32 v22, 0
    v_mov_b32 v23, 0
    v_mov_b32 v24, 0
    v_mov_b32 v25, 0
    v_mov_b32 v26, 0
    v_mov_b32 v27, 0
    v_mov_b32 v28, 0
    v_mov_b32 v29, 0
    v_mov_b32 v30, 0
    v_mov_b32 v31, 0
    v_mov_b32 v32, 0
    v_mov_b32 v33, 0
    v_mov_b32 v34, 0
    v_mov_b32 v35, 0
    v_mov_b32 v36, 0
    v_mov_b32 v37, 0
    v_mov_b32 v38, 0
    v_mov_b32 v39, 0
    v_mov_b32 v40, 0
    v_mov_b32 v41, 0
    v_mov_b32 v42, 0
    v_mov_b32 v43, 0
    v_mov_b32 v44, 0
    v_mov_b32 v45, 0
    v_mov_b32 v46, 0
    v_mov_b32 v47, 0
    v_mov_b32 v48, 0
    v_mov_b32 v49, 0
    v_mov_b32 v50, 0
    v_mov_b32 v51, 0
    v_mov_b32 v52, 0
    v_mov_b32 v53, 0
    v_mov_b32 v54, 0
    v_mov_b32 v55, 0
    v_mov_b32 v56, 0
    v_mov_b32 v57, 0
    v_mov_b32 v58, 0
    v_mov_b32 v59, 0
    v_mov_b32 v60, 0
    v_mov_b32 v61, 0
    v_mov_b32 v62, 0
    v_mov_b32 v63, 0
    v_mov_b32 v64, 0
    v_mov_b32 v65, 0
    v_mov_b32 v66, 0
    v_mov_b32 v67, 0
    v_mov_b32 v68, 0
    v_mov_b32 v69, 0
    v_mov_b32 v70, 0
    v_mov_b32 v71, 0
    v_mov_b32 v72, 0
    v_mov_b32 v73, 0
    v_mov_b32 v74, 0
    v_mov_b32 v75, 0
    v_mov_b32 v76, 0
    v_mov_b32 v77, 0
    v_mov_b32 v78, 0
    v_mov_b32 v79, 0
    v_mov_b32 v80, 0
    v_mov_b32 v81, 0
    v_mov_b32 v82, 0
    v_mov_b32 v83, 0
    v_mov_b32 v84, 0
    v_mov_b32 v85, 0
    v_mov_b32 v86, 0
    v_mov_b32 v87, 0
    v_mov_b32 v88, 0
    v_mov_b32 v89, 0
    v_mov_b32 v90, 0
    v_mov_b32 v91, 0
    v_mov_b32 v92, 0
    v_mov_b32 v93, 0
    v_mov_b32 v94, 0
    v_mov_b32 v95, 0
    v_mov_b32 v96, 0
    v_mov_b32 v97, 0
    v_mov_b32 v98, 0
    v_mov_b32 v99, 0
    v_mov_b32 v172, 0
    v_mov_b32 v173, 0
    v_mov_b32 v174, 0
    v_mov_b32 v175, 0
    v_mov_b32 v176, 0
    v_mov_b32 v177, 0
    v_mov_b32 v178, 0
    v_mov_b32 v179, 0
    v_mov_b32 v180, 0
    v_mov_b32 v181, 0
    v_mov_b32 v182, 0
    v_mov_b32 v183, 0
    v_mov_b32 v236, 0
    v_mov_b32 v237, 0
    v_mov_b32 v238, 0
    v_mov_b32 v239, 0
    v_mov_b32 v240, 0
    v_mov_b32 v241, 0
    v_mov_b32 v242, 0
    v_mov_b32 v243, 0
    v_mov_b32 v244, 0
    v_mov_b32 v245, 0
    v_mov_b32 v246, 0
    v_mov_b32 v247, 0
    v_mov_b32 v248, 0x3f803f80
    v_mov_b32 v249, 0x3f803f80
    v_mov_b32 v250, 0x3f803f80
    v_mov_b32 v251, 0x3f803f80
L_safe_F:
    s_barrier
    s_waitcnt lgkmcnt(4)
    v_mfma_f32_16x16x32_bf16 v[148:151], v[196:199], v[100:103], v[172:175]
    v_add_u32 v234, s55, v230
    v_add_u32 v235, s55, v231
    v_mfma_f32_16x16x32_bf16 v[148:151], v[204:207], v[104:107], v[148:151]
    v_add_u32 v232, s50, v228
    v_add_u32 v233, s50, v229
    v_mfma_f32_16x16x32_bf16 v[148:151], v[212:215], v[108:111], v[148:151]
    s_mov_b32 s59, s50
    s_mov_b32 s50, s51
    v_mfma_f32_16x16x32_bf16 v[148:151], v[220:223], v[112:115], v[148:151]
    s_mov_b32 s51, s52
    s_mov_b32 s52, s53
    s_waitcnt lgkmcnt(0)
    v_mfma_f32_16x16x32_bf16 v[152:155], v[200:203], v[100:103], v[172:175]
    s_mov_b32 s53, s54
    s_mov_b32 s54, s59
    v_mfma_f32_16x16x32_bf16 v[152:155], v[208:211], v[104:107], v[152:155]
    s_mov_b32 s59, s55
    s_mov_b32 s55, s56
    v_mfma_f32_16x16x32_bf16 v[152:155], v[216:219], v[108:111], v[152:155]
    s_mov_b32 s56, s57
    s_mov_b32 s57, s58
    v_mfma_f32_16x16x32_bf16 v[152:155], v[224:227], v[112:115], v[152:155]
    s_mov_b32 s58, s59
    v_mfma_f32_16x16x32_bf16 v[156:159], v[196:199], v[116:119], v[176:179]
    v_mfma_f32_16x16x32_bf16 v[156:159], v[204:207], v[120:123], v[156:159]
    v_mfma_f32_16x16x32_bf16 v[156:159], v[212:215], v[124:127], v[156:159]
    v_mfma_f32_16x16x32_bf16 v[156:159], v[220:223], v[128:131], v[156:159]
    v_mfma_f32_16x16x32_bf16 v[160:163], v[200:203], v[116:119], v[176:179]
    v_mfma_f32_16x16x32_bf16 v[160:163], v[208:211], v[120:123], v[160:163]
    v_mfma_f32_16x16x32_bf16 v[160:163], v[216:219], v[124:127], v[160:163]
    v_mfma_f32_16x16x32_bf16 v[160:163], v[224:227], v[128:131], v[160:163]
    v_mfma_f32_16x16x32_bf16 v[164:167], v[196:199], v[132:135], v[180:183]
    ds_read_b64_tr_b16 v[196:197], v234 offset:0
    ds_read_b64_tr_b16 v[198:199], v234 offset:4352
    v_mfma_f32_16x16x32_bf16 v[164:167], v[204:207], v[136:139], v[164:167]
    ds_read_b64_tr_b16 v[204:205], v234 offset:64
    ds_read_b64_tr_b16 v[206:207], v234 offset:4416
    v_mfma_f32_16x16x32_bf16 v[164:167], v[212:215], v[140:143], v[164:167]
    ds_read_b64_tr_b16 v[212:213], v234 offset:128
    ds_read_b64_tr_b16 v[214:215], v234 offset:4480
    v_mfma_f32_16x16x32_bf16 v[164:167], v[220:223], v[144:147], v[164:167]
    ds_read_b64_tr_b16 v[220:221], v234 offset:192
    ds_read_b64_tr_b16 v[222:223], v234 offset:4544
    v_mfma_f32_16x16x32_bf16 v[168:171], v[200:203], v[132:135], v[180:183]
    ds_read_b64_tr_b16 v[200:201], v235 offset:0
    ds_read_b64_tr_b16 v[202:203], v235 offset:4352
    v_mfma_f32_16x16x32_bf16 v[168:171], v[208:211], v[136:139], v[168:171]
    ds_read_b64_tr_b16 v[208:209], v235 offset:64
    ds_read_b64_tr_b16 v[210:211], v235 offset:4416
    v_mfma_f32_16x16x32_bf16 v[168:171], v[216:219], v[140:143], v[168:171]
    ds_read_b64_tr_b16 v[216:217], v235 offset:128
    ds_read_b64_tr_b16 v[218:219], v235 offset:4480
    v_mfma_f32_16x16x32_bf16 v[168:171], v[224:227], v[144:147], v[168:171]
    ds_read_b64_tr_b16 v[224:225], v235 offset:192
    ds_read_b64_tr_b16 v[226:227], v235 offset:4544
    v_max3_f32 v252, v148, v149, v150
    v_max3_f32 v252, v252, v151, v152
    v_max3_f32 v252, v252, v153, v154
    v_max_f32 v252, v252, v155
    v_cmp_lt_f32 vcc, s61, v252
    s_nop 0
    s_cbranch_vccnz L_slow_F0
L_back_F0:
    v_exp_f32 v148, v148
    v_exp_f32 v149, v149
    v_exp_f32 v150, v150
    v_exp_f32 v151, v151
    v_cvt_pk_bf16_f32 v148, v148, v149
    v_cvt_pk_bf16_f32 v149, v150, v151
    v_exp_f32 v152, v152
    v_exp_f32 v153, v153
    v_exp_f32 v154, v154
    v_exp_f32 v155, v155
    v_cvt_pk_bf16_f32 v150, v152, v153
    v_cvt_pk_bf16_f32 v151, v154, v155
    v_max3_f32 v252, v156, v157, v158
    v_max3_f32 v252, v252, v159, v160
    v_max3_f32 v252, v252, v161, v162
    v_max_f32 v252, v252, v163
    v_cmp_lt_f32 vcc, s61, v252
    s_nop 0
    s_cbranch_vccnz L_slow_F1
L_back_F1:
    v_exp_f32 v156, v156
    v_exp_f32 v157, v157
    v_exp_f32 v158, v158
    v_exp_f32 v159, v159
    v_cvt_pk_bf16_f32 v156, v156, v157
    v_cvt_pk_bf16_f32 v157, v158, v159
    v_exp_f32 v160, v160
    v_exp_f32 v161, v161
    v_exp_f32 v162, v162
    v_exp_f32 v163, v163
    v_cvt_pk_bf16_f32 v158, v160, v161
    v_cvt_pk_bf16_f32 v159, v162, v163
    v_max3_f32 v252, v164, v165, v166
    v_max3_f32 v252, v252, v167, v168
    v_max3_f32 v252, v252, v169, v170
    v_max_f32 v252, v252, v171
    v_cmp_lt_f32 vcc, s61, v252
    s_nop 0
    s_cbranch_vccnz L_slow_F2
L_back_F2:
    v_exp_f32 v164, v164
    v_exp_f32 v165, v165
    v_exp_f32 v166, v166
    v_exp_f32 v167, v167
    v_cvt_pk_bf16_f32 v164, v164, v165
    v_cvt_pk_bf16_f32 v165, v166, v167
    v_exp_f32 v168, v168
    v_exp_f32 v169, v169
    v_exp_f32 v170, v170
    v_exp_f32 v171, v171
    v_cvt_pk_bf16_f32 v166, v168, v169
    v_cvt_pk_bf16_f32 v167, v170, v171
    s_mov_b32 s47, 0
    s_mov_b32 s61, 0x41000000
    s_waitcnt lgkmcnt(8)
    v_mfma_f32_16x16x32_bf16 v[4:7], v[196:199], v[148:151], v[4:7]
    v_mfma_f32_16x16x32_bf16 v[12:15], v[204:207], v[148:151], v[12:15]
    v_mfma_f32_16x16x32_bf16 v[20:23], v[212:215], v[148:151], v[20:23]
    v_mfma_f32_16x16x32_bf16 v[28:31], v[220:223], v[148:151], v[28:31]
    s_waitcnt lgkmcnt(0)
    v_mfma_f32_16x16x32_bf16 v[8:11], v[200:203], v[148:151], v[8:11]
    v_mfma_f32_16x16x32_bf16 v[16:19], v[208:211], v[148:151], v[16:19]
    v_mfma_f32_16x16x32_bf16 v[24:27], v[216:219], v[148:151], v[24:27]
    v_mfma_f32_16x16x32_bf16 v[32:35], v[224:227], v[148:151], v[32:35]
    v_mfma_f32_16x16x32_bf16 v[236:239], v[248:251], v[148:151], v[236:239]
    v_mfma_f32_16x16x32_bf16 v[36:39], v[196:199], v[156:159], v[36:39]
    v_mfma_f32_16x16x32_bf16 v[44:47], v[204:207], v[156:159], v[44:47]
    v_mfma_f32_16x16x32_bf16 v[52:55], v[212:215], v[156:159], v[52:55]
    v_mfma_f32_16x16x32_bf16 v[60:63], v[220:223], v[156:159], v[60:63]
    v_mfma_f32_16x16x32_bf16 v[40:43], v[200:203], v[156:159], v[40:43]
    v_mfma_f32_16x16x32_bf16 v[48:51], v[208:211], v[156:159], v[48:51]
    v_mfma_f32_16x16x32_bf16 v[56:59], v[216:219], v[156:159], v[56:59]
    v_mfma_f32_16x16x32_bf16 v[64:67], v[224:227], v[156:159], v[64:67]
    v_mfma_f32_16x16x32_bf16 v[240:243], v[248:251], v[156:159], v[240:243]
    v_mfma_f32_16x16x32_bf16 v[68:71], v[196:199], v[164:167], v[68:71]
    ds_read_b128 v[196:199], v232 offset:0
    v_mfma_f32_16x16x32_bf16 v[76:79], v[204:207], v[164:167], v[76:79]
    ds_read_b128 v[204:207], v232 offset:64
    v_mfma_f32_16x16x32_bf16 v[84:87], v[212:215], v[164:167], v[84:87]
    ds_read_b128 v[212:215], v232 offset:128
    v_mfma_f32_16x16x32_bf16 v[92:95], v[220:223], v[164:167], v[92:95]
    ds_read_b128 v[220:223], v232 offset:192
    v_mfma_f32_16x16x32_bf16 v[72:75], v[200:203], v[164:167], v[72:75]
    ds_read_b128 v[200:203], v233 offset:0
    v_mfma_f32_16x16x32_bf16 v[80:83], v[208:211], v[164:167], v[80:83]
    ds_read_b128 v[208:211], v233 offset:64
    v_mfma_f32_16x16x32_bf16 v[88:91], v[216:219], v[164:167], v[88:91]
    ds_read_b128 v[216:219], v233 offset:128
    v_mfma_f32_16x16x32_bf16 v[96:99], v[224:227], v[164:167], v[96:99]
    v_mfma_f32_16x16x32_bf16 v[244:247], v[248:251], v[164:167], v[244:247]
    ds_read_b128 v[224:227], v233 offset:192
    s_add_u32 s60, s60, 1
    s_cmp_lt_u32 s60, 16
    s_cbranch_scc1 L_safe_F
    s_waitcnt lgkmcnt(0)
    s_branch L_epi_F
L_slow_F0:
    v_mov_b32 v253, v252
    s_nop 1
    v_permlane32_swap_b32 v252, v253
    v_max_f32 v252, v252, v253
    v_mov_b32 v253, v252
    s_nop 1
    v_permlane16_swap_b32 v252, v253
    v_max_f32 v252, v252, v253
    v_max_f32 v252, s47, v252
    v_min_f32_e64 v253, -v252, 0
    v_exp_f32 v253, v253
    v_sub_f32 v148, v148, v252
    v_sub_f32 v149, v149, v252
    v_sub_f32 v150, v150, v252
    v_sub_f32 v151, v151, v252
    v_sub_f32 v152, v152, v252
    v_sub_f32 v153, v153, v252
    v_sub_f32 v154, v154, v252
    v_sub_f32 v155, v155, v252
    v_sub_f32 v172, v172, v252
    v_sub_f32 v173, v173, v252
    v_sub_f32 v174, v174, v252
    v_sub_f32 v175, v175, v252
    v_mul_f32 v236, v236, v253
    v_mul_f32 v237, v237, v253
    v_mul_f32 v238, v238, v253
    v_mul_f32 v239, v239, v253
    v_mul_f32 v4, v4, v253
    v_mul_f32 v5, v5, v253
    v_mul_f32 v6, v6, v253
    v_mul_f32 v7, v7, v253
    v_mul_f32 v8, v8, v253
    v_mul_f32 v9, v9, v253
    v_mul_f32 v10, v10, v253
    v_mul_f32 v11, v11, v253
    v_mul_f32 v12, v12, v253
    v_mul_f32 v13, v13, v253
    v_mul_f32 v14, v14, v253
    v_mul_f32 v15, v15, v253
    v_mul_f32 v16, v16, v253
    v_mul_f32 v17, v17, v253
    v_mul_f32 v18, v18, v253
    v_mul_f32 v19, v19, v253
    v_mul_f32 v20, v20, v253
    v_mul_f32 v21, v21, v253
    v_mul_f32 v22, v22, v253
    v_mul_f32 v23, v23, v253
    v_mul_f32 v24, v24, v253
    v_mul_f32 v25, v25, v253
    v_mul_f32 v26, v26, v253
    v_mul_f32 v27, v27, v253
    v_mul_f32 v28, v28, v253
    v_mul_f32 v29, v29, v253
    v_mul_f32 v30, v30, v253
    v_mul_f32 v31, v31, v253
    v_mul_f32 v32, v32, v253
    v_mul_f32 v33, v33, v253
    v_mul_f32 v34, v34, v253
    v_mul_f32 v35, v35, v253
    s_branch L_back_F0
L_slow_F1:
    v_mov_b32 v253, v252
    s_nop 1
    v_permlane32_swap_b32 v252, v253
    v_max_f32 v252, v252, v253
    v_mov_b32 v253, v252
    s_nop 1
    v_permlane16_swap_b32 v252, v253
    v_max_f32 v252, v252, v253
    v_max_f32 v252, s47, v252
    v_min_f32_e64 v253, -v252, 0
    v_exp_f32 v253, v253
    v_sub_f32 v156, v156, v252
    v_sub_f32 v157, v157, v252
    v_sub_f32 v158, v158, v252
    v_sub_f32 v159, v159, v252
    v_sub_f32 v160, v160, v252
    v_sub_f32 v161, v161, v252
    v_sub_f32 v162, v162, v252
    v_sub_f32 v163, v163, v252
    v_sub_f32 v176, v176, v252
    v_sub_f32 v177, v177, v252
    v_sub_f32 v178, v178, v252
    v_sub_f32 v179, v179, v252
    v_mul_f32 v240, v240, v253
    v_mul_f32 v241, v241, v253
    v_mul_f32 v242, v242, v253
    v_mul_f32 v243, v243, v253
    v_mul_f32 v36, v36, v253
    v_mul_f32 v37, v37, v253
    v_mul_f32 v38, v38, v253
    v_mul_f32 v39, v39, v253
    v_mul_f32 v40, v40, v253
    v_mul_f32 v41, v41, v253
    v_mul_f32 v42, v42, v253
    v_mul_f32 v43, v43, v253
    v_mul_f32 v44, v44, v253
    v_mul_f32 v45, v45, v253
    v_mul_f32 v46, v46, v253
    v_mul_f32 v47, v47, v253
    v_mul_f32 v48, v48, v253
    v_mul_f32 v49, v49, v253
    v_mul_f32 v50, v50, v253
    v_mul_f32 v51, v51, v253
    v_mul_f32 v52, v52, v253
    v_mul_f32 v53, v53, v253
    v_mul_f32 v54, v54, v253
    v_mul_f32 v55, v55, v253
    v_mul_f32 v56, v56, v253
    v_mul_f32 v57, v57, v253
    v_mul_f32 v58, v58, v253
    v_mul_f32 v59, v59, v253
    v_mul_f32 v60, v60, v253
    v_mul_f32 v61, v61, v253
    v_mul_f32 v62, v62, v253
    v_mul_f32 v63, v63, v253
    v_mul_f32 v64, v64, v253
    v_mul_f32 v65, v65, v253
    v_mul_f32 v66, v66, v253
    v_mul_f32 v67, v67, v253
    s_branch L_back_F1
L_slow_F2:
    v_mov_b32 v253, v252
    s_nop 1
    v_permlane32_swap_b32 v252, v253
    v_max_f32 v252, v252, v253
    v_mov_b32 v253, v252
    s_nop 1
    v_permlane16_swap_b32 v252, v253
    v_max_f32 v252, v252, v253
    v_max_f32 v252, s47, v252
    v_min_f32_e64 v253, -v252, 0
    v_exp_f32 v253, v253
    v_sub_f32 v164, v164, v252
    v_sub_f32 v165, v165, v252
    v_sub_f32 v166, v166, v252
    v_sub_f32 v167, v167, v252
    v_sub_f32 v168, v168, v252
    v_sub_f32 v169, v169, v252
    v_sub_f32 v170, v170, v252
    v_sub_f32 v171, v171, v252
    v_sub_f32 v180, v180, v252
    v_sub_f32 v181, v181, v252
    v_sub_f32 v182, v182, v252
    v_sub_f32 v183, v183, v252
    v_mul_f32 v244, v244, v253
    v_mul_f32 v245, v245, v253
    v_mul_f32 v246, v246, v253
    v_mul_f32 v247, v247, v253
    v_mul_f32 v68, v68, v253
    v_mul_f32 v69, v69, v253
    v_mul_f32 v70, v70, v253
    v_mul_f32 v71, v71, v253
    v_mul_f32 v72, v72, v253
    v_mul_f32 v73, v73, v253
    v_mul_f32 v74, v74, v253
    v_mul_f32 v75, v75, v253
    v_mul_f32 v76, v76, v253
    v_mul_f32 v77, v77, v253
    v_mul_f32 v78, v78, v253
    v_mul_f32 v79, v79, v253
    v_mul_f32 v80, v80, v253
    v_mul_f32 v81, v81, v253
    v_mul_f32 v82, v82, v253
    v_mul_f32 v83, v83, v253
    v_mul_f32 v84, v84, v253
    v_mul_f32 v85, v85, v253
    v_mul_f32 v86, v86, v253
    v_mul_f32 v87, v87, v253
    v_mul_f32 v88, v88, v253
    v_mul_f32 v89, v89, v253
    v_mul_f32 v90, v90, v253
    v_mul_f32 v91, v91, v253
    v_mul_f32 v92, v92, v253
    v_mul_f32 v93, v93, v253
    v_mul_f32 v94, v94, v253
    v_mul_f32 v95, v95, v253
    v_mul_f32 v96, v96, v253
    v_mul_f32 v97, v97, v253
    v_mul_f32 v98, v98, v253
    v_mul_f32 v99, v99, v253
    s_branch L_back_F2
L_end:
    s_endpgm
.section .rodata,"a"
.p2align 6
.amdhsa_kernel concat_heads__gqa_block_cached__mha_block_cached__near_ridge_kernel
  .amdhsa_next_free_vgpr 254
  .amdhsa_next_free_sgpr 101
  .amdhsa_accum_offset 256
  .amdhsa_group_segment_fixed_size 0
  .amdhsa_kernarg_size 104
  .amdhsa_user_sgpr_count 2
  .amdhsa_user_sgpr_kernarg_segment_ptr 1
  .amdhsa_system_sgpr_workgroup_id_x 1
.end_amdhsa_kernel
```
